```python
import torch

def _softmax(x, axis=-1):
    return torch.softmax(x, dim=axis)
def _gelu(x):
    return torch.nn.functional.gelu(x, approximate="tanh")
def _silu(x):
    return torch.nn.functional.silu(x)
def _sigmoid(x):
    return torch.sigmoid(x)
def _layernorm(x, axis=-1, eps=1e-5):
    m = x.mean(dim=axis, keepdim=True)
    v = x.var(dim=axis, keepdim=True, unbiased=False)
    return (x - m) / torch.sqrt(v + eps)
def _scatter_add(tgt, idx, src, axis=0):
    return tgt.clone().index_add_(axis, idx, src)
def _segment_sum(src, seg, n):
    out = torch.zeros((n,) + src.shape[1:], dtype=src.dtype)
    return out.index_add_(0, seg, src)
def _pad(x, pw):
    flat = tuple(v for pair in reversed(pw) for v in pair)
    return torch.nn.functional.pad(x, flat)

kernel_name = 'standalone__softmax_full_mha__prompt'

def setup_inputs():

    _w = (lambda a: (lambda t: t.to(torch.bfloat16) if t.is_floating_point() else t)(torch.as_tensor(a)))
    B, S, D = 1, 2048, 640
    return {
        "x": _w((lambda *s: torch.randn(*s, dtype=torch.bfloat16) * 0.2)(B, S, D)),
        "wqkv": _w((lambda *s: torch.randn(*s, dtype=torch.bfloat16) * 0.2)(D, 3 * D)),
        "wo": _w((lambda *s: torch.randn(*s, dtype=torch.bfloat16) * 0.05)(D, D)),
    }

def reference(x, wqkv, wo):
    B, S, D = x.shape
    H = 32; Dh = D // H
    qkv = (lambda x, *d: x.permute(*d))((x @ wqkv).reshape(B, S, 3, H, Dh), 2, 0, 3, 1, 4)
    q, k, v = qkv[0], qkv[1], qkv[2]
    scale = Dh ** -0.5
    scores = torch.einsum("bhqd,bhkd->bhqk", q, k) * scale
    p = _softmax(scores, axis=-1)
    o = torch.einsum("bhqk,bhkd->bhqd", p, v)
    return (lambda x, *d: x.permute(*d))(o, 0, 2, 1, 3).reshape(B, S, D) @ wo
```

```asm
; @launch grid=(256,1,1) block=(512,1,1) lds=163840
.amdgcn_target "amdgcn-amd-amdhsa--gfx950"
.text
.globl standalone__softmax_full_mha__prompt_kernel
.p2align 12
.fill 832, 4, 0xbf800000
.p2align 8
.type standalone__softmax_full_mha__prompt_kernel,@function
standalone__softmax_full_mha__prompt_kernel:
    s_cmp_ge_u32 s2, 256
    s_cbranch_scc1 L_end
    s_load_dwordx4 s[4:7], s[0:1], 0
    s_load_dwordx8 s[36:43], s[0:1], 16
    v_lshrrev_b32 v2, 6, v0
    v_and_b32 v1, 63, v0
    v_readfirstlane_b32 s16, v2
    s_getpc_b64 s[26:27]
L_pc:
    s_bfe_u32 s3, s2, 0x30003
    s_lshl_b32 s3, s3, 13
    s_cmp_eq_u32 s16, 0
    s_cbranch_scc0 L_nopf
    v_lshl_add_u32 v3, v1, 7, s3
    v_min_u32 v3, L_code_end - L_pc - 4, v3
    global_load_dword v0, v3, s[26:27]
L_nopf:
    s_bfe_u32 s3, s2, 0x20003
    s_and_b32 s18, s2, 3
    s_lshl_b32 s18, s18, 2
    s_add_u32 s18, s18, s3
    s_and_b32 s17, s2, 0xe4
    s_cmp_eq_u32 s17, 0xe4
    s_cbranch_scc1 L_idle
    s_bitcmp1_b32 s2, 2
    s_cselect_b32 s19, 0, 7
    s_lshr_b32 s17, s2, 5
    s_add_u32 s17, s17, s19
    s_cmp_lt_u32 s16, 4
    s_cbranch_scc1 L_qkv_cons
    s_add_u32 s100, s3, s17
    s_and_b32 s100, s100, 1
    s_mul_i32 s100, s100, 5
    s_and_b32 s101, s2, 7
    s_lshl_b32 s101, s101, 2
    s_lshr_b32 s101, 558056208, s101
    s_and_b32 s101, s101, 15
    s_add_u32 s100, s100, s101
    s_sub_u32 s101, s100, 10
    s_cselect_b32 s100, s100, s101
    s_and_b32 s19, s16, 3
    s_lshl_b32 s96, s19, 4
    s_lshr_b32 s101, s19, 1
    s_lshl_b32 s101, s101, 5
    s_and_b32 s34, s19, 1
    s_lshl_b32 s34, s34, 2
    s_add_u32 s101, s101, s34
    s_cmp_lt_u32 s17, 10
    s_cselect_b32 s96, s96, s101
    s_cselect_b32 s101, 4, 8
    s_mul_i32 s101, s101, 1280
    s_lshl_b32 s34, s18, 7
    s_add_u32 s96, s96, s34
    s_mul_i32 s96, s96, 1280
    v_lshrrev_b32 v2, 5, v1
    v_mul_u32_u24 v2, s101, v2
    v_bfe_u32 v3, v1, 3, 2
    v_mul_u32_u24 v3, 1280, v3
    v_lshrrev_b32 v5, 4, v1
    v_and_b32 v4, 7, v1
    v_xor_b32 v4, v4, v5
    v_lshlrev_b32 v4, 4, v4
    v_add3_u32 v8, v2, v3, v4
    v_xor_b32 v4, 64, v4
    v_add3_u32 v9, v2, v3, v4
    s_lshl_b32 s101, s101, 1
    s_sub_u32 s101, s101, 1024
    v_add_u32 v9, s101, v9
    v_and_b32 v3, 15, v1
    v_lshlrev_b32 v6, 1, v5
    v_xor_b32 v3, v3, v6
    v_mul_u32_u24 v2, 3840, v5
    v_lshl_add_u32 v16, v3, 4, v2
    v_add_u32 v17, 14336, v16
    v_xor_b32 v3, 8, v3
    v_lshl_add_u32 v18, v3, 4, v2
    v_add_u32 v19, 43008, v18
    v_add_u32 v18, 28672, v18
    s_mul_i32 s97, s19, 61440
    s_lshl_b32 s3, s17, 8
    s_add_u32 s97, s97, s3
    s_lshl_b32 s98, s19, 11
    s_lshl_b32 s99, s19, 12
    s_mov_b32 s10, 2621440
    s_mov_b32 s11, 0x00020000
    s_mov_b32 s14, 2457600
    s_mov_b32 s15, 0x00020000
    s_waitcnt lgkmcnt(0)
    s_mov_b32 s8, s4
    s_mov_b32 s9, s5
    s_mov_b32 s12, s6
    s_mov_b32 s13, s7
    s_lshl_b32 s101, s100, 7
    s_add_u32 m0, s98, 0
    s_add_u32 s101, s101, s96
    buffer_load_dwordx4 v8, s[8:11], s101 offen offset:0  lds
    buffer_load_dwordx4 v9, s[8:11], s101 offen offset:1024  lds
    s_mul_i32 s34, s100, 245760
    s_add_u32 m0, s99, 8192
    s_add_u32 s34, s34, s97
    buffer_load_dwordx4 v16, s[12:15], s34 offen offset:0  lds
    buffer_load_dwordx4 v17, s[12:15], s34 offen offset:1024  lds
    buffer_load_dwordx4 v18, s[12:15], s34 offen offset:2048  lds
    buffer_load_dwordx4 v19, s[12:15], s34 offen offset:3072  lds
    s_add_u32 s100, s100, 1
    s_cmp_eq_u32 s100, 10
    s_cselect_b32 s100, 0, s100
    s_lshl_b32 s101, s100, 7
    s_add_u32 m0, s98, 24576
    s_add_u32 s101, s101, s96
    buffer_load_dwordx4 v8, s[8:11], s101 offen offset:0  lds
    buffer_load_dwordx4 v9, s[8:11], s101 offen offset:1024  lds
    s_mul_i32 s34, s100, 245760
    s_add_u32 m0, s99, 32768
    s_add_u32 s34, s34, s97
    buffer_load_dwordx4 v16, s[12:15], s34 offen offset:0  lds
    buffer_load_dwordx4 v17, s[12:15], s34 offen offset:1024  lds
    buffer_load_dwordx4 v18, s[12:15], s34 offen offset:2048  lds
    buffer_load_dwordx4 v19, s[12:15], s34 offen offset:3072  lds
    s_add_u32 s100, s100, 1
    s_cmp_eq_u32 s100, 10
    s_cselect_b32 s100, 0, s100
    s_lshl_b32 s101, s100, 7
    s_add_u32 m0, s98, 49152
    s_add_u32 s101, s101, s96
    buffer_load_dwordx4 v8, s[8:11], s101 offen offset:0  lds
    buffer_load_dwordx4 v9, s[8:11], s101 offen offset:1024  lds
    s_mul_i32 s34, s100, 245760
    s_add_u32 m0, s99, 57344
    s_add_u32 s34, s34, s97
    buffer_load_dwordx4 v16, s[12:15], s34 offen offset:0  lds
    buffer_load_dwordx4 v17, s[12:15], s34 offen offset:1024  lds
    buffer_load_dwordx4 v18, s[12:15], s34 offen offset:2048  lds
    buffer_load_dwordx4 v19, s[12:15], s34 offen offset:3072  lds
    s_add_u32 s100, s100, 1
    s_cmp_eq_u32 s100, 10
    s_cselect_b32 s100, 0, s100
    s_mov_b32 s44, s42
    s_mov_b32 s45, s43
    s_mov_b32 s46, 10616832
    s_mov_b32 s47, 0x00020000
    s_mov_b32 s48, s36
    s_mov_b32 s49, s37
    s_mov_b32 s50, 819200
    s_mov_b32 s51, 0x00020000
    s_mov_b32 s52, s38
    s_mov_b32 s53, s39
    s_mov_b32 s54, 2621440
    s_mov_b32 s55, 0x00020000
    s_mov_b32 s56, s40
    s_mov_b32 s57, s41
    s_mov_b32 s58, 256
    s_mov_b32 s59, 0x00020000
    v_and_b32 v10, 15, v1
    v_lshlrev_b32 v10, 2, v10
    s_lshl_b32 s60, s17, 4
    s_add_u32 s60, s60, s18
    s_lshl_b32 s60, s60, 7
    s_add_u32 s60, s60, 10518528
    s_waitcnt vmcnt(12)
    s_barrier
    s_lshl_b32 s101, s100, 7
    s_add_u32 m0, s98, 81920
    s_add_u32 s101, s101, s96
    buffer_load_dwordx4 v8, s[8:11], s101 offen offset:0  lds
    buffer_load_dwordx4 v9, s[8:11], s101 offen offset:1024  lds
    s_mul_i32 s34, s100, 245760
    s_add_u32 m0, s99, 90112
    s_add_u32 s34, s34, s97
    buffer_load_dwordx4 v16, s[12:15], s34 offen offset:0  lds
    buffer_load_dwordx4 v17, s[12:15], s34 offen offset:1024  lds
    buffer_load_dwordx4 v18, s[12:15], s34 offen offset:2048  lds
    buffer_load_dwordx4 v19, s[12:15], s34 offen offset:3072  lds
    s_add_u32 s100, s100, 1
    s_cmp_eq_u32 s100, 10
    s_cselect_b32 s100, 0, s100
    s_and_b32 s17, s2, 7
    s_lshl_b32 s17, s17, 2
    s_lshr_b32 s17, 0x75643120, s17
    s_and_b32 s17, s17, 7
    s_lshl_b32 s17, s17, 2
    s_bfe_u32 s3, s2, 0x20003
    s_add_u32 s17, s17, s3
    s_lshr_b32 s29, s2, 5
    s_lshl_b32 s18, s29, 2
    s_and_b32 s3, s16, 2
    s_add_u32 s18, s18, s3
    s_add_u32 s18, s18, 0
    s_and_b32 s19, s16, 1
    s_mul_i32 s20, s19, 5120
    v_and_b32 v2, 31, v1
    v_lshrrev_b32 v3, 5, v1
    v_lshlrev_b32 v14, 3, v2
    v_lshl_add_u32 v122, v3, 9, v14
    v_add_u32 v133, s20, v122
    v_add_u32 v134, 256, v133
    v_lshlrev_b32 v14, 3, v1
    v_add_u32 v135, s20, v14
    s_lshl_b32 s3, s19, 8
    v_xor_b32 v123, s3, v14
    v_mul_u32_u24 v15, 320, v3
    v_lshl_add_u32 v15, v2, 4, v15
    s_add_u32 s3, s20, 2560
    v_add_u32 v136, s3, v15
    v_add_u32 v137, 40960, v136
    v_lshlrev_b32 v121, 4, v1
    v_mov_b32 v132, 0xdddddddd
    s_mov_b32 s24, 0x000fffff
    s_mov_b32 s25, 0x000fffff
    v_cmp_eq_u32 vcc, 20, v2
    v_mov_b32 v15, 0x3f803f80
    s_mul_i32 s21, s17, 163840
    v_cndmask_b32 v96, 0, v15, vcc
    s_add_u32 s21, s21, 2621440
    v_mov_b32 v97, v96
    v_mov_b64 v[98:99], v[96:97]
    s_waitcnt vmcnt(12)
    s_barrier
    s_lshl_b32 s101, s100, 7
    s_add_u32 m0, s98, 106496
    s_add_u32 s101, s101, s96
    buffer_load_dwordx4 v8, s[8:11], s101 offen offset:0  lds
    buffer_load_dwordx4 v9, s[8:11], s101 offen offset:1024  lds
    s_mul_i32 s34, s100, 245760
    s_add_u32 m0, s99, 114688
    s_add_u32 s34, s34, s97
    buffer_load_dwordx4 v16, s[12:15], s34 offen offset:0  lds
    buffer_load_dwordx4 v17, s[12:15], s34 offen offset:1024  lds
    buffer_load_dwordx4 v18, s[12:15], s34 offen offset:2048  lds
    buffer_load_dwordx4 v19, s[12:15], s34 offen offset:3072  lds
    s_add_u32 s100, s100, 1
    s_cmp_eq_u32 s100, 10
    s_cselect_b32 s100, 0, s100
    v_mov_b64 v[100:101], v[96:97]
    v_mov_b64 v[102:103], v[96:97]
    v_mov_b64 v[104:105], v[96:97]
    v_mov_b64 v[106:107], v[96:97]
    v_mov_b64 v[108:109], v[96:97]
    v_mov_b64 v[110:111], v[96:97]
    s_mul_i32 s26, s18, 2560
    s_mul_i32 s3, s17, 81920
    s_add_u32 s26, s26, s3
    s_lshl_b32 s3, s19, 8
    s_add_u32 s22, s26, s3
    s_xor_b32 s3, s3, 256
    s_add_u32 s23, s26, s3
    s_and_b32 s28, s16, 3
    s_mul_i32 s27, s29, 0
    s_add_u32 s27, s27, s28
    s_mul_i32 s28, s28, 5120
    s_add_u32 s28, s28, 0
    s_add_u32 s61, s21, 0
    s_lshl_b32 s30, s18, 1
    s_xor_b32 s31, s19, 1
    s_add_u32 s30, s30, s31
    s_mul_i32 s37, s30, 40960
    s_add_u32 s37, s37, 7864320
    s_lshl_b32 s36, s17, 9
    s_add_u32 s36, s36, s37
    s_lshl_b32 s3, s17, 7
    s_add_u32 s37, s37, s3
    s_add_u32 s37, s37, 16384
    s_lshr_b32 s38, s2, 5
    s_lshl_b32 s38, s38, 12
    s_add_u32 s38, s38, s3
    s_add_u32 s38, s38, 10551296
    s_add_u32 s39, s38, 32768
    v_bfe_u32 v2, v1, 4, 1
    v_mul_u32_u24 v2, 20480, v2
    v_and_b32 v3, 15, v1
    v_lshl_add_u32 v127, v3, 3, v2
    v_lshl_add_u32 v2, v3, 4, v2
    v_lshrrev_b32 v3, 5, v1
    s_waitcnt vmcnt(12)
    s_barrier
    s_lshl_b32 s101, s100, 7
    s_add_u32 m0, s98, 131072
    s_add_u32 s101, s101, s96
    buffer_load_dwordx4 v8, s[8:11], s101 offen offset:0  lds
    buffer_load_dwordx4 v9, s[8:11], s101 offen offset:1024  lds
    s_mul_i32 s34, s100, 245760
    s_add_u32 m0, s99, 139264
    s_add_u32 s34, s34, s97
    buffer_load_dwordx4 v16, s[12:15], s34 offen offset:0  lds
    buffer_load_dwordx4 v17, s[12:15], s34 offen offset:1024  lds
    buffer_load_dwordx4 v18, s[12:15], s34 offen offset:2048  lds
    buffer_load_dwordx4 v19, s[12:15], s34 offen offset:3072  lds
    s_add_u32 s100, s100, 1
    s_cmp_eq_u32 s100, 10
    s_cselect_b32 s100, 0, s100
    v_lshl_add_u32 v126, v3, 8, v2
    s_mul_i32 s3, s16, 3072
    s_add_u32 s3, s3, 102400
    v_add_u32 v128, s3, v121
    s_xor_b32 s3, s16, 1
    s_mul_i32 s3, s3, 3072
    s_add_u32 s3, s3, 102400
    v_add_u32 v129, s3, v121
    v_mov_b64 v[112:113], -1
    v_mov_b64 v[114:115], -1
    v_mov_b32 v130, 1
    v_mov_b32 v131, 0
    s_lshr_b32 s30, s16, 2
    s_and_b32 s31, s16, 3
    s_mul_i32 s3, s30, 51200
    v_lshrrev_b32 v2, 5, v1
    v_bfe_u32 v3, v1, 4, 1
    v_bfe_u32 v14, v1, 2, 2
    v_mul_u32_u24 v15, 20, v2
    v_lshl_add_u32 v15, v3, 2, v15
    v_add_u32 v15, v15, v14
    v_mul_u32_u24 v15, 160, v15
    v_and_b32 v2, 3, v1
    v_lshl_add_u32 v2, v2, 3, s3
    v_add_u32 v138, v15, v2
    v_lshrrev_b32 v3, 4, v1
    v_mul_u32_u24 v15, 20, v3
    v_add3_u32 v15, v15, 16, v14
    v_mul_u32_u24 v15, 160, v15
    v_add_u32 v139, v15, v2
    s_mul_i32 s3, s31, 5120
    s_add_u32 s3, s3, 143360
    v_add_u32 v140, s3, v121
    s_mul_i32 s3, s31, 3584
    s_add_u32 s3, s3, 102400
    v_and_b32 v2, 15, v1
    v_mul_u32_u24 v2, 176, v2
    v_lshl_add_u32 v2, v3, 3, v2
    v_add_u32 v141, s3, v2
    s_and_b32 s40, s2, 7
    s_waitcnt vmcnt(12)
    s_barrier
    s_lshl_b32 s101, s100, 7
    s_add_u32 m0, s98, 0
    s_add_u32 s101, s101, s96
    buffer_load_dwordx4 v8, s[8:11], s101 offen offset:0  lds
    buffer_load_dwordx4 v9, s[8:11], s101 offen offset:1024  lds
    s_mul_i32 s34, s100, 245760
    s_add_u32 m0, s99, 8192
    s_add_u32 s34, s34, s97
    buffer_load_dwordx4 v16, s[12:15], s34 offen offset:0  lds
    buffer_load_dwordx4 v17, s[12:15], s34 offen offset:1024  lds
    buffer_load_dwordx4 v18, s[12:15], s34 offen offset:2048  lds
    buffer_load_dwordx4 v19, s[12:15], s34 offen offset:3072  lds
    s_add_u32 s100, s100, 1
    s_cmp_eq_u32 s100, 10
    s_cselect_b32 s100, 0, s100
    s_lshl_b32 s41, s40, 2
    s_bfe_u32 s30, s2, 0x20003
    s_add_u32 s41, s41, s30
    s_lshl_b32 s40, s40, 12
    s_add_u32 s40, s40, 10551296
    s_lshl_b32 s41, s41, 2
    s_add_u32 s41, s41, s31
    s_mul_i32 s41, s41, 20480
    v_lshrrev_b32 v2, 1, v1
    v_lshlrev_b32 v145, 7, v2
    v_add_u32 v2, 0, v1
    v_mul_u32_u24 v3, 6554, v2
    v_lshrrev_b32 v3, 16, v3
    v_mul_u32_u24 v14, 1120, v3
    v_lshl_add_u32 v116, v2, 4, v14
    v_add_u32 v14, v2, v3
    v_lshl_add_u32 v142, v14, 4, s3
    v_add_u32 v2, 64, v1
    v_mul_u32_u24 v3, 6554, v2
    v_lshrrev_b32 v3, 16, v3
    v_mul_u32_u24 v14, 1120, v3
    v_lshl_add_u32 v117, v2, 4, v14
    v_add_u32 v14, v2, v3
    v_lshl_add_u32 v143, v14, 4, s3
    v_add_u32 v2, 128, v1
    v_mul_u32_u24 v3, 6554, v2
    v_lshrrev_b32 v3, 16, v3
    v_mul_u32_u24 v14, 1120, v3
    v_lshl_add_u32 v118, v2, 4, v14
    v_add_u32 v14, v2, v3
    v_lshl_add_u32 v144, v14, 4, s3
    v_add_u32 v2, 192, v1
    v_mul_u32_u24 v3, 6554, v2
    v_lshrrev_b32 v3, 16, v3
    v_mul_u32_u24 v14, 1120, v3
    v_lshl_add_u32 v119, v2, 4, v14
    v_add_u32 v2, 256, v1
    v_mul_u32_u24 v3, 6554, v2
    v_lshrrev_b32 v3, 16, v3
    v_mul_u32_u24 v14, 1120, v3
    s_waitcnt vmcnt(12)
    s_barrier
    s_lshl_b32 s101, s100, 7
    s_add_u32 m0, s98, 24576
    s_add_u32 s101, s101, s96
    buffer_load_dwordx4 v8, s[8:11], s101 offen offset:0  lds
    buffer_load_dwordx4 v9, s[8:11], s101 offen offset:1024  lds
    s_mul_i32 s34, s100, 245760
    s_add_u32 m0, s99, 32768
    s_add_u32 s34, s34, s97
    buffer_load_dwordx4 v16, s[12:15], s34 offen offset:0  lds
    buffer_load_dwordx4 v17, s[12:15], s34 offen offset:1024  lds
    buffer_load_dwordx4 v18, s[12:15], s34 offen offset:2048  lds
    buffer_load_dwordx4 v19, s[12:15], s34 offen offset:3072  lds
    s_add_u32 s100, s100, 1
    s_cmp_eq_u32 s100, 10
    s_cselect_b32 s100, 0, s100
    v_lshl_add_u32 v120, v2, 4, v14
    s_mul_i32 s30, s17, 20
    s_add_u32 s31, s30, 19
    s_lshr_b32 s30, s30, 7
    s_lshr_b32 s31, s31, 7
    s_sub_u32 s31, s31, s30
    v_and_b32 v2, 1, v1
    v_mul_u32_u24 v2, s31, v2
    v_add_u32 v2, s30, v2
    v_lshrrev_b32 v14, 5, v1
    v_mul_u32_u24 v3, 5, v14
    v_add3_u32 v3, v2, v3, 5
    v_bfe_u32 v15, v1, 1, 4
    v_lshl_add_u32 v3, v3, 4, v15
    v_lshlrev_b32 v124, 7, v3
    v_bfe_u32 v2, v1, 4, 1
    v_mul_u32_u24 v2, s31, v2
    v_add_u32 v2, s30, v2
    s_lshr_b32 s3, s2, 5
    s_lshl_b32 s3, s3, 1
    v_lshl_add_u32 v2, v2, 4, v14
    v_add_u32 v2, s3, v2
    v_lshlrev_b32 v125, 7, v2
    s_mov_b32 s33, 10518528
    v_mov_b64 v[146:147], 0
    v_mov_b64 v[148:149], 0
    v_mov_b64 v[150:151], 0
    v_mov_b64 v[152:153], 0
    v_mov_b64 v[154:155], 0
    v_mov_b64 v[156:157], 0
    v_mov_b64 v[158:159], 0
    v_mov_b64 v[160:161], 0
    v_mov_b64 v[162:163], 0
    v_mov_b64 v[164:165], 0
    v_mov_b64 v[166:167], 0
    v_mov_b64 v[168:169], 0
    v_mov_b64 v[170:171], 0
    v_mov_b64 v[172:173], 0
    v_mov_b64 v[174:175], 0
    v_mov_b64 v[176:177], 0
    s_waitcnt vmcnt(12)
    s_barrier
    s_lshl_b32 s101, s100, 7
    s_add_u32 m0, s98, 49152
    s_add_u32 s101, s101, s96
    buffer_load_dwordx4 v8, s[8:11], s101 offen offset:0  lds
    buffer_load_dwordx4 v9, s[8:11], s101 offen offset:1024  lds
    s_mul_i32 s34, s100, 245760
    s_add_u32 m0, s99, 57344
    s_add_u32 s34, s34, s97
    buffer_load_dwordx4 v16, s[12:15], s34 offen offset:0  lds
    buffer_load_dwordx4 v17, s[12:15], s34 offen offset:1024  lds
    buffer_load_dwordx4 v18, s[12:15], s34 offen offset:2048  lds
    buffer_load_dwordx4 v19, s[12:15], s34 offen offset:3072  lds
    s_add_u32 s100, s100, 1
    s_cmp_eq_u32 s100, 10
    s_cselect_b32 s100, 0, s100
    s_waitcnt vmcnt(12)
    s_barrier
    s_lshl_b32 s101, s100, 7
    s_add_u32 m0, s98, 139264
    s_add_u32 s101, s101, s96
    buffer_load_dwordx4 v8, s[8:11], s101 offen offset:0  lds
    buffer_load_dwordx4 v9, s[8:11], s101 offen offset:1024  lds
    s_mul_i32 s34, s100, 245760
    s_add_u32 m0, s99, 147456
    s_add_u32 s34, s34, s97
    buffer_load_dwordx4 v16, s[12:15], s34 offen offset:0  lds
    buffer_load_dwordx4 v17, s[12:15], s34 offen offset:1024  lds
    buffer_load_dwordx4 v18, s[12:15], s34 offen offset:2048  lds
    buffer_load_dwordx4 v19, s[12:15], s34 offen offset:3072  lds
    s_add_u32 s100, s100, 1
    s_cmp_eq_u32 s100, 10
    s_cselect_b32 s100, 0, s100
    s_waitcnt vmcnt(12)
    s_barrier
    s_add_u32 s96, s96, 81920
    s_lshl_b32 s101, s100, 7
    s_add_u32 m0, s98, 81920
    s_add_u32 s101, s101, s96
    buffer_load_dwordx4 v8, s[8:11], s101 offen offset:0  lds
    buffer_load_dwordx4 v9, s[8:11], s101 offen offset:1024  lds
    s_add_u32 s100, s100, 1
    s_cmp_eq_u32 s100, 10
    s_cselect_b32 s100, 0, s100
    s_lshl_b32 s101, s100, 7
    s_add_u32 m0, s98, 90112
    s_add_u32 s101, s101, s96
    buffer_load_dwordx4 v8, s[8:11], s101 offen offset:0  lds
    buffer_load_dwordx4 v9, s[8:11], s101 offen offset:1024  lds
    s_add_u32 s100, s100, 1
    s_cmp_eq_u32 s100, 10
    s_cselect_b32 s100, 0, s100
    s_lshl_b32 s101, s100, 7
    s_add_u32 m0, s98, 98304
    s_add_u32 s101, s101, s96
    buffer_load_dwordx4 v8, s[8:11], s101 offen offset:0  lds
    buffer_load_dwordx4 v9, s[8:11], s101 offen offset:1024  lds
    s_add_u32 s100, s100, 1
    s_cmp_eq_u32 s100, 10
    s_cselect_b32 s100, 0, s100
    s_waitcnt vmcnt(12)
    s_barrier
    s_lshl_b32 s101, s100, 7
    s_add_u32 m0, s98, 106496
    s_add_u32 s101, s101, s96
    buffer_load_dwordx4 v8, s[8:11], s101 offen offset:0  lds
    buffer_load_dwordx4 v9, s[8:11], s101 offen offset:1024  lds
    s_add_u32 s100, s100, 1
    s_cmp_eq_u32 s100, 10
    s_cselect_b32 s100, 0, s100
    s_lshl_b32 s101, s100, 7
    s_add_u32 m0, s98, 114688
    s_add_u32 s101, s101, s96
    buffer_load_dwordx4 v8, s[8:11], s101 offen offset:0  lds
    buffer_load_dwordx4 v9, s[8:11], s101 offen offset:1024  lds
    s_add_u32 s100, s100, 1
    s_cmp_eq_u32 s100, 10
    s_cselect_b32 s100, 0, s100
    s_lshl_b32 s101, s100, 7
    s_add_u32 m0, s98, 122880
    s_add_u32 s101, s101, s96
    buffer_load_dwordx4 v8, s[8:11], s101 offen offset:0  lds
    buffer_load_dwordx4 v9, s[8:11], s101 offen offset:1024  lds
    s_add_u32 s100, s100, 1
    s_cmp_eq_u32 s100, 10
    s_cselect_b32 s100, 0, s100
    s_waitcnt vmcnt(12)
    s_barrier
    buffer_load_dword v5, v10, s[56:59], 0 offen sc1
    s_waitcnt vmcnt(7)
    s_barrier
    v_mov_b32 v11, 81904
    v_mov_b32 v7, 0
    ds_write_b32 v11, v7
    s_waitcnt vmcnt(0)
    v_cmp_ne_u32 vcc, 0, v5
    s_waitcnt lgkmcnt(0)
    s_cmp_eq_u64 vcc, -1
    s_cbranch_scc1 L_rdy_l_ok
    s_mov_b32 s35, 0
L_rdy_l:
    buffer_load_dword v5, v10, s[56:59], 0 offen sc1
    s_waitcnt vmcnt(0)
    v_cmp_ne_u32 vcc, 0, v5
    s_nop 0
    s_cmp_eq_u64 vcc, -1
    s_cselect_b32 s35, 262144, s35
    s_add_u32 s35, s35, 1
    s_cmp_lt_u32 s35, 262144
    s_cbranch_scc1 L_rdy_l
L_rdy_l_ok:
    s_barrier
    s_cmp_eq_u32 s16, 4
    s_cbranch_scc0 L_ld_nofl
    s_add_u32 s6, s42, s60
    s_addc_u32 s7, s43, 0
    s_mov_b32 s5, 1
    s_atomic_add s5, s[6:7], 0x0 glc
L_ld_nofl:
    s_lshl_b32 s101, s100, 7
    s_add_u32 m0, s98, 131072
    s_add_u32 s101, s101, s96
    buffer_load_dwordx4 v8, s[8:11], s101 offen offset:0  lds
    buffer_load_dwordx4 v9, s[8:11], s101 offen offset:1024  lds
    s_add_u32 s100, s100, 1
    s_cmp_eq_u32 s100, 10
    s_cselect_b32 s100, 0, s100
    s_lshl_b32 s101, s100, 7
    s_add_u32 m0, s98, 139264
    s_add_u32 s101, s101, s96
    buffer_load_dwordx4 v8, s[8:11], s101 offen offset:0  lds
    buffer_load_dwordx4 v9, s[8:11], s101 offen offset:1024  lds
    s_add_u32 s100, s100, 1
    s_cmp_eq_u32 s100, 10
    s_cselect_b32 s100, 0, s100
    s_lshl_b32 s101, s100, 7
    s_add_u32 m0, s98, 147456
    s_add_u32 s101, s101, s96
    buffer_load_dwordx4 v8, s[8:11], s101 offen offset:0  lds
    buffer_load_dwordx4 v9, s[8:11], s101 offen offset:1024  lds
    s_add_u32 s100, s100, 1
    s_cmp_eq_u32 s100, 10
    s_cselect_b32 s100, 0, s100
    s_lshl_b32 s101, s100, 7
    s_add_u32 m0, s98, 155648
    s_add_u32 s101, s101, s96
    buffer_load_dwordx4 v8, s[8:11], s101 offen offset:0  lds
    buffer_load_dwordx4 v9, s[8:11], s101 offen offset:1024  lds
    s_cmp_eq_u32 s16, 5
    s_cbranch_scc0 L_ld_nt
    v_min_u32 v2, 39, v1
    v_cmp_lt_u32 vcc, 19, v2
    s_lshr_b32 s3, s2, 5
    s_and_b32 s3, s3, 3
    s_mul_i32 s3, s3, 5120
    s_add_u32 s3, s3, s21
    s_mov_b32 s34, s26
    v_add_u32 v4, 20, v2
    v_cndmask_b32 v4, v2, v4, vcc
    v_lshlrev_b32 v4, 7, v4
    v_lshlrev_b32 v6, 7, v2
    s_mov_b32 s35, 0
    v_mov_b32 v7, 1
    s_waitcnt vmcnt(0)
    s_barrier
    buffer_load_dword v5, v124, s[44:47], s33 offen sc1
    buffer_load_dword v3, v125, s[44:47], s33 offen sc1
    buffer_load_dword v34, v6, s[44:47], s3 offen sc1
    buffer_load_dword v35, v4, s[44:47], s34 offen sc1
    s_branch L_poll1e_first
L_ld_nt:
    s_waitcnt vmcnt(0)
    s_barrier
    s_branch L_early
L_idle:
    s_lshl_b32 s19, s18, 2
    s_lshl_b32 s17, s18, 13
    s_add_u32 s17, s17, 10485760
    s_lshl_b32 s20, s18, 4
    s_add_u32 s20, s20, s16
    s_mul_i32 s23, s20, 10240
    s_add_u32 s20, s23, 81920
    s_add_u32 s21, s20, 8192
    v_lshlrev_b32 v2, 7, v1
    v_min_u32 v3, 1920, v2
    v_mov_b32 v4, 0
    v_and_b32 v10, 15, v1
    v_lshlrev_b32 v10, 2, v10
    v_mov_b32 v11, 81904
    ds_write_b32 v11, v4
    s_and_b32 s24, s2, 7
    s_lshl_b32 s24, s24, 2
    s_lshr_b32 s24, 558056208, s24
    s_and_b32 s24, s24, 15
    s_lshl_b32 s25, s3, 2
    s_and_b32 s26, s16, 3
    s_add_u32 s25, s25, s26
    s_mul_i32 s25, s25, 15360
    s_lshr_b32 s26, s16, 2
    s_mul_i32 s26, s26, 5
    s_add_u32 s24, s24, s26
    s_lshl_b32 s22, s18, 3
    s_and_b32 s26, s16, 3
    s_add_u32 s22, s22, s26
    s_mul_i32 s22, s22, 20480
    v_lshrrev_b32 v5, 4, v1
    v_mul_u32_u24 v5, 3840, v5
    v_and_b32 v6, 15, v1
    v_min_u32 v8, 13, v6
    v_lshl_add_u32 v8, v8, 7, v5
    v_min_u32 v9, 15, v1
    v_mul_u32_u24 v9, 1280, v9
    s_waitcnt lgkmcnt(0)
    s_mov_b32 s44, s42
    s_mov_b32 s45, s43
    s_mov_b32 s46, 10616832
    s_mov_b32 s47, 0x00020000
    s_mov_b32 s48, s36
    s_mov_b32 s49, s37
    s_mov_b32 s50, 819200
    s_mov_b32 s51, 0x00020000
    s_mov_b32 s52, s38
    s_mov_b32 s53, s39
    s_mov_b32 s54, 2621440
    s_mov_b32 s55, 0x00020000
    s_mov_b32 s56, s40
    s_mov_b32 s57, s41
    s_mov_b32 s58, 256
    s_mov_b32 s59, 0x00020000
    s_mov_b32 s8, s4
    s_mov_b32 s9, s5
    s_mov_b32 s10, 2621440
    s_mov_b32 s11, 0x00020000
    s_mov_b32 s12, s6
    s_mov_b32 s13, s7
    s_mov_b32 s14, 2457600
    s_mov_b32 s15, 0x00020000
    s_cmp_eq_u32 s16, 0
    s_cbranch_scc0 L_idle_pf
    buffer_store_dword v4, v2, s[44:47], s17 offen sc1
L_idle_pf:
    s_add_u32 s26, s24, 4
    s_sub_u32 s27, s26, 10
    s_cselect_b32 s26, s26, s27
    s_mul_i32 s27, s26, 245760
    s_add_u32 s27, s27, s25
    s_lshl_b32 s26, s26, 7
    s_add_u32 s26, s26, s22
    buffer_load_dword v94, v8, s[12:15], s27 offen
    buffer_load_dword v95, v9, s[8:11], s26 offen
    s_cmp_eq_u32 s16, 0
    s_cbranch_scc0 L_idle_pf2
    v_mov_b32 v6, 1
    s_waitcnt vmcnt(2)
    s_mov_b64 exec, 1
    buffer_store_dword v6, v4, s[56:59], s19 offen sc1
    s_mov_b64 exec, -1
L_idle_pf2:
    s_barrier
    buffer_load_dword v90, v2, s[8:11], s20 offen
    buffer_load_dword v92, v3, s[8:11], s21 offen
    s_cmp_eq_u32 s16, 0
    s_cbranch_scc0 L_rdy_i_ok
    s_mov_b32 s35, 0
L_rdy_i:
    buffer_load_dword v5, v10, s[56:59], 0 offen sc1
    s_waitcnt vmcnt(0)
    v_cmp_ne_u32 vcc, 0, v5
    s_nop 0
    s_cmp_eq_u64 vcc, -1
    s_cselect_b32 s35, 262144, s35
    s_add_u32 s35, s35, 1
    s_cmp_lt_u32 s35, 262144
    s_cbranch_scc1 L_rdy_i
L_rdy_i_ok:
    s_waitcnt vmcnt(0)
    s_barrier
    s_mov_b32 s63, 0
    s_cmp_lt_u32 s16, 4
    s_cbranch_scc1 L_late_setup
    s_and_b32 s17, s2, 7
    s_lshl_b32 s17, s17, 2
    s_lshr_b32 s17, 0x75643120, s17
    s_and_b32 s17, s17, 7
    s_lshl_b32 s17, s17, 2
    s_bfe_u32 s3, s2, 0x20003
    s_add_u32 s17, s17, s3
    s_lshr_b32 s29, s2, 5
    s_lshl_b32 s18, s29, 2
    s_and_b32 s3, s16, 2
    s_add_u32 s18, s18, s3
    s_add_u32 s18, s18, 0
    s_and_b32 s19, s16, 1
    s_mul_i32 s20, s19, 5120
    v_and_b32 v2, 31, v1
    v_lshrrev_b32 v3, 5, v1
    v_lshlrev_b32 v14, 3, v2
    v_lshl_add_u32 v122, v3, 9, v14
    v_add_u32 v133, s20, v122
    v_add_u32 v134, 256, v133
    v_lshlrev_b32 v14, 3, v1
    v_add_u32 v135, s20, v14
    s_lshl_b32 s3, s19, 8
    v_xor_b32 v123, s3, v14
    v_mul_u32_u24 v15, 320, v3
    v_lshl_add_u32 v15, v2, 4, v15
    s_add_u32 s3, s20, 2560
    v_add_u32 v136, s3, v15
    v_add_u32 v137, 40960, v136
    v_lshlrev_b32 v121, 4, v1
    v_mov_b32 v132, 0xdddddddd
    s_mov_b32 s24, 0x000fffff
    s_mov_b32 s25, 0x000fffff
    v_cmp_eq_u32 vcc, 20, v2
    v_mov_b32 v15, 0x3f803f80
    s_mul_i32 s21, s17, 163840
    v_cndmask_b32 v96, 0, v15, vcc
    s_add_u32 s21, s21, 2621440
    v_mov_b32 v97, v96
    v_mov_b64 v[98:99], v[96:97]
    v_mov_b64 v[100:101], v[96:97]
    v_mov_b64 v[102:103], v[96:97]
    v_mov_b64 v[104:105], v[96:97]
    v_mov_b64 v[106:107], v[96:97]
    v_mov_b64 v[108:109], v[96:97]
    v_mov_b64 v[110:111], v[96:97]
    s_mul_i32 s26, s18, 2560
    s_mul_i32 s3, s17, 81920
    s_add_u32 s26, s26, s3
    s_lshl_b32 s3, s19, 8
    s_add_u32 s22, s26, s3
    s_xor_b32 s3, s3, 256
    s_add_u32 s23, s26, s3
    s_and_b32 s28, s16, 3
    s_mul_i32 s27, s29, 0
    s_add_u32 s27, s27, s28
    s_mul_i32 s28, s28, 5120
    s_add_u32 s28, s28, 0
    s_add_u32 s61, s21, 0
    s_lshl_b32 s30, s18, 1
    s_xor_b32 s31, s19, 1
    s_add_u32 s30, s30, s31
    s_mul_i32 s37, s30, 40960
    s_add_u32 s37, s37, 7864320
    s_lshl_b32 s36, s17, 9
    s_add_u32 s36, s36, s37
    s_lshl_b32 s3, s17, 7
    s_add_u32 s37, s37, s3
    s_add_u32 s37, s37, 16384
    s_lshr_b32 s38, s2, 5
    s_lshl_b32 s38, s38, 12
    s_add_u32 s38, s38, s3
    s_add_u32 s38, s38, 10551296
    s_add_u32 s39, s38, 32768
    v_bfe_u32 v2, v1, 4, 1
    v_mul_u32_u24 v2, 20480, v2
    v_and_b32 v3, 15, v1
    v_lshl_add_u32 v127, v3, 3, v2
    v_lshl_add_u32 v2, v3, 4, v2
    v_lshrrev_b32 v3, 5, v1
    v_lshl_add_u32 v126, v3, 8, v2
    s_mul_i32 s3, s16, 3072
    s_add_u32 s3, s3, 102400
    v_add_u32 v128, s3, v121
    s_xor_b32 s3, s16, 1
    s_mul_i32 s3, s3, 3072
    s_add_u32 s3, s3, 102400
    v_add_u32 v129, s3, v121
    v_mov_b64 v[112:113], -1
    v_mov_b64 v[114:115], -1
    v_mov_b32 v130, 1
    v_mov_b32 v131, 0
    s_lshr_b32 s30, s16, 2
    s_and_b32 s31, s16, 3
    s_mul_i32 s3, s30, 51200
    v_lshrrev_b32 v2, 5, v1
    v_bfe_u32 v3, v1, 4, 1
    v_bfe_u32 v14, v1, 2, 2
    v_mul_u32_u24 v15, 20, v2
    v_lshl_add_u32 v15, v3, 2, v15
    v_add_u32 v15, v15, v14
    v_mul_u32_u24 v15, 160, v15
    v_and_b32 v2, 3, v1
    v_lshl_add_u32 v2, v2, 3, s3
    v_add_u32 v138, v15, v2
    v_lshrrev_b32 v3, 4, v1
    v_mul_u32_u24 v15, 20, v3
    v_add3_u32 v15, v15, 16, v14
    v_mul_u32_u24 v15, 160, v15
    v_add_u32 v139, v15, v2
    s_mul_i32 s3, s31, 5120
    s_add_u32 s3, s3, 143360
    v_add_u32 v140, s3, v121
    s_mul_i32 s3, s31, 3584
    s_add_u32 s3, s3, 102400
    v_and_b32 v2, 15, v1
    v_mul_u32_u24 v2, 176, v2
    v_lshl_add_u32 v2, v3, 3, v2
    v_add_u32 v141, s3, v2
    s_and_b32 s40, s2, 7
    s_lshl_b32 s41, s40, 2
    s_bfe_u32 s30, s2, 0x20003
    s_add_u32 s41, s41, s30
    s_lshl_b32 s40, s40, 12
    s_add_u32 s40, s40, 10551296
    s_lshl_b32 s41, s41, 2
    s_add_u32 s41, s41, s31
    s_mul_i32 s41, s41, 20480
    v_lshrrev_b32 v2, 1, v1
    v_lshlrev_b32 v145, 7, v2
    v_add_u32 v2, 0, v1
    v_mul_u32_u24 v3, 6554, v2
    v_lshrrev_b32 v3, 16, v3
    v_mul_u32_u24 v14, 1120, v3
    v_lshl_add_u32 v116, v2, 4, v14
    v_add_u32 v14, v2, v3
    v_lshl_add_u32 v142, v14, 4, s3
    v_add_u32 v2, 64, v1
    v_mul_u32_u24 v3, 6554, v2
    v_lshrrev_b32 v3, 16, v3
    v_mul_u32_u24 v14, 1120, v3
    v_lshl_add_u32 v117, v2, 4, v14
    v_add_u32 v14, v2, v3
    v_lshl_add_u32 v143, v14, 4, s3
    v_add_u32 v2, 128, v1
    v_mul_u32_u24 v3, 6554, v2
    v_lshrrev_b32 v3, 16, v3
    v_mul_u32_u24 v14, 1120, v3
    v_lshl_add_u32 v118, v2, 4, v14
    v_add_u32 v14, v2, v3
    v_lshl_add_u32 v144, v14, 4, s3
    v_add_u32 v2, 192, v1
    v_mul_u32_u24 v3, 6554, v2
    v_lshrrev_b32 v3, 16, v3
    v_mul_u32_u24 v14, 1120, v3
    v_lshl_add_u32 v119, v2, 4, v14
    v_add_u32 v2, 256, v1
    v_mul_u32_u24 v3, 6554, v2
    v_lshrrev_b32 v3, 16, v3
    v_mul_u32_u24 v14, 1120, v3
    v_lshl_add_u32 v120, v2, 4, v14
    s_mul_i32 s30, s17, 20
    s_add_u32 s31, s30, 19
    s_lshr_b32 s30, s30, 7
    s_lshr_b32 s31, s31, 7
    s_sub_u32 s31, s31, s30
    v_and_b32 v2, 1, v1
    v_mul_u32_u24 v2, s31, v2
    v_add_u32 v2, s30, v2
    v_lshrrev_b32 v14, 5, v1
    v_mul_u32_u24 v3, 5, v14
    v_add3_u32 v3, v2, v3, 5
    v_bfe_u32 v15, v1, 1, 4
    v_lshl_add_u32 v3, v3, 4, v15
    v_lshlrev_b32 v124, 7, v3
    v_bfe_u32 v2, v1, 4, 1
    v_mul_u32_u24 v2, s31, v2
    v_add_u32 v2, s30, v2
    s_lshr_b32 s3, s2, 5
    s_lshl_b32 s3, s3, 1
    v_lshl_add_u32 v2, v2, 4, v14
    v_add_u32 v2, s3, v2
    v_lshlrev_b32 v125, 7, v2
    s_mov_b32 s33, 10518528
    v_mov_b64 v[146:147], 0
    v_mov_b64 v[148:149], 0
    v_mov_b64 v[150:151], 0
    v_mov_b64 v[152:153], 0
    v_mov_b64 v[154:155], 0
    v_mov_b64 v[156:157], 0
    v_mov_b64 v[158:159], 0
    v_mov_b64 v[160:161], 0
    v_mov_b64 v[162:163], 0
    v_mov_b64 v[164:165], 0
    v_mov_b64 v[166:167], 0
    v_mov_b64 v[168:169], 0
    v_mov_b64 v[170:171], 0
    v_mov_b64 v[172:173], 0
    v_mov_b64 v[174:175], 0
    v_mov_b64 v[176:177], 0
    s_branch L_early
L_late_setup:
    s_and_b32 s17, s2, 7
    s_lshl_b32 s17, s17, 2
    s_lshr_b32 s17, 0x75643120, s17
    s_and_b32 s17, s17, 7
    s_lshl_b32 s17, s17, 2
    s_bfe_u32 s3, s2, 0x20003
    s_add_u32 s17, s17, s3
    s_lshr_b32 s29, s2, 5
    s_lshl_b32 s18, s29, 2
    s_and_b32 s3, s16, 2
    s_add_u32 s18, s18, s3
    s_add_u32 s18, s18, 1
    s_and_b32 s19, s16, 1
    s_mul_i32 s20, s19, 5120
    v_and_b32 v2, 31, v1
    v_lshrrev_b32 v3, 5, v1
    v_lshlrev_b32 v14, 3, v2
    v_lshl_add_u32 v122, v3, 9, v14
    v_add_u32 v133, s20, v122
    v_add_u32 v134, 256, v133
    v_lshlrev_b32 v14, 3, v1
    v_add_u32 v135, s20, v14
    s_lshl_b32 s3, s19, 8
    v_xor_b32 v123, s3, v14
    v_mul_u32_u24 v15, 320, v3
    v_lshl_add_u32 v15, v2, 4, v15
    s_add_u32 s3, s20, 2560
    v_add_u32 v136, s3, v15
    v_add_u32 v137, 40960, v136
    v_lshlrev_b32 v121, 4, v1
    v_mov_b32 v132, 0xdddddddd
    s_mov_b32 s24, 0x000fffff
    s_mov_b32 s25, 0x000fffff
    v_cmp_eq_u32 vcc, 20, v2
    v_mov_b32 v15, 0x3f803f80
    s_mul_i32 s21, s17, 163840
    v_cndmask_b32 v96, 0, v15, vcc
    s_add_u32 s21, s21, 2621440
    v_mov_b32 v97, v96
    v_mov_b64 v[98:99], v[96:97]
    v_mov_b64 v[100:101], v[96:97]
    v_mov_b64 v[102:103], v[96:97]
    v_mov_b64 v[104:105], v[96:97]
    v_mov_b64 v[106:107], v[96:97]
    v_mov_b64 v[108:109], v[96:97]
    v_mov_b64 v[110:111], v[96:97]
    s_mul_i32 s26, s18, 2560
    s_mul_i32 s3, s17, 81920
    s_add_u32 s26, s26, s3
    s_lshl_b32 s3, s19, 8
    s_add_u32 s22, s26, s3
    s_xor_b32 s3, s3, 256
    s_add_u32 s23, s26, s3
    s_and_b32 s28, s16, 3
    s_mul_i32 s27, s29, 0
    s_add_u32 s27, s27, s28
    s_mul_i32 s28, s28, 5120
    s_add_u32 s28, s28, 81920
    s_add_u32 s61, s21, 81920
    s_lshl_b32 s30, s18, 1
    s_xor_b32 s31, s19, 1
    s_add_u32 s30, s30, s31
    s_mul_i32 s37, s30, 40960
    s_add_u32 s37, s37, 7864320
    s_lshl_b32 s36, s17, 9
    s_add_u32 s36, s36, s37
    s_lshl_b32 s3, s17, 7
    s_add_u32 s37, s37, s3
    s_add_u32 s37, s37, 16384
    s_lshr_b32 s38, s2, 5
    s_lshl_b32 s38, s38, 12
    s_add_u32 s38, s38, s3
    s_add_u32 s38, s38, 10551296
    s_add_u32 s39, s38, 32768
    v_bfe_u32 v2, v1, 4, 1
    v_mul_u32_u24 v2, 20480, v2
    v_and_b32 v3, 15, v1
    v_lshl_add_u32 v127, v3, 3, v2
    v_lshl_add_u32 v2, v3, 4, v2
    v_lshrrev_b32 v3, 5, v1
    v_lshl_add_u32 v126, v3, 8, v2
    s_mul_i32 s3, s16, 3072
    s_add_u32 s3, s3, 102400
    v_add_u32 v128, s3, v121
    s_xor_b32 s3, s16, 1
    s_mul_i32 s3, s3, 3072
    s_add_u32 s3, s3, 102400
    v_add_u32 v129, s3, v121
    v_mov_b64 v[112:113], -1
    v_mov_b64 v[114:115], -1
    v_mov_b32 v130, 1
    v_mov_b32 v131, 0
    s_lshr_b32 s30, s16, 2
    s_and_b32 s31, s16, 3
    s_mul_i32 s3, s30, 51200
    v_lshrrev_b32 v2, 5, v1
    v_bfe_u32 v3, v1, 4, 1
    v_bfe_u32 v14, v1, 2, 2
    v_mul_u32_u24 v15, 20, v2
    v_lshl_add_u32 v15, v3, 2, v15
    v_add_u32 v15, v15, v14
    v_mul_u32_u24 v15, 160, v15
    v_and_b32 v2, 3, v1
    v_lshl_add_u32 v2, v2, 3, s3
    v_add_u32 v138, v15, v2
    v_lshrrev_b32 v3, 4, v1
    v_mul_u32_u24 v15, 20, v3
    v_add3_u32 v15, v15, 16, v14
    v_mul_u32_u24 v15, 160, v15
    v_add_u32 v139, v15, v2
    s_mul_i32 s3, s31, 5120
    s_add_u32 s3, s3, 143360
    v_add_u32 v140, s3, v121
    s_mul_i32 s3, s31, 3584
    s_add_u32 s3, s3, 102400
    v_and_b32 v2, 15, v1
    v_mul_u32_u24 v2, 176, v2
    v_lshl_add_u32 v2, v3, 3, v2
    v_add_u32 v141, s3, v2
    s_and_b32 s40, s2, 7
    s_lshl_b32 s41, s40, 2
    s_bfe_u32 s30, s2, 0x20003
    s_add_u32 s41, s41, s30
    s_lshl_b32 s40, s40, 12
    s_add_u32 s40, s40, 10551296
    s_lshl_b32 s41, s41, 2
    s_add_u32 s41, s41, s31
    s_mul_i32 s41, s41, 20480
    v_lshrrev_b32 v2, 1, v1
    v_lshlrev_b32 v145, 7, v2
    v_add_u32 v2, 0, v1
    v_mul_u32_u24 v3, 6554, v2
    v_lshrrev_b32 v3, 16, v3
    v_mul_u32_u24 v14, 1120, v3
    v_lshl_add_u32 v116, v2, 4, v14
    v_add_u32 v14, v2, v3
    v_lshl_add_u32 v142, v14, 4, s3
    v_add_u32 v2, 64, v1
    v_mul_u32_u24 v3, 6554, v2
    v_lshrrev_b32 v3, 16, v3
    v_mul_u32_u24 v14, 1120, v3
    v_lshl_add_u32 v117, v2, 4, v14
    v_add_u32 v14, v2, v3
    v_lshl_add_u32 v143, v14, 4, s3
    v_add_u32 v2, 128, v1
    v_mul_u32_u24 v3, 6554, v2
    v_lshrrev_b32 v3, 16, v3
    v_mul_u32_u24 v14, 1120, v3
    v_lshl_add_u32 v118, v2, 4, v14
    v_add_u32 v14, v2, v3
    v_lshl_add_u32 v144, v14, 4, s3
    v_add_u32 v2, 192, v1
    v_mul_u32_u24 v3, 6554, v2
    v_lshrrev_b32 v3, 16, v3
    v_mul_u32_u24 v14, 1120, v3
    v_lshl_add_u32 v119, v2, 4, v14
    v_add_u32 v2, 256, v1
    v_mul_u32_u24 v3, 6554, v2
    v_lshrrev_b32 v3, 16, v3
    v_mul_u32_u24 v14, 1120, v3
    v_lshl_add_u32 v120, v2, 4, v14
    s_mul_i32 s30, s17, 20
    s_add_u32 s31, s30, 19
    s_lshr_b32 s30, s30, 7
    s_lshr_b32 s31, s31, 7
    s_sub_u32 s31, s31, s30
    v_and_b32 v2, 1, v1
    v_mul_u32_u24 v2, s31, v2
    v_add_u32 v2, s30, v2
    v_lshrrev_b32 v14, 5, v1
    v_mul_u32_u24 v3, 5, v14
    v_add3_u32 v3, v2, v3, 5
    v_bfe_u32 v15, v1, 1, 4
    v_lshl_add_u32 v3, v3, 4, v15
    v_lshlrev_b32 v124, 7, v3
    v_bfe_u32 v2, v1, 4, 1
    v_mul_u32_u24 v2, s31, v2
    v_add_u32 v2, s30, v2
    s_lshr_b32 s3, s2, 5
    s_lshl_b32 s3, s3, 1
    v_lshl_add_u32 v2, v2, 4, v14
    v_add_u32 v2, s3, v2
    v_lshlrev_b32 v125, 7, v2
    s_mov_b32 s33, 10485760
    v_mov_b64 v[146:147], 0
    v_mov_b64 v[148:149], 0
    v_mov_b64 v[150:151], 0
    v_mov_b64 v[152:153], 0
    v_mov_b64 v[154:155], 0
    v_mov_b64 v[156:157], 0
    v_mov_b64 v[158:159], 0
    v_mov_b64 v[160:161], 0
    v_mov_b64 v[162:163], 0
    v_mov_b64 v[164:165], 0
    v_mov_b64 v[166:167], 0
    v_mov_b64 v[168:169], 0
    v_mov_b64 v[170:171], 0
    v_mov_b64 v[172:173], 0
    v_mov_b64 v[174:175], 0
    v_mov_b64 v[176:177], 0
    s_barrier
    s_branch L_late_st
.p2align 12
.fill 318, 4, 0xbf800000
L_qkv_cons:
    v_and_b32 v2, 15, v1
    v_lshrrev_b32 v3, 4, v1
    v_bfe_u32 v4, v1, 1, 3
    v_xor_b32 v4, v4, v3
    v_lshlrev_b32 v4, 4, v4
    v_lshl_add_u32 v8, v2, 7, v4
    v_xor_b32 v9, 64, v8
    v_bfe_u32 v4, v1, 2, 2
    v_lshl_add_u32 v5, v3, 3, v4
    v_and_b32 v6, 1, v3
    v_lshl_or_b32 v4, v6, 2, v4
    s_lshl_b32 s3, s16, 1
    v_xor_b32 v4, s3, v4
    v_lshlrev_b32 v4, 5, v4
    v_lshl_add_u32 v4, v5, 8, v4
    v_and_b32 v5, 3, v1
    v_lshl_add_u32 v4, v5, 3, v4
    v_add_u32 v10, 8192, v4
    v_xor_b32 v11, 32, v10
    s_lshl_b32 s60, s17, 4
    s_add_u32 s60, s60, s18
    s_lshl_b32 s60, s60, 7
    s_add_u32 s60, s60, 10485760
    s_mul_i32 s21, s18, 5120
    s_waitcnt lgkmcnt(0)
    s_mov_b32 s44, s42
    s_mov_b32 s45, s43
    s_mov_b32 s46, 10616832
    s_mov_b32 s47, 0x00020000
    s_mov_b32 s48, s36
    s_mov_b32 s49, s37
    s_mov_b32 s50, 819200
    s_mov_b32 s51, 0x00020000
    s_mov_b32 s52, s38
    s_mov_b32 s53, s39
    s_mov_b32 s54, 2621440
    s_mov_b32 s55, 0x00020000
    s_mov_b32 s56, s40
    s_mov_b32 s57, s41
    s_mov_b32 s58, 256
    s_mov_b32 s59, 0x00020000
    s_cmp_lt_u32 s17, 10
    s_cbranch_scc0 L_qkv_v
    s_cmp_lt_u32 s17, 5
    s_cselect_b32 s25, 0, 81920
    s_cselect_b32 s12, 1051011932, 1.0
    s_cselect_b32 s23, 0, 2621440
    s_cselect_b32 s3, 0, 5
    s_add_u32 s24, s25, 79360
    s_max_u32 s22, s25, 2560
    s_mov_b32 s13, s12
    s_add_u32 s21, s21, s23
    s_add_u32 s62, s22, s21
    s_sub_u32 s3, s17, s3
    s_lshl_b32 s3, s3, 2
    s_add_u32 s3, s3, s16
    s_lshl_b32 s3, s3, 3
    v_add_u32 v6, s3, v3
    v_lshlrev_b32 v4, 3, v2
    v_add_u32 v7, 0, v6
    v_mul_u32_u24 v5, 52429, v7
    v_lshrrev_b32 v5, 18, v5
    v_lshl_add_u32 v7, v7, 9, v4
    v_mad_u32_u24 v12, v5, s24, v7
    v_add_u32 v7, 4, v6
    v_mul_u32_u24 v5, 52429, v7
    v_lshrrev_b32 v5, 18, v5
    v_lshl_add_u32 v7, v7, 9, v4
    v_mad_u32_u24 v13, v5, s24, v7
    v_add_u32 v4, 81920, v8
    v_add_u32 v6, 81920, v10
    v_add_u32 v5, 81920, v9
    v_add_u32 v7, 81920, v11
    s_barrier
.p2align 3
    ds_read_b64_tr_b16 v[96:97], v10 offset:0
    ds_read_b64_tr_b16 v[98:99], v10 offset:1024
    ds_read_b128 v[16:19], v8 offset:0
    ds_read_b64_tr_b16 v[100:101], v11 offset:0
    ds_read_b64_tr_b16 v[102:103], v11 offset:1024
    ds_read_b128 v[20:23], v8 offset:2048
    ds_read_b128 v[24:27], v8 offset:4096
    ds_read_b128 v[28:31], v8 offset:6144
    s_waitcnt lgkmcnt(0)
    s_nop 0
    v_mfma_f32_16x16x32_bf16 v[48:51], v[96:99], v[16:19], 0
    ds_read_b64_tr_b16 v[104:105], v10 offset:8192
    ds_read_b64_tr_b16 v[106:107], v10 offset:9216
    v_mfma_f32_16x16x32_bf16 v[52:55], v[100:103], v[16:19], 0
    ds_read_b128 v[32:35], v9 offset:0
    ds_read_b64_tr_b16 v[108:109], v11 offset:8192
    v_mfma_f32_16x16x32_bf16 v[60:63], v[100:103], v[20:23], 0
    ds_read_b64_tr_b16 v[110:111], v11 offset:9216
    ds_read_b128 v[36:39], v9 offset:2048
    v_mfma_f32_16x16x32_bf16 v[56:59], v[96:99], v[20:23], 0
    ds_read_b128 v[40:43], v9 offset:4096
    ds_read_b128 v[44:47], v9 offset:6144
    v_mfma_f32_16x16x32_bf16 v[64:67], v[96:99], v[24:27], 0
    v_mfma_f32_16x16x32_bf16 v[68:71], v[100:103], v[24:27], 0
    v_mfma_f32_16x16x32_bf16 v[76:79], v[100:103], v[28:31], 0
    v_mfma_f32_16x16x32_bf16 v[72:75], v[96:99], v[28:31], 0
    s_waitcnt lgkmcnt(0)
    s_barrier
    v_mfma_f32_16x16x32_bf16 v[48:51], v[104:107], v[32:35], v[48:51]
    ds_read_b64_tr_b16 v[112:113], v10 offset:24576
    ds_read_b64_tr_b16 v[114:115], v10 offset:25600
    v_mfma_f32_16x16x32_bf16 v[52:55], v[108:111], v[32:35], v[52:55]
    ds_read_b128 v[16:19], v8 offset:24576
    ds_read_b64_tr_b16 v[116:117], v11 offset:24576
    v_mfma_f32_16x16x32_bf16 v[60:63], v[108:111], v[36:39], v[60:63]
    ds_read_b64_tr_b16 v[118:119], v11 offset:25600
    ds_read_b128 v[20:23], v8 offset:26624
    v_mfma_f32_16x16x32_bf16 v[56:59], v[104:107], v[36:39], v[56:59]
    ds_read_b128 v[24:27], v8 offset:28672
    ds_read_b128 v[28:31], v8 offset:30720
    v_mfma_f32_16x16x32_bf16 v[64:67], v[104:107], v[40:43], v[64:67]
    v_mfma_f32_16x16x32_bf16 v[68:71], v[108:111], v[40:43], v[68:71]
    v_mfma_f32_16x16x32_bf16 v[76:79], v[108:111], v[44:47], v[76:79]
    v_mfma_f32_16x16x32_bf16 v[72:75], v[104:107], v[44:47], v[72:75]
    s_waitcnt lgkmcnt(0)
    s_nop 0
    v_mfma_f32_16x16x32_bf16 v[48:51], v[112:115], v[16:19], v[48:51]
    ds_read_b64_tr_b16 v[120:121], v10 offset:32768
    ds_read_b64_tr_b16 v[122:123], v10 offset:33792
    v_mfma_f32_16x16x32_bf16 v[52:55], v[116:119], v[16:19], v[52:55]
    ds_read_b128 v[32:35], v9 offset:24576
    ds_read_b64_tr_b16 v[124:125], v11 offset:32768
    v_mfma_f32_16x16x32_bf16 v[60:63], v[116:119], v[20:23], v[60:63]
    ds_read_b64_tr_b16 v[126:127], v11 offset:33792
    ds_read_b128 v[36:39], v9 offset:26624
    v_mfma_f32_16x16x32_bf16 v[56:59], v[112:115], v[20:23], v[56:59]
    ds_read_b128 v[40:43], v9 offset:28672
    ds_read_b128 v[44:47], v9 offset:30720
    v_mfma_f32_16x16x32_bf16 v[64:67], v[112:115], v[24:27], v[64:67]
    v_mfma_f32_16x16x32_bf16 v[68:71], v[116:119], v[24:27], v[68:71]
    v_mfma_f32_16x16x32_bf16 v[76:79], v[116:119], v[28:31], v[76:79]
    v_mfma_f32_16x16x32_bf16 v[72:75], v[112:115], v[28:31], v[72:75]
    s_waitcnt lgkmcnt(0)
    s_barrier
    v_mfma_f32_16x16x32_bf16 v[48:51], v[120:123], v[32:35], v[48:51]
    ds_read_b64_tr_b16 v[128:129], v10 offset:49152
    ds_read_b64_tr_b16 v[130:131], v10 offset:50176
    v_mfma_f32_16x16x32_bf16 v[52:55], v[124:127], v[32:35], v[52:55]
    ds_read_b128 v[16:19], v8 offset:49152
    ds_read_b64_tr_b16 v[132:133], v11 offset:49152
    v_mfma_f32_16x16x32_bf16 v[60:63], v[124:127], v[36:39], v[60:63]
    ds_read_b64_tr_b16 v[134:135], v11 offset:50176
    ds_read_b128 v[20:23], v8 offset:51200
    v_mfma_f32_16x16x32_bf16 v[56:59], v[120:123], v[36:39], v[56:59]
    ds_read_b128 v[24:27], v8 offset:53248
    ds_read_b128 v[28:31], v8 offset:55296
    v_mfma_f32_16x16x32_bf16 v[64:67], v[120:123], v[40:43], v[64:67]
    v_mfma_f32_16x16x32_bf16 v[68:71], v[124:127], v[40:43], v[68:71]
    v_mfma_f32_16x16x32_bf16 v[76:79], v[124:127], v[44:47], v[76:79]
    v_mfma_f32_16x16x32_bf16 v[72:75], v[120:123], v[44:47], v[72:75]
    s_waitcnt lgkmcnt(0)
    s_nop 0
    v_mfma_f32_16x16x32_bf16 v[48:51], v[128:131], v[16:19], v[48:51]
    ds_read_b64_tr_b16 v[136:137], v10 offset:57344
    ds_read_b64_tr_b16 v[138:139], v10 offset:58368
    v_mfma_f32_16x16x32_bf16 v[52:55], v[132:135], v[16:19], v[52:55]
    ds_read_b128 v[32:35], v9 offset:49152
    ds_read_b64_tr_b16 v[140:141], v11 offset:57344
    v_mfma_f32_16x16x32_bf16 v[60:63], v[132:135], v[20:23], v[60:63]
    ds_read_b64_tr_b16 v[142:143], v11 offset:58368
    ds_read_b128 v[36:39], v9 offset:51200
    v_mfma_f32_16x16x32_bf16 v[56:59], v[128:131], v[20:23], v[56:59]
    ds_read_b128 v[40:43], v9 offset:53248
    ds_read_b128 v[44:47], v9 offset:55296
    v_mfma_f32_16x16x32_bf16 v[64:67], v[128:131], v[24:27], v[64:67]
    v_mfma_f32_16x16x32_bf16 v[68:71], v[132:135], v[24:27], v[68:71]
    v_mfma_f32_16x16x32_bf16 v[76:79], v[132:135], v[28:31], v[76:79]
    v_mfma_f32_16x16x32_bf16 v[72:75], v[128:131], v[28:31], v[72:75]
    s_waitcnt lgkmcnt(0)
    s_barrier
    v_mfma_f32_16x16x32_bf16 v[48:51], v[136:139], v[32:35], v[48:51]
    ds_read_b64_tr_b16 v[144:145], v6 offset:0
    ds_read_b64_tr_b16 v[146:147], v6 offset:1024
    v_mfma_f32_16x16x32_bf16 v[52:55], v[140:143], v[32:35], v[52:55]
    ds_read_b128 v[16:19], v4 offset:0
    ds_read_b64_tr_b16 v[148:149], v7 offset:0
    v_mfma_f32_16x16x32_bf16 v[60:63], v[140:143], v[36:39], v[60:63]
    ds_read_b64_tr_b16 v[150:151], v7 offset:1024
    ds_read_b128 v[20:23], v4 offset:2048
    v_mfma_f32_16x16x32_bf16 v[56:59], v[136:139], v[36:39], v[56:59]
    ds_read_b128 v[24:27], v4 offset:4096
    ds_read_b128 v[28:31], v4 offset:6144
    v_mfma_f32_16x16x32_bf16 v[64:67], v[136:139], v[40:43], v[64:67]
    v_mfma_f32_16x16x32_bf16 v[68:71], v[140:143], v[40:43], v[68:71]
    v_mfma_f32_16x16x32_bf16 v[76:79], v[140:143], v[44:47], v[76:79]
    v_mfma_f32_16x16x32_bf16 v[72:75], v[136:139], v[44:47], v[72:75]
    s_waitcnt lgkmcnt(0)
    s_nop 0
    v_mfma_f32_16x16x32_bf16 v[48:51], v[144:147], v[16:19], v[48:51]
    ds_read_b64_tr_b16 v[152:153], v6 offset:8192
    ds_read_b64_tr_b16 v[154:155], v6 offset:9216
    v_mfma_f32_16x16x32_bf16 v[52:55], v[148:151], v[16:19], v[52:55]
    ds_read_b128 v[32:35], v5 offset:0
    ds_read_b64_tr_b16 v[156:157], v7 offset:8192
    v_mfma_f32_16x16x32_bf16 v[60:63], v[148:151], v[20:23], v[60:63]
    ds_read_b64_tr_b16 v[158:159], v7 offset:9216
    ds_read_b128 v[36:39], v5 offset:2048
    v_mfma_f32_16x16x32_bf16 v[56:59], v[144:147], v[20:23], v[56:59]
    ds_read_b128 v[40:43], v5 offset:4096
    ds_read_b128 v[44:47], v5 offset:6144
    v_mfma_f32_16x16x32_bf16 v[64:67], v[144:147], v[24:27], v[64:67]
    v_mfma_f32_16x16x32_bf16 v[68:71], v[148:151], v[24:27], v[68:71]
    v_mfma_f32_16x16x32_bf16 v[76:79], v[148:151], v[28:31], v[76:79]
    v_mfma_f32_16x16x32_bf16 v[72:75], v[144:147], v[28:31], v[72:75]
    s_waitcnt lgkmcnt(0)
    s_barrier
    v_mfma_f32_16x16x32_bf16 v[48:51], v[152:155], v[32:35], v[48:51]
    ds_read_b64_tr_b16 v[160:161], v6 offset:24576
    ds_read_b64_tr_b16 v[162:163], v6 offset:25600
    v_mfma_f32_16x16x32_bf16 v[52:55], v[156:159], v[32:35], v[52:55]
    ds_read_b128 v[16:19], v4 offset:24576
    ds_read_b64_tr_b16 v[164:165], v7 offset:24576
    v_mfma_f32_16x16x32_bf16 v[60:63], v[156:159], v[36:39], v[60:63]
    ds_read_b64_tr_b16 v[166:167], v7 offset:25600
    ds_read_b128 v[20:23], v4 offset:26624
    v_mfma_f32_16x16x32_bf16 v[56:59], v[152:155], v[36:39], v[56:59]
    ds_read_b128 v[24:27], v4 offset:28672
    ds_read_b128 v[28:31], v4 offset:30720
    v_mfma_f32_16x16x32_bf16 v[64:67], v[152:155], v[40:43], v[64:67]
    v_mfma_f32_16x16x32_bf16 v[68:71], v[156:159], v[40:43], v[68:71]
    v_mfma_f32_16x16x32_bf16 v[76:79], v[156:159], v[44:47], v[76:79]
    v_mfma_f32_16x16x32_bf16 v[72:75], v[152:155], v[44:47], v[72:75]
    s_waitcnt lgkmcnt(0)
    s_nop 0
    v_mfma_f32_16x16x32_bf16 v[48:51], v[160:163], v[16:19], v[48:51]
    ds_read_b64_tr_b16 v[168:169], v6 offset:32768
    ds_read_b64_tr_b16 v[170:171], v6 offset:33792
    v_mfma_f32_16x16x32_bf16 v[52:55], v[164:167], v[16:19], v[52:55]
    ds_read_b128 v[32:35], v5 offset:24576
    ds_read_b64_tr_b16 v[172:173], v7 offset:32768
    v_mfma_f32_16x16x32_bf16 v[60:63], v[164:167], v[20:23], v[60:63]
    ds_read_b64_tr_b16 v[174:175], v7 offset:33792
    ds_read_b128 v[36:39], v5 offset:26624
    v_mfma_f32_16x16x32_bf16 v[56:59], v[160:163], v[20:23], v[56:59]
    ds_read_b128 v[40:43], v5 offset:28672
    ds_read_b128 v[44:47], v5 offset:30720
    v_mfma_f32_16x16x32_bf16 v[64:67], v[160:163], v[24:27], v[64:67]
    v_mfma_f32_16x16x32_bf16 v[68:71], v[164:167], v[24:27], v[68:71]
    v_mfma_f32_16x16x32_bf16 v[76:79], v[164:167], v[28:31], v[76:79]
    v_mfma_f32_16x16x32_bf16 v[72:75], v[160:163], v[28:31], v[72:75]
    s_waitcnt lgkmcnt(0)
    s_barrier
    v_mfma_f32_16x16x32_bf16 v[48:51], v[168:171], v[32:35], v[48:51]
    ds_read_b64_tr_b16 v[176:177], v6 offset:49152
    ds_read_b64_tr_b16 v[178:179], v6 offset:50176
    v_mfma_f32_16x16x32_bf16 v[52:55], v[172:175], v[32:35], v[52:55]
    ds_read_b128 v[16:19], v4 offset:49152
    ds_read_b64_tr_b16 v[180:181], v7 offset:49152
    v_mfma_f32_16x16x32_bf16 v[60:63], v[172:175], v[36:39], v[60:63]
    ds_read_b64_tr_b16 v[182:183], v7 offset:50176
    ds_read_b128 v[20:23], v4 offset:51200
    v_mfma_f32_16x16x32_bf16 v[56:59], v[168:171], v[36:39], v[56:59]
    ds_read_b128 v[24:27], v4 offset:53248
    ds_read_b128 v[28:31], v4 offset:55296
    v_mfma_f32_16x16x32_bf16 v[64:67], v[168:171], v[40:43], v[64:67]
    v_mfma_f32_16x16x32_bf16 v[68:71], v[172:175], v[40:43], v[68:71]
    v_mfma_f32_16x16x32_bf16 v[76:79], v[172:175], v[44:47], v[76:79]
    v_mfma_f32_16x16x32_bf16 v[72:75], v[168:171], v[44:47], v[72:75]
    s_waitcnt lgkmcnt(0)
    s_nop 0
    v_mfma_f32_16x16x32_bf16 v[48:51], v[176:179], v[16:19], v[48:51]
    ds_read_b64_tr_b16 v[184:185], v6 offset:57344
    ds_read_b64_tr_b16 v[186:187], v6 offset:58368
    v_mfma_f32_16x16x32_bf16 v[52:55], v[180:183], v[16:19], v[52:55]
    ds_read_b128 v[32:35], v5 offset:49152
    ds_read_b64_tr_b16 v[188:189], v7 offset:57344
    v_mfma_f32_16x16x32_bf16 v[60:63], v[180:183], v[20:23], v[60:63]
    ds_read_b64_tr_b16 v[190:191], v7 offset:58368
    ds_read_b128 v[36:39], v5 offset:51200
    v_mfma_f32_16x16x32_bf16 v[56:59], v[176:179], v[20:23], v[56:59]
    ds_read_b128 v[40:43], v5 offset:53248
    ds_read_b128 v[44:47], v5 offset:55296
    v_mfma_f32_16x16x32_bf16 v[64:67], v[176:179], v[24:27], v[64:67]
    v_mfma_f32_16x16x32_bf16 v[68:71], v[180:183], v[24:27], v[68:71]
    v_mfma_f32_16x16x32_bf16 v[76:79], v[180:183], v[28:31], v[76:79]
    v_mfma_f32_16x16x32_bf16 v[72:75], v[176:179], v[28:31], v[72:75]
    s_waitcnt lgkmcnt(0)
    s_barrier
    v_mfma_f32_16x16x32_bf16 v[48:51], v[184:187], v[32:35], v[48:51]
    ds_read_b64_tr_b16 v[192:193], v10 offset:0
    ds_read_b64_tr_b16 v[194:195], v10 offset:1024
    v_mfma_f32_16x16x32_bf16 v[52:55], v[188:191], v[32:35], v[52:55]
    ds_read_b128 v[16:19], v8 offset:0
    ds_read_b64_tr_b16 v[196:197], v11 offset:0
    v_mfma_f32_16x16x32_bf16 v[60:63], v[188:191], v[36:39], v[60:63]
    ds_read_b64_tr_b16 v[198:199], v11 offset:1024
    ds_read_b128 v[20:23], v8 offset:2048
    v_mfma_f32_16x16x32_bf16 v[56:59], v[184:187], v[36:39], v[56:59]
    ds_read_b128 v[24:27], v8 offset:4096
    ds_read_b128 v[28:31], v8 offset:6144
    v_mfma_f32_16x16x32_bf16 v[64:67], v[184:187], v[40:43], v[64:67]
    v_mfma_f32_16x16x32_bf16 v[68:71], v[188:191], v[40:43], v[68:71]
    v_mfma_f32_16x16x32_bf16 v[76:79], v[188:191], v[44:47], v[76:79]
    v_mfma_f32_16x16x32_bf16 v[72:75], v[184:187], v[44:47], v[72:75]
    s_waitcnt lgkmcnt(0)
    s_nop 0
    v_mfma_f32_16x16x32_bf16 v[48:51], v[192:195], v[16:19], v[48:51]
    ds_read_b64_tr_b16 v[200:201], v10 offset:8192
    ds_read_b64_tr_b16 v[202:203], v10 offset:9216
    v_mfma_f32_16x16x32_bf16 v[52:55], v[196:199], v[16:19], v[52:55]
    ds_read_b128 v[32:35], v9 offset:0
    ds_read_b64_tr_b16 v[204:205], v11 offset:8192
    v_mfma_f32_16x16x32_bf16 v[60:63], v[196:199], v[20:23], v[60:63]
    ds_read_b64_tr_b16 v[206:207], v11 offset:9216
    ds_read_b128 v[36:39], v9 offset:2048
    v_mfma_f32_16x16x32_bf16 v[56:59], v[192:195], v[20:23], v[56:59]
    ds_read_b128 v[40:43], v9 offset:4096
    ds_read_b128 v[44:47], v9 offset:6144
    v_mfma_f32_16x16x32_bf16 v[64:67], v[192:195], v[24:27], v[64:67]
    v_mfma_f32_16x16x32_bf16 v[68:71], v[196:199], v[24:27], v[68:71]
    v_mfma_f32_16x16x32_bf16 v[76:79], v[196:199], v[28:31], v[76:79]
    v_mfma_f32_16x16x32_bf16 v[72:75], v[192:195], v[28:31], v[72:75]
    s_waitcnt lgkmcnt(0)
    s_barrier
    v_add_u32 v6, 8192, v6
    v_add_u32 v7, 8192, v7
    v_mfma_f32_16x16x32_bf16 v[48:51], v[200:203], v[32:35], v[48:51]
    ds_read_b64_tr_b16 v[208:209], v10 offset:24576
    ds_read_b64_tr_b16 v[210:211], v10 offset:25600
    v_mfma_f32_16x16x32_bf16 v[52:55], v[204:207], v[32:35], v[52:55]
    ds_read_b128 v[16:19], v8 offset:24576
    ds_read_b64_tr_b16 v[212:213], v11 offset:24576
    v_mfma_f32_16x16x32_bf16 v[60:63], v[204:207], v[36:39], v[60:63]
    ds_read_b64_tr_b16 v[214:215], v11 offset:25600
    ds_read_b128 v[20:23], v8 offset:26624
    v_mfma_f32_16x16x32_bf16 v[56:59], v[200:203], v[36:39], v[56:59]
    ds_read_b128 v[24:27], v8 offset:28672
    ds_read_b128 v[28:31], v8 offset:30720
    v_mfma_f32_16x16x32_bf16 v[64:67], v[200:203], v[40:43], v[64:67]
    v_mfma_f32_16x16x32_bf16 v[68:71], v[204:207], v[40:43], v[68:71]
    v_mfma_f32_16x16x32_bf16 v[76:79], v[204:207], v[44:47], v[76:79]
    v_mfma_f32_16x16x32_bf16 v[72:75], v[200:203], v[44:47], v[72:75]
    s_waitcnt lgkmcnt(0)
    s_nop 0
    v_mfma_f32_16x16x32_bf16 v[48:51], v[208:211], v[16:19], v[48:51]
    ds_read_b64_tr_b16 v[216:217], v10 offset:32768
    ds_read_b64_tr_b16 v[218:219], v10 offset:33792
    v_mfma_f32_16x16x32_bf16 v[52:55], v[212:215], v[16:19], v[52:55]
    ds_read_b128 v[32:35], v9 offset:24576
    ds_read_b64_tr_b16 v[220:221], v11 offset:32768
    v_mfma_f32_16x16x32_bf16 v[60:63], v[212:215], v[20:23], v[60:63]
    ds_read_b64_tr_b16 v[222:223], v11 offset:33792
    ds_read_b128 v[36:39], v9 offset:26624
    v_mfma_f32_16x16x32_bf16 v[56:59], v[208:211], v[20:23], v[56:59]
    ds_read_b128 v[40:43], v9 offset:28672
    ds_read_b128 v[44:47], v9 offset:30720
    v_mfma_f32_16x16x32_bf16 v[64:67], v[208:211], v[24:27], v[64:67]
    v_mfma_f32_16x16x32_bf16 v[68:71], v[212:215], v[24:27], v[68:71]
    v_mfma_f32_16x16x32_bf16 v[76:79], v[212:215], v[28:31], v[76:79]
    v_mfma_f32_16x16x32_bf16 v[72:75], v[208:211], v[28:31], v[72:75]
    s_waitcnt lgkmcnt(0)
    s_barrier
    v_mfma_f32_16x16x32_bf16 v[48:51], v[216:219], v[32:35], v[48:51]
    ds_read_b64_tr_b16 v[224:225], v10 offset:49152
    ds_read_b64_tr_b16 v[226:227], v10 offset:50176
    v_mfma_f32_16x16x32_bf16 v[52:55], v[220:223], v[32:35], v[52:55]
    ds_read_b128 v[16:19], v8 offset:49152
    ds_read_b64_tr_b16 v[228:229], v11 offset:49152
    v_mfma_f32_16x16x32_bf16 v[60:63], v[220:223], v[36:39], v[60:63]
    ds_read_b64_tr_b16 v[230:231], v11 offset:50176
    ds_read_b128 v[20:23], v8 offset:51200
    v_mfma_f32_16x16x32_bf16 v[56:59], v[216:219], v[36:39], v[56:59]
    ds_read_b128 v[24:27], v8 offset:53248
    ds_read_b128 v[28:31], v8 offset:55296
    v_mfma_f32_16x16x32_bf16 v[64:67], v[216:219], v[40:43], v[64:67]
    v_mfma_f32_16x16x32_bf16 v[68:71], v[220:223], v[40:43], v[68:71]
    v_mfma_f32_16x16x32_bf16 v[76:79], v[220:223], v[44:47], v[76:79]
    v_mfma_f32_16x16x32_bf16 v[72:75], v[216:219], v[44:47], v[72:75]
    s_waitcnt lgkmcnt(0)
    s_nop 0
    v_mfma_f32_16x16x32_bf16 v[48:51], v[224:227], v[16:19], v[48:51]
    ds_read_b64_tr_b16 v[232:233], v10 offset:57344
    ds_read_b64_tr_b16 v[234:235], v10 offset:58368
    v_mfma_f32_16x16x32_bf16 v[52:55], v[228:231], v[16:19], v[52:55]
    ds_read_b128 v[32:35], v9 offset:49152
    ds_read_b64_tr_b16 v[236:237], v11 offset:57344
    v_mfma_f32_16x16x32_bf16 v[60:63], v[228:231], v[20:23], v[60:63]
    ds_read_b64_tr_b16 v[238:239], v11 offset:58368
    ds_read_b128 v[36:39], v9 offset:51200
    v_mfma_f32_16x16x32_bf16 v[56:59], v[224:227], v[20:23], v[56:59]
    ds_read_b128 v[40:43], v9 offset:53248
    ds_read_b128 v[44:47], v9 offset:55296
    v_mfma_f32_16x16x32_bf16 v[64:67], v[224:227], v[24:27], v[64:67]
    v_mfma_f32_16x16x32_bf16 v[68:71], v[228:231], v[24:27], v[68:71]
    v_mfma_f32_16x16x32_bf16 v[76:79], v[228:231], v[28:31], v[76:79]
    v_mfma_f32_16x16x32_bf16 v[72:75], v[224:227], v[28:31], v[72:75]
    s_waitcnt lgkmcnt(0)
    s_barrier
    v_mfma_f32_16x16x32_bf16 v[48:51], v[232:235], v[32:35], v[48:51]
    ds_read_b64_tr_b16 v[240:241], v6 offset:49152
    ds_read_b64_tr_b16 v[242:243], v6 offset:50176
    v_mfma_f32_16x16x32_bf16 v[52:55], v[236:239], v[32:35], v[52:55]
    ds_read_b128 v[16:19], v4 offset:57344
    ds_read_b64_tr_b16 v[244:245], v7 offset:49152
    v_mfma_f32_16x16x32_bf16 v[60:63], v[236:239], v[36:39], v[60:63]
    ds_read_b64_tr_b16 v[246:247], v7 offset:50176
    ds_read_b128 v[20:23], v4 offset:59392
    v_mfma_f32_16x16x32_bf16 v[56:59], v[232:235], v[36:39], v[56:59]
    ds_read_b128 v[24:27], v4 offset:61440
    ds_read_b128 v[28:31], v4 offset:63488
    v_mfma_f32_16x16x32_bf16 v[64:67], v[232:235], v[40:43], v[64:67]
    v_mfma_f32_16x16x32_bf16 v[68:71], v[236:239], v[40:43], v[68:71]
    v_mfma_f32_16x16x32_bf16 v[76:79], v[236:239], v[44:47], v[76:79]
    v_mfma_f32_16x16x32_bf16 v[72:75], v[232:235], v[44:47], v[72:75]
    s_waitcnt lgkmcnt(0)
    s_nop 0
    v_mfma_f32_16x16x32_bf16 v[48:51], v[240:243], v[16:19], v[48:51]
    ds_read_b64_tr_b16 v[248:249], v6 offset:57344
    ds_read_b64_tr_b16 v[250:251], v6 offset:58368
    v_mfma_f32_16x16x32_bf16 v[52:55], v[244:247], v[16:19], v[52:55]
    ds_read_b128 v[32:35], v5 offset:57344
    ds_read_b64_tr_b16 v[252:253], v7 offset:57344
    v_mfma_f32_16x16x32_bf16 v[60:63], v[244:247], v[20:23], v[60:63]
    ds_read_b64_tr_b16 v[254:255], v7 offset:58368
    ds_read_b128 v[36:39], v5 offset:59392
    v_mfma_f32_16x16x32_bf16 v[56:59], v[240:243], v[20:23], v[56:59]
    ds_read_b128 v[40:43], v5 offset:61440
    ds_read_b128 v[44:47], v5 offset:63488
    v_mfma_f32_16x16x32_bf16 v[64:67], v[240:243], v[24:27], v[64:67]
    v_mfma_f32_16x16x32_bf16 v[68:71], v[244:247], v[24:27], v[68:71]
    v_mfma_f32_16x16x32_bf16 v[76:79], v[244:247], v[28:31], v[76:79]
    v_mfma_f32_16x16x32_bf16 v[72:75], v[240:243], v[28:31], v[72:75]
    s_waitcnt lgkmcnt(0)
    s_nop 0
    v_mfma_f32_16x16x32_bf16 v[48:51], v[248:251], v[32:35], v[48:51]
    v_mfma_f32_16x16x32_bf16 v[52:55], v[252:255], v[32:35], v[52:55]
    v_mfma_f32_16x16x32_bf16 v[60:63], v[252:255], v[36:39], v[60:63]
    v_mfma_f32_16x16x32_bf16 v[56:59], v[248:251], v[36:39], v[56:59]
    v_mfma_f32_16x16x32_bf16 v[64:67], v[248:251], v[40:43], v[64:67]
    v_mfma_f32_16x16x32_bf16 v[68:71], v[252:255], v[40:43], v[68:71]
    v_mfma_f32_16x16x32_bf16 v[76:79], v[252:255], v[44:47], v[76:79]
    v_mfma_f32_16x16x32_bf16 v[72:75], v[248:251], v[44:47], v[72:75]
    v_add_u32 v8, 122880, v8
    v_add_u32 v9, 122880, v9
    v_pk_mul_f32 v[48:49], v[48:49], s[12:13]
    v_pk_mul_f32 v[50:51], v[50:51], s[12:13]
    v_cvt_pk_bf16_f32 v80, v48, v49
    v_cvt_pk_bf16_f32 v81, v50, v51
    buffer_store_dwordx2 v[80:81], v12, s[44:47], s21 offen offset:0 sc1
    v_pk_mul_f32 v[52:53], v[52:53], s[12:13]
    v_pk_mul_f32 v[54:55], v[54:55], s[12:13]
    v_cvt_pk_bf16_f32 v82, v52, v53
    v_cvt_pk_bf16_f32 v83, v54, v55
    buffer_store_dwordx2 v[82:83], v13, s[44:47], s21 offen offset:0 sc1
    v_pk_mul_f32 v[60:61], v[60:61], s[12:13]
    v_pk_mul_f32 v[62:63], v[62:63], s[12:13]
    v_cvt_pk_bf16_f32 v84, v60, v61
    v_cvt_pk_bf16_f32 v85, v62, v63
    buffer_store_dwordx2 v[84:85], v13, s[44:47], s21 offen offset:128 sc1
    v_pk_mul_f32 v[56:57], v[56:57], s[12:13]
    v_pk_mul_f32 v[58:59], v[58:59], s[12:13]
    v_cvt_pk_bf16_f32 v86, v56, v57
    v_cvt_pk_bf16_f32 v87, v58, v59
    buffer_store_dwordx2 v[86:87], v12, s[44:47], s21 offen offset:128 sc1
    v_pk_mul_f32 v[64:65], v[64:65], s[12:13]
    v_pk_mul_f32 v[66:67], v[66:67], s[12:13]
    v_cvt_pk_bf16_f32 v88, v64, v65
    v_cvt_pk_bf16_f32 v89, v66, v67
    buffer_store_dwordx2 v[88:89], v12, s[44:47], s21 offen offset:256 sc1
    v_pk_mul_f32 v[68:69], v[68:69], s[12:13]
    v_pk_mul_f32 v[70:71], v[70:71], s[12:13]
    v_cvt_pk_bf16_f32 v90, v68, v69
    v_cvt_pk_bf16_f32 v91, v70, v71
    buffer_store_dwordx2 v[90:91], v13, s[44:47], s21 offen offset:256 sc1
    v_pk_mul_f32 v[76:77], v[76:77], s[12:13]
    v_pk_mul_f32 v[78:79], v[78:79], s[12:13]
    v_cvt_pk_bf16_f32 v92, v76, v77
    v_cvt_pk_bf16_f32 v93, v78, v79
    buffer_store_dwordx2 v[92:93], v13, s[44:47], s21 offen offset:384 sc1
    v_pk_mul_f32 v[72:73], v[72:73], s[12:13]
    v_pk_mul_f32 v[74:75], v[74:75], s[12:13]
    v_cvt_pk_bf16_f32 v94, v72, v73
    v_cvt_pk_bf16_f32 v95, v74, v75
    buffer_store_dwordx2 v[94:95], v12, s[44:47], s21 offen offset:384 sc1
    s_barrier
    ds_read_b128 v[16:19], v4 offset:0
    ds_read_b128 v[20:23], v4 offset:2048
    ds_read_b128 v[24:27], v4 offset:4096
    ds_read_b128 v[28:31], v4 offset:6144
.p2align 3
    s_waitcnt lgkmcnt(0)
    s_nop 0
    v_mfma_f32_16x16x32_bf16 v[48:51], v[96:99], v[16:19], 0
    ds_read_b128 v[32:35], v5 offset:0
    v_mfma_f32_16x16x32_bf16 v[52:55], v[100:103], v[16:19], 0
    ds_read_b128 v[36:39], v5 offset:2048
    v_mfma_f32_16x16x32_bf16 v[60:63], v[100:103], v[20:23], 0
    ds_read_b128 v[40:43], v5 offset:4096
    v_mfma_f32_16x16x32_bf16 v[56:59], v[96:99], v[20:23], 0
    ds_read_b128 v[44:47], v5 offset:6144
    v_mfma_f32_16x16x32_bf16 v[64:67], v[96:99], v[24:27], 0
    v_mfma_f32_16x16x32_bf16 v[68:71], v[100:103], v[24:27], 0
    v_mfma_f32_16x16x32_bf16 v[76:79], v[100:103], v[28:31], 0
    v_mfma_f32_16x16x32_bf16 v[72:75], v[96:99], v[28:31], 0
    s_waitcnt lgkmcnt(0)
    s_nop 0
    v_mfma_f32_16x16x32_bf16 v[48:51], v[104:107], v[32:35], v[48:51]
    ds_read_b128 v[16:19], v4 offset:8192
    v_mfma_f32_16x16x32_bf16 v[52:55], v[108:111], v[32:35], v[52:55]
    ds_read_b128 v[20:23], v4 offset:10240
    v_mfma_f32_16x16x32_bf16 v[60:63], v[108:111], v[36:39], v[60:63]
    ds_read_b128 v[24:27], v4 offset:12288
    v_mfma_f32_16x16x32_bf16 v[56:59], v[104:107], v[36:39], v[56:59]
    ds_read_b128 v[28:31], v4 offset:14336
    v_mfma_f32_16x16x32_bf16 v[64:67], v[104:107], v[40:43], v[64:67]
    v_mfma_f32_16x16x32_bf16 v[68:71], v[108:111], v[40:43], v[68:71]
    v_mfma_f32_16x16x32_bf16 v[76:79], v[108:111], v[44:47], v[76:79]
    v_mfma_f32_16x16x32_bf16 v[72:75], v[104:107], v[44:47], v[72:75]
    s_waitcnt lgkmcnt(0)
    s_nop 0
    v_mfma_f32_16x16x32_bf16 v[48:51], v[112:115], v[16:19], v[48:51]
    ds_read_b128 v[32:35], v5 offset:8192
    v_mfma_f32_16x16x32_bf16 v[52:55], v[116:119], v[16:19], v[52:55]
    ds_read_b128 v[36:39], v5 offset:10240
    v_mfma_f32_16x16x32_bf16 v[60:63], v[116:119], v[20:23], v[60:63]
    ds_read_b128 v[40:43], v5 offset:12288
    v_mfma_f32_16x16x32_bf16 v[56:59], v[112:115], v[20:23], v[56:59]
    ds_read_b128 v[44:47], v5 offset:14336
    v_mfma_f32_16x16x32_bf16 v[64:67], v[112:115], v[24:27], v[64:67]
    v_mfma_f32_16x16x32_bf16 v[68:71], v[116:119], v[24:27], v[68:71]
    v_mfma_f32_16x16x32_bf16 v[76:79], v[116:119], v[28:31], v[76:79]
    v_mfma_f32_16x16x32_bf16 v[72:75], v[112:115], v[28:31], v[72:75]
    s_waitcnt lgkmcnt(0)
    s_nop 0
    v_mfma_f32_16x16x32_bf16 v[48:51], v[120:123], v[32:35], v[48:51]
    ds_read_b128 v[16:19], v4 offset:16384
    v_mfma_f32_16x16x32_bf16 v[52:55], v[124:127], v[32:35], v[52:55]
    ds_read_b128 v[20:23], v4 offset:18432
    v_mfma_f32_16x16x32_bf16 v[60:63], v[124:127], v[36:39], v[60:63]
    ds_read_b128 v[24:27], v4 offset:20480
    v_mfma_f32_16x16x32_bf16 v[56:59], v[120:123], v[36:39], v[56:59]
    ds_read_b128 v[28:31], v4 offset:22528
    v_mfma_f32_16x16x32_bf16 v[64:67], v[120:123], v[40:43], v[64:67]
    v_mfma_f32_16x16x32_bf16 v[68:71], v[124:127], v[40:43], v[68:71]
    v_mfma_f32_16x16x32_bf16 v[76:79], v[124:127], v[44:47], v[76:79]
    v_mfma_f32_16x16x32_bf16 v[72:75], v[120:123], v[44:47], v[72:75]
    s_waitcnt vmcnt(0) lgkmcnt(0)
    s_barrier
    v_mfma_f32_16x16x32_bf16 v[48:51], v[128:131], v[16:19], v[48:51]
    ds_read_b128 v[32:35], v5 offset:16384
    v_mfma_f32_16x16x32_bf16 v[52:55], v[132:135], v[16:19], v[52:55]
    ds_read_b128 v[36:39], v5 offset:18432
    v_mfma_f32_16x16x32_bf16 v[60:63], v[132:135], v[20:23], v[60:63]
    ds_read_b128 v[40:43], v5 offset:20480
    v_mfma_f32_16x16x32_bf16 v[56:59], v[128:131], v[20:23], v[56:59]
    ds_read_b128 v[44:47], v5 offset:22528
    v_mfma_f32_16x16x32_bf16 v[64:67], v[128:131], v[24:27], v[64:67]
    v_mfma_f32_16x16x32_bf16 v[68:71], v[132:135], v[24:27], v[68:71]
    v_mfma_f32_16x16x32_bf16 v[76:79], v[132:135], v[28:31], v[76:79]
    v_mfma_f32_16x16x32_bf16 v[72:75], v[128:131], v[28:31], v[72:75]
    s_waitcnt lgkmcnt(0)
    v_mfma_f32_16x16x32_bf16 v[48:51], v[136:139], v[32:35], v[48:51]
    s_and_b32 s17, s2, 7
    ds_read_b128 v[16:19], v4 offset:24576
    s_lshl_b32 s17, s17, 2
    v_mfma_f32_16x16x32_bf16 v[52:55], v[140:143], v[32:35], v[52:55]
    s_lshr_b32 s17, 0x75643120, s17
    ds_read_b128 v[20:23], v4 offset:26624
    s_and_b32 s17, s17, 7
    v_mfma_f32_16x16x32_bf16 v[60:63], v[140:143], v[36:39], v[60:63]
    s_lshl_b32 s17, s17, 2
    ds_read_b128 v[24:27], v4 offset:28672
    s_bfe_u32 s3, s2, 0x20003
    v_mfma_f32_16x16x32_bf16 v[56:59], v[136:139], v[36:39], v[56:59]
    s_add_u32 s17, s17, s3
    ds_read_b128 v[28:31], v4 offset:30720
    s_lshr_b32 s29, s2, 5
    v_mfma_f32_16x16x32_bf16 v[64:67], v[136:139], v[40:43], v[64:67]
    s_lshl_b32 s18, s29, 2
    s_and_b32 s3, s16, 2
    s_add_u32 s18, s18, s3
    v_mfma_f32_16x16x32_bf16 v[68:71], v[140:143], v[40:43], v[68:71]
    s_add_u32 s18, s18, 1
    s_and_b32 s19, s16, 1
    s_mul_i32 s20, s19, 5120
    v_mfma_f32_16x16x32_bf16 v[76:79], v[140:143], v[44:47], v[76:79]
    v_and_b32 v2, 31, v1
    v_lshrrev_b32 v3, 5, v1
    v_mfma_f32_16x16x32_bf16 v[72:75], v[136:139], v[44:47], v[72:75]
    v_lshlrev_b32 v14, 3, v2
    v_lshl_add_u32 v122, v3, 9, v14
    s_waitcnt lgkmcnt(0)
    v_mfma_f32_16x16x32_bf16 v[48:51], v[144:147], v[16:19], v[48:51]
    ds_read_b128 v[32:35], v5 offset:24576
    v_add_u32 v133, s20, v122
    v_mfma_f32_16x16x32_bf16 v[52:55], v[148:151], v[16:19], v[52:55]
    ds_read_b128 v[36:39], v5 offset:26624
    v_add_u32 v134, 256, v133
    v_mfma_f32_16x16x32_bf16 v[60:63], v[148:151], v[20:23], v[60:63]
    ds_read_b128 v[40:43], v5 offset:28672
    v_lshlrev_b32 v14, 3, v1
    v_mfma_f32_16x16x32_bf16 v[56:59], v[144:147], v[20:23], v[56:59]
    ds_read_b128 v[44:47], v5 offset:30720
    v_add_u32 v135, s20, v14
    v_mfma_f32_16x16x32_bf16 v[64:67], v[144:147], v[24:27], v[64:67]
    s_lshl_b32 s3, s19, 8
    v_xor_b32 v123, s3, v14
    v_mul_u32_u24 v15, 320, v3
    v_mfma_f32_16x16x32_bf16 v[68:71], v[148:151], v[24:27], v[68:71]
    v_lshl_add_u32 v15, v2, 4, v15
    s_add_u32 s3, s20, 2560
    v_mfma_f32_16x16x32_bf16 v[76:79], v[148:151], v[28:31], v[76:79]
    v_add_u32 v136, s3, v15
    v_add_u32 v137, 40960, v136
    v_mfma_f32_16x16x32_bf16 v[72:75], v[144:147], v[28:31], v[72:75]
    v_lshlrev_b32 v121, 4, v1
    v_mov_b32 v132, 0xdddddddd
    s_waitcnt lgkmcnt(0)
    v_mfma_f32_16x16x32_bf16 v[48:51], v[152:155], v[32:35], v[48:51]
    s_mov_b32 s24, 0x000fffff
    ds_read_b128 v[16:19], v4 offset:32768
    s_mov_b32 s25, 0x000fffff
    v_mfma_f32_16x16x32_bf16 v[52:55], v[156:159], v[32:35], v[52:55]
    ds_read_b128 v[20:23], v4 offset:34816
    v_cmp_eq_u32 vcc, 20, v2
    v_mfma_f32_16x16x32_bf16 v[60:63], v[156:159], v[36:39], v[60:63]
    ds_read_b128 v[24:27], v4 offset:36864
    v_mov_b32 v15, 0x3f803f80
    v_mfma_f32_16x16x32_bf16 v[56:59], v[152:155], v[36:39], v[56:59]
    s_mul_i32 s21, s17, 163840
    ds_read_b128 v[28:31], v4 offset:38912
    v_cndmask_b32 v96, 0, v15, vcc
    v_mfma_f32_16x16x32_bf16 v[64:67], v[152:155], v[40:43], v[64:67]
    s_add_u32 s21, s21, 2621440
    v_mov_b32 v97, v96
    v_mov_b64 v[98:99], v[96:97]
    v_mfma_f32_16x16x32_bf16 v[68:71], v[156:159], v[40:43], v[68:71]
    v_mov_b64 v[100:101], v[96:97]
    v_mov_b64 v[102:103], v[96:97]
    v_mfma_f32_16x16x32_bf16 v[76:79], v[156:159], v[44:47], v[76:79]
    v_mov_b64 v[104:105], v[96:97]
    v_mov_b64 v[106:107], v[96:97]
    v_mfma_f32_16x16x32_bf16 v[72:75], v[152:155], v[44:47], v[72:75]
    v_mov_b64 v[108:109], v[96:97]
    v_mov_b64 v[110:111], v[96:97]
    s_waitcnt lgkmcnt(0)
    v_mfma_f32_16x16x32_bf16 v[48:51], v[160:163], v[16:19], v[48:51]
    s_mul_i32 s26, s18, 2560
    ds_read_b128 v[32:35], v5 offset:32768
    s_mul_i32 s3, s17, 81920
    v_mfma_f32_16x16x32_bf16 v[52:55], v[164:167], v[16:19], v[52:55]
    s_add_u32 s26, s26, s3
    ds_read_b128 v[36:39], v5 offset:34816
    s_lshl_b32 s3, s19, 8
    v_mfma_f32_16x16x32_bf16 v[60:63], v[164:167], v[20:23], v[60:63]
    s_add_u32 s22, s26, s3
    ds_read_b128 v[40:43], v5 offset:36864
    s_xor_b32 s3, s3, 256
    v_mfma_f32_16x16x32_bf16 v[56:59], v[160:163], v[20:23], v[56:59]
    s_add_u32 s23, s26, s3
    ds_read_b128 v[44:47], v5 offset:38912
    s_and_b32 s28, s16, 3
    v_mfma_f32_16x16x32_bf16 v[64:67], v[160:163], v[24:27], v[64:67]
    s_mul_i32 s27, s29, 0
    s_add_u32 s27, s27, s28
    s_mul_i32 s28, s28, 5120
    v_mfma_f32_16x16x32_bf16 v[68:71], v[164:167], v[24:27], v[68:71]
    s_add_u32 s28, s28, 81920
    s_add_u32 s61, s21, 81920
    s_lshl_b32 s30, s18, 1
    v_mfma_f32_16x16x32_bf16 v[76:79], v[164:167], v[28:31], v[76:79]
    s_xor_b32 s31, s19, 1
    s_add_u32 s30, s30, s31
    s_mul_i32 s37, s30, 40960
    v_mfma_f32_16x16x32_bf16 v[72:75], v[160:163], v[28:31], v[72:75]
    s_add_u32 s37, s37, 7864320
    s_lshl_b32 s36, s17, 9
    s_add_u32 s36, s36, s37
    s_waitcnt lgkmcnt(0)
    v_mfma_f32_16x16x32_bf16 v[48:51], v[168:171], v[32:35], v[48:51]
    s_lshl_b32 s3, s17, 7
    ds_read_b128 v[16:19], v8 offset:0
    s_add_u32 s37, s37, s3
    v_mfma_f32_16x16x32_bf16 v[52:55], v[172:175], v[32:35], v[52:55]
    s_add_u32 s37, s37, 16384
    ds_read_b128 v[20:23], v8 offset:2048
    s_lshr_b32 s38, s2, 5
    v_mfma_f32_16x16x32_bf16 v[60:63], v[172:175], v[36:39], v[60:63]
    s_lshl_b32 s38, s38, 12
    ds_read_b128 v[24:27], v8 offset:4096
    s_add_u32 s38, s38, s3
    v_mfma_f32_16x16x32_bf16 v[56:59], v[168:171], v[36:39], v[56:59]
    s_add_u32 s38, s38, 10551296
    ds_read_b128 v[28:31], v8 offset:6144
    s_add_u32 s39, s38, 32768
    v_mfma_f32_16x16x32_bf16 v[64:67], v[168:171], v[40:43], v[64:67]
    v_bfe_u32 v2, v1, 4, 1
    v_mul_u32_u24 v2, 20480, v2
    v_mfma_f32_16x16x32_bf16 v[68:71], v[172:175], v[40:43], v[68:71]
    v_and_b32 v3, 15, v1
    v_lshl_add_u32 v127, v3, 3, v2
    v_mfma_f32_16x16x32_bf16 v[76:79], v[172:175], v[44:47], v[76:79]
    v_lshl_add_u32 v2, v3, 4, v2
    v_lshrrev_b32 v3, 5, v1
    v_mfma_f32_16x16x32_bf16 v[72:75], v[168:171], v[44:47], v[72:75]
    v_lshl_add_u32 v126, v3, 8, v2
    s_mul_i32 s3, s16, 3072
    s_waitcnt lgkmcnt(0)
    v_mfma_f32_16x16x32_bf16 v[48:51], v[176:179], v[16:19], v[48:51]
    s_add_u32 s3, s3, 102400
    ds_read_b128 v[32:35], v9 offset:0
    v_add_u32 v128, s3, v121
    v_mfma_f32_16x16x32_bf16 v[52:55], v[180:183], v[16:19], v[52:55]
    s_xor_b32 s3, s16, 1
    ds_read_b128 v[36:39], v9 offset:2048
    s_mul_i32 s3, s3, 3072
    v_mfma_f32_16x16x32_bf16 v[60:63], v[180:183], v[20:23], v[60:63]
    s_add_u32 s3, s3, 102400
    ds_read_b128 v[40:43], v9 offset:4096
    v_add_u32 v129, s3, v121
    v_mfma_f32_16x16x32_bf16 v[56:59], v[176:179], v[20:23], v[56:59]
    ds_read_b128 v[44:47], v9 offset:6144
    v_mov_b64 v[112:113], -1
    v_mfma_f32_16x16x32_bf16 v[64:67], v[176:179], v[24:27], v[64:67]
    v_mov_b64 v[114:115], -1
    v_mov_b32 v130, 1
    v_mfma_f32_16x16x32_bf16 v[68:71], v[180:183], v[24:27], v[68:71]
    v_mov_b32 v131, 0
    s_lshr_b32 s30, s16, 2
    v_mfma_f32_16x16x32_bf16 v[76:79], v[180:183], v[28:31], v[76:79]
    s_and_b32 s31, s16, 3
    s_mul_i32 s3, s30, 51200
    v_lshrrev_b32 v2, 5, v1
    v_mfma_f32_16x16x32_bf16 v[72:75], v[176:179], v[28:31], v[72:75]
    v_bfe_u32 v3, v1, 4, 1
    v_bfe_u32 v14, v1, 2, 2
    s_waitcnt lgkmcnt(0)
    s_barrier
    v_mfma_f32_16x16x32_bf16 v[48:51], v[184:187], v[32:35], v[48:51]
    ds_read_b128 v[16:19], v8 offset:8192
    v_mul_u32_u24 v15, 20, v2
    v_mfma_f32_16x16x32_bf16 v[52:55], v[188:191], v[32:35], v[52:55]
    ds_read_b128 v[20:23], v8 offset:10240
    v_lshl_add_u32 v15, v3, 2, v15
    v_mfma_f32_16x16x32_bf16 v[60:63], v[188:191], v[36:39], v[60:63]
    ds_read_b128 v[24:27], v8 offset:12288
    v_add_u32 v15, v15, v14
    v_mfma_f32_16x16x32_bf16 v[56:59], v[184:187], v[36:39], v[56:59]
    ds_read_b128 v[28:31], v8 offset:14336
    v_mul_u32_u24 v15, 160, v15
    v_mfma_f32_16x16x32_bf16 v[64:67], v[184:187], v[40:43], v[64:67]
    v_and_b32 v2, 3, v1
    v_lshl_add_u32 v2, v2, 3, s3
    v_mfma_f32_16x16x32_bf16 v[68:71], v[188:191], v[40:43], v[68:71]
    v_add_u32 v138, v15, v2
    v_lshrrev_b32 v3, 4, v1
    v_mfma_f32_16x16x32_bf16 v[76:79], v[188:191], v[44:47], v[76:79]
    v_mul_u32_u24 v15, 20, v3
    v_add3_u32 v15, v15, 16, v14
    v_mfma_f32_16x16x32_bf16 v[72:75], v[184:187], v[44:47], v[72:75]
    v_mul_u32_u24 v15, 160, v15
    v_add_u32 v139, v15, v2
    s_waitcnt lgkmcnt(0)
    v_mfma_f32_16x16x32_bf16 v[48:51], v[192:195], v[16:19], v[48:51]
    s_mul_i32 s3, s31, 5120
    ds_read_b128 v[32:35], v9 offset:8192
    s_add_u32 s3, s3, 143360
    v_mfma_f32_16x16x32_bf16 v[52:55], v[196:199], v[16:19], v[52:55]
    ds_read_b128 v[36:39], v9 offset:10240
    v_add_u32 v140, s3, v121
    v_mfma_f32_16x16x32_bf16 v[60:63], v[196:199], v[20:23], v[60:63]
    s_mul_i32 s3, s31, 3584
    ds_read_b128 v[40:43], v9 offset:12288
    s_add_u32 s3, s3, 102400
    v_mfma_f32_16x16x32_bf16 v[56:59], v[192:195], v[20:23], v[56:59]
    ds_read_b128 v[44:47], v9 offset:14336
    v_and_b32 v2, 15, v1
    v_mfma_f32_16x16x32_bf16 v[64:67], v[192:195], v[24:27], v[64:67]
    v_mul_u32_u24 v2, 176, v2
    v_lshl_add_u32 v2, v3, 3, v2
    v_mfma_f32_16x16x32_bf16 v[68:71], v[196:199], v[24:27], v[68:71]
    v_add_u32 v141, s3, v2
    s_and_b32 s40, s2, 7
    v_mfma_f32_16x16x32_bf16 v[76:79], v[196:199], v[28:31], v[76:79]
    s_lshl_b32 s41, s40, 2
    s_bfe_u32 s30, s2, 0x20003
    s_add_u32 s41, s41, s30
    v_mfma_f32_16x16x32_bf16 v[72:75], v[192:195], v[28:31], v[72:75]
    s_lshl_b32 s40, s40, 12
    s_add_u32 s40, s40, 10551296
    s_lshl_b32 s41, s41, 2
    s_waitcnt lgkmcnt(0)
    v_mfma_f32_16x16x32_bf16 v[48:51], v[200:203], v[32:35], v[48:51]
    s_add_u32 s41, s41, s31
    ds_read_b128 v[16:19], v8 offset:16384
    s_mul_i32 s41, s41, 20480
    v_mfma_f32_16x16x32_bf16 v[52:55], v[204:207], v[32:35], v[52:55]
    ds_read_b128 v[20:23], v8 offset:18432
    v_lshrrev_b32 v2, 1, v1
    v_mfma_f32_16x16x32_bf16 v[60:63], v[204:207], v[36:39], v[60:63]
    ds_read_b128 v[24:27], v8 offset:20480
    v_lshlrev_b32 v145, 7, v2
    v_mfma_f32_16x16x32_bf16 v[56:59], v[200:203], v[36:39], v[56:59]
    ds_read_b128 v[28:31], v8 offset:22528
    v_add_u32 v2, 0, v1
    v_mfma_f32_16x16x32_bf16 v[64:67], v[200:203], v[40:43], v[64:67]
    v_mul_u32_u24 v3, 6554, v2
    v_lshrrev_b32 v3, 16, v3
    v_mfma_f32_16x16x32_bf16 v[68:71], v[204:207], v[40:43], v[68:71]
    v_mul_u32_u24 v14, 1120, v3
    v_lshl_add_u32 v116, v2, 4, v14
    v_mfma_f32_16x16x32_bf16 v[76:79], v[204:207], v[44:47], v[76:79]
    v_add_u32 v14, v2, v3
    v_lshl_add_u32 v142, v14, 4, s3
    v_mfma_f32_16x16x32_bf16 v[72:75], v[200:203], v[44:47], v[72:75]
    v_add_u32 v2, 64, v1
    v_mul_u32_u24 v3, 6554, v2
    s_waitcnt lgkmcnt(0)
    v_mfma_f32_16x16x32_bf16 v[48:51], v[208:211], v[16:19], v[48:51]
    ds_read_b128 v[32:35], v9 offset:16384
    v_lshrrev_b32 v3, 16, v3
    v_mfma_f32_16x16x32_bf16 v[52:55], v[212:215], v[16:19], v[52:55]
    ds_read_b128 v[36:39], v9 offset:18432
    v_mul_u32_u24 v14, 1120, v3
    v_mfma_f32_16x16x32_bf16 v[60:63], v[212:215], v[20:23], v[60:63]
    ds_read_b128 v[40:43], v9 offset:20480
    v_lshl_add_u32 v117, v2, 4, v14
    v_mfma_f32_16x16x32_bf16 v[56:59], v[208:211], v[20:23], v[56:59]
    ds_read_b128 v[44:47], v9 offset:22528
    v_add_u32 v14, v2, v3
    v_mfma_f32_16x16x32_bf16 v[64:67], v[208:211], v[24:27], v[64:67]
    v_lshl_add_u32 v143, v14, 4, s3
    v_add_u32 v2, 128, v1
    v_mfma_f32_16x16x32_bf16 v[68:71], v[212:215], v[24:27], v[68:71]
    v_mul_u32_u24 v3, 6554, v2
    v_lshrrev_b32 v3, 16, v3
    v_mfma_f32_16x16x32_bf16 v[76:79], v[212:215], v[28:31], v[76:79]
    v_mul_u32_u24 v14, 1120, v3
    v_lshl_add_u32 v118, v2, 4, v14
    v_mfma_f32_16x16x32_bf16 v[72:75], v[208:211], v[28:31], v[72:75]
    v_add_u32 v14, v2, v3
    v_lshl_add_u32 v144, v14, 4, s3
    s_waitcnt lgkmcnt(0)
    v_mfma_f32_16x16x32_bf16 v[48:51], v[216:219], v[32:35], v[48:51]
    ds_read_b128 v[16:19], v8 offset:24576
    v_add_u32 v2, 192, v1
    v_mfma_f32_16x16x32_bf16 v[52:55], v[220:223], v[32:35], v[52:55]
    ds_read_b128 v[20:23], v8 offset:26624
    v_mul_u32_u24 v3, 6554, v2
    v_mfma_f32_16x16x32_bf16 v[60:63], v[220:223], v[36:39], v[60:63]
    ds_read_b128 v[24:27], v8 offset:28672
    v_lshrrev_b32 v3, 16, v3
    v_mfma_f32_16x16x32_bf16 v[56:59], v[216:219], v[36:39], v[56:59]
    ds_read_b128 v[28:31], v8 offset:30720
    v_mul_u32_u24 v14, 1120, v3
    v_mfma_f32_16x16x32_bf16 v[64:67], v[216:219], v[40:43], v[64:67]
    v_lshl_add_u32 v119, v2, 4, v14
    v_add_u32 v2, 256, v1
    v_mfma_f32_16x16x32_bf16 v[68:71], v[220:223], v[40:43], v[68:71]
    v_mul_u32_u24 v3, 6554, v2
    v_lshrrev_b32 v3, 16, v3
    v_mfma_f32_16x16x32_bf16 v[76:79], v[220:223], v[44:47], v[76:79]
    v_mul_u32_u24 v14, 1120, v3
    v_lshl_add_u32 v120, v2, 4, v14
    v_mfma_f32_16x16x32_bf16 v[72:75], v[216:219], v[44:47], v[72:75]
    s_mul_i32 s30, s17, 20
    s_add_u32 s31, s30, 19
    s_lshr_b32 s30, s30, 7
    s_waitcnt lgkmcnt(0)
    v_mfma_f32_16x16x32_bf16 v[48:51], v[224:227], v[16:19], v[48:51]
    s_lshr_b32 s31, s31, 7
    ds_read_b128 v[32:35], v9 offset:24576
    s_sub_u32 s31, s31, s30
    v_mfma_f32_16x16x32_bf16 v[52:55], v[228:231], v[16:19], v[52:55]
    ds_read_b128 v[36:39], v9 offset:26624
    v_and_b32 v2, 1, v1
    v_mfma_f32_16x16x32_bf16 v[60:63], v[228:231], v[20:23], v[60:63]
    ds_read_b128 v[40:43], v9 offset:28672
    v_mul_u32_u24 v2, s31, v2
    v_mfma_f32_16x16x32_bf16 v[56:59], v[224:227], v[20:23], v[56:59]
    ds_read_b128 v[44:47], v9 offset:30720
    v_add_u32 v2, s30, v2
    v_mfma_f32_16x16x32_bf16 v[64:67], v[224:227], v[24:27], v[64:67]
    v_lshrrev_b32 v14, 5, v1
    v_mul_u32_u24 v3, 5, v14
    v_mfma_f32_16x16x32_bf16 v[68:71], v[228:231], v[24:27], v[68:71]
    v_add3_u32 v3, v2, v3, 5
    v_bfe_u32 v15, v1, 1, 4
    v_mfma_f32_16x16x32_bf16 v[76:79], v[228:231], v[28:31], v[76:79]
    v_lshl_add_u32 v3, v3, 4, v15
    v_lshlrev_b32 v124, 7, v3
    v_mfma_f32_16x16x32_bf16 v[72:75], v[224:227], v[28:31], v[72:75]
    v_bfe_u32 v2, v1, 4, 1
    v_mul_u32_u24 v2, s31, v2
    s_waitcnt lgkmcnt(0)
    v_mfma_f32_16x16x32_bf16 v[48:51], v[232:235], v[32:35], v[48:51]
    ds_read_b128 v[16:19], v8 offset:32768
    v_add_u32 v2, s30, v2
    v_mfma_f32_16x16x32_bf16 v[52:55], v[236:239], v[32:35], v[52:55]
    s_lshr_b32 s3, s2, 5
    ds_read_b128 v[20:23], v8 offset:34816
    s_lshl_b32 s3, s3, 1
    v_mfma_f32_16x16x32_bf16 v[60:63], v[236:239], v[36:39], v[60:63]
    ds_read_b128 v[24:27], v8 offset:36864
    v_lshl_add_u32 v2, v2, 4, v14
    v_mfma_f32_16x16x32_bf16 v[56:59], v[232:235], v[36:39], v[56:59]
    ds_read_b128 v[28:31], v8 offset:38912
    v_add_u32 v2, s3, v2
    v_mfma_f32_16x16x32_bf16 v[64:67], v[232:235], v[40:43], v[64:67]
    v_lshlrev_b32 v125, 7, v2
    s_mov_b32 s33, 10485760
    v_mfma_f32_16x16x32_bf16 v[68:71], v[236:239], v[40:43], v[68:71]
    v_mov_b64 v[146:147], 0
    v_mov_b64 v[148:149], 0
    v_mfma_f32_16x16x32_bf16 v[76:79], v[236:239], v[44:47], v[76:79]
    v_mov_b64 v[150:151], 0
    v_mov_b64 v[152:153], 0
    v_mfma_f32_16x16x32_bf16 v[72:75], v[232:235], v[44:47], v[72:75]
    v_mov_b64 v[154:155], 0
    v_mov_b64 v[156:157], 0
    s_waitcnt lgkmcnt(0)
    v_mfma_f32_16x16x32_bf16 v[48:51], v[240:243], v[16:19], v[48:51]
    ds_read_b128 v[32:35], v9 offset:32768
    v_mov_b64 v[158:159], 0
    v_mfma_f32_16x16x32_bf16 v[52:55], v[244:247], v[16:19], v[52:55]
    ds_read_b128 v[36:39], v9 offset:34816
    v_mov_b64 v[160:161], 0
    v_mfma_f32_16x16x32_bf16 v[60:63], v[244:247], v[20:23], v[60:63]
    ds_read_b128 v[40:43], v9 offset:36864
    v_mov_b64 v[162:163], 0
    v_mfma_f32_16x16x32_bf16 v[56:59], v[240:243], v[20:23], v[56:59]
    ds_read_b128 v[44:47], v9 offset:38912
    v_mov_b64 v[164:165], 0
    v_mfma_f32_16x16x32_bf16 v[64:67], v[240:243], v[24:27], v[64:67]
    v_mov_b64 v[166:167], 0
    v_mov_b64 v[168:169], 0
    v_mfma_f32_16x16x32_bf16 v[68:71], v[244:247], v[24:27], v[68:71]
    v_mov_b64 v[170:171], 0
    v_mov_b64 v[172:173], 0
    v_mfma_f32_16x16x32_bf16 v[76:79], v[244:247], v[28:31], v[76:79]
    v_mov_b64 v[174:175], 0
    v_mov_b64 v[176:177], 0
    v_mfma_f32_16x16x32_bf16 v[72:75], v[240:243], v[28:31], v[72:75]
    s_waitcnt lgkmcnt(0)
    v_mfma_f32_16x16x32_bf16 v[48:51], v[248:251], v[32:35], v[48:51]
    v_mfma_f32_16x16x32_bf16 v[52:55], v[252:255], v[32:35], v[52:55]
    v_mfma_f32_16x16x32_bf16 v[60:63], v[252:255], v[36:39], v[60:63]
    v_mfma_f32_16x16x32_bf16 v[56:59], v[248:251], v[36:39], v[56:59]
    v_mfma_f32_16x16x32_bf16 v[64:67], v[248:251], v[40:43], v[64:67]
    v_mfma_f32_16x16x32_bf16 v[68:71], v[252:255], v[40:43], v[68:71]
    v_mfma_f32_16x16x32_bf16 v[76:79], v[252:255], v[44:47], v[76:79]
    v_mfma_f32_16x16x32_bf16 v[72:75], v[248:251], v[44:47], v[72:75]
    s_nop 1
    v_pk_mul_f32 v[48:49], v[48:49], s[12:13]
    v_pk_mul_f32 v[50:51], v[50:51], s[12:13]
    v_cvt_pk_bf16_f32 v80, v48, v49
    v_cvt_pk_bf16_f32 v81, v50, v51
    v_pk_mul_f32 v[52:53], v[52:53], s[12:13]
    v_pk_mul_f32 v[54:55], v[54:55], s[12:13]
    v_cvt_pk_bf16_f32 v82, v52, v53
    v_cvt_pk_bf16_f32 v83, v54, v55
    v_pk_mul_f32 v[60:61], v[60:61], s[12:13]
    v_pk_mul_f32 v[62:63], v[62:63], s[12:13]
    v_cvt_pk_bf16_f32 v84, v60, v61
    v_cvt_pk_bf16_f32 v85, v62, v63
    v_pk_mul_f32 v[56:57], v[56:57], s[12:13]
    v_pk_mul_f32 v[58:59], v[58:59], s[12:13]
    v_cvt_pk_bf16_f32 v86, v56, v57
    v_cvt_pk_bf16_f32 v87, v58, v59
    v_pk_mul_f32 v[64:65], v[64:65], s[12:13]
    v_pk_mul_f32 v[66:67], v[66:67], s[12:13]
    v_cvt_pk_bf16_f32 v88, v64, v65
    v_cvt_pk_bf16_f32 v89, v66, v67
    v_pk_mul_f32 v[68:69], v[68:69], s[12:13]
    v_pk_mul_f32 v[70:71], v[70:71], s[12:13]
    v_cvt_pk_bf16_f32 v90, v68, v69
    v_cvt_pk_bf16_f32 v91, v70, v71
    v_pk_mul_f32 v[76:77], v[76:77], s[12:13]
    v_pk_mul_f32 v[78:79], v[78:79], s[12:13]
    v_cvt_pk_bf16_f32 v92, v76, v77
    v_cvt_pk_bf16_f32 v93, v78, v79
    v_pk_mul_f32 v[72:73], v[72:73], s[12:13]
    v_pk_mul_f32 v[74:75], v[74:75], s[12:13]
    v_cvt_pk_bf16_f32 v94, v72, v73
    v_cvt_pk_bf16_f32 v95, v74, v75
    s_barrier
L_end_qk:
    buffer_store_dwordx2 v[80:81], v12, s[44:47], s62 offen offset:0 sc1
    buffer_store_dwordx2 v[82:83], v13, s[44:47], s62 offen offset:0 sc1
    buffer_store_dwordx2 v[84:85], v13, s[44:47], s62 offen offset:128 sc1
    buffer_store_dwordx2 v[86:87], v12, s[44:47], s62 offen offset:128 sc1
    buffer_store_dwordx2 v[88:89], v12, s[44:47], s62 offen offset:256 sc1
    buffer_store_dwordx2 v[90:91], v13, s[44:47], s62 offen offset:256 sc1
    buffer_store_dwordx2 v[92:93], v13, s[44:47], s62 offen offset:384 sc1
    buffer_store_dwordx2 v[94:95], v12, s[44:47], s62 offen offset:384 sc1
    s_mov_b32 s63, 1
    s_branch L_late_st
.p2align 8
.fill 380, 4, 0xbf800000
L_qkv_v:
    s_sub_u32 s3, s17, 10
    s_lshl_b32 s3, s3, 2
    s_add_u32 s3, s3, s16
    s_lshl_b32 s3, s3, 5
    v_add_u32 v6, s3, v2
    s_add_u32 s21, s21, 2624000
    s_add_u32 s62, s21, 81920
    v_mul_u32_u24 v4, 320, v3
    s_mov_b32 s24, 163520
    v_add_u32 v7, 0, v6
    v_mul_u32_u24 v5, 13108, v7
    v_lshrrev_b32 v5, 18, v5
    v_lshl_add_u32 v7, v7, 4, v4
    v_mad_u32_u24 v12, v5, s24, v7
    v_add_u32 v7, 16, v6
    v_mul_u32_u24 v5, 13108, v7
    v_lshrrev_b32 v5, 18, v5
    v_lshl_add_u32 v7, v7, 4, v4
    v_mad_u32_u24 v13, v5, s24, v7
    v_add_u32 v4, 81920, v8
    v_add_u32 v6, 81920, v10
    v_add_u32 v5, 81920, v9
    v_add_u32 v7, 81920, v11
    s_barrier
.p2align 3
    ds_read_b64_tr_b16 v[96:97], v10 offset:0
    ds_read_b64_tr_b16 v[98:99], v10 offset:1024
    ds_read_b128 v[16:19], v8 offset:0
    ds_read_b64_tr_b16 v[100:101], v11 offset:0
    ds_read_b64_tr_b16 v[102:103], v11 offset:1024
    ds_read_b128 v[20:23], v8 offset:2048
    ds_read_b128 v[24:27], v8 offset:4096
    ds_read_b128 v[28:31], v8 offset:6144
    s_waitcnt lgkmcnt(0)
    s_nop 0
    v_mfma_f32_16x16x32_bf16 v[48:51], v[16:19], v[96:99], 0
    ds_read_b64_tr_b16 v[104:105], v10 offset:8192
    ds_read_b64_tr_b16 v[106:107], v10 offset:9216
    v_mfma_f32_16x16x32_bf16 v[52:55], v[16:19], v[100:103], 0
    ds_read_b128 v[32:35], v9 offset:0
    ds_read_b64_tr_b16 v[108:109], v11 offset:8192
    v_mfma_f32_16x16x32_bf16 v[60:63], v[20:23], v[100:103], 0
    ds_read_b64_tr_b16 v[110:111], v11 offset:9216
    ds_read_b128 v[36:39], v9 offset:2048
    v_mfma_f32_16x16x32_bf16 v[56:59], v[20:23], v[96:99], 0
    ds_read_b128 v[40:43], v9 offset:4096
    ds_read_b128 v[44:47], v9 offset:6144
    v_mfma_f32_16x16x32_bf16 v[64:67], v[24:27], v[96:99], 0
    v_mfma_f32_16x16x32_bf16 v[68:71], v[24:27], v[100:103], 0
    v_mfma_f32_16x16x32_bf16 v[76:79], v[28:31], v[100:103], 0
    v_mfma_f32_16x16x32_bf16 v[72:75], v[28:31], v[96:99], 0
    s_waitcnt lgkmcnt(0)
    s_barrier
    v_mfma_f32_16x16x32_bf16 v[48:51], v[32:35], v[104:107], v[48:51]
    ds_read_b64_tr_b16 v[112:113], v10 offset:24576
    ds_read_b64_tr_b16 v[114:115], v10 offset:25600
    v_mfma_f32_16x16x32_bf16 v[52:55], v[32:35], v[108:111], v[52:55]
    ds_read_b128 v[16:19], v8 offset:24576
    ds_read_b64_tr_b16 v[116:117], v11 offset:24576
    v_mfma_f32_16x16x32_bf16 v[60:63], v[36:39], v[108:111], v[60:63]
    ds_read_b64_tr_b16 v[118:119], v11 offset:25600
    ds_read_b128 v[20:23], v8 offset:26624
    v_mfma_f32_16x16x32_bf16 v[56:59], v[36:39], v[104:107], v[56:59]
    ds_read_b128 v[24:27], v8 offset:28672
    ds_read_b128 v[28:31], v8 offset:30720
    v_mfma_f32_16x16x32_bf16 v[64:67], v[40:43], v[104:107], v[64:67]
    v_mfma_f32_16x16x32_bf16 v[68:71], v[40:43], v[108:111], v[68:71]
    v_mfma_f32_16x16x32_bf16 v[76:79], v[44:47], v[108:111], v[76:79]
    v_mfma_f32_16x16x32_bf16 v[72:75], v[44:47], v[104:107], v[72:75]
    s_waitcnt lgkmcnt(0)
    s_nop 0
    v_mfma_f32_16x16x32_bf16 v[48:51], v[16:19], v[112:115], v[48:51]
    ds_read_b64_tr_b16 v[120:121], v10 offset:32768
    ds_read_b64_tr_b16 v[122:123], v10 offset:33792
    v_mfma_f32_16x16x32_bf16 v[52:55], v[16:19], v[116:119], v[52:55]
    ds_read_b128 v[32:35], v9 offset:24576
    ds_read_b64_tr_b16 v[124:125], v11 offset:32768
    v_mfma_f32_16x16x32_bf16 v[60:63], v[20:23], v[116:119], v[60:63]
    ds_read_b64_tr_b16 v[126:127], v11 offset:33792
    ds_read_b128 v[36:39], v9 offset:26624
    v_mfma_f32_16x16x32_bf16 v[56:59], v[20:23], v[112:115], v[56:59]
    ds_read_b128 v[40:43], v9 offset:28672
    ds_read_b128 v[44:47], v9 offset:30720
    v_mfma_f32_16x16x32_bf16 v[64:67], v[24:27], v[112:115], v[64:67]
    v_mfma_f32_16x16x32_bf16 v[68:71], v[24:27], v[116:119], v[68:71]
    v_mfma_f32_16x16x32_bf16 v[76:79], v[28:31], v[116:119], v[76:79]
    v_mfma_f32_16x16x32_bf16 v[72:75], v[28:31], v[112:115], v[72:75]
    s_waitcnt lgkmcnt(0)
    s_barrier
    v_mfma_f32_16x16x32_bf16 v[48:51], v[32:35], v[120:123], v[48:51]
    ds_read_b64_tr_b16 v[128:129], v10 offset:49152
    ds_read_b64_tr_b16 v[130:131], v10 offset:50176
    v_mfma_f32_16x16x32_bf16 v[52:55], v[32:35], v[124:127], v[52:55]
    ds_read_b128 v[16:19], v8 offset:49152
    ds_read_b64_tr_b16 v[132:133], v11 offset:49152
    v_mfma_f32_16x16x32_bf16 v[60:63], v[36:39], v[124:127], v[60:63]
    ds_read_b64_tr_b16 v[134:135], v11 offset:50176
    ds_read_b128 v[20:23], v8 offset:51200
    v_mfma_f32_16x16x32_bf16 v[56:59], v[36:39], v[120:123], v[56:59]
    ds_read_b128 v[24:27], v8 offset:53248
    ds_read_b128 v[28:31], v8 offset:55296
    v_mfma_f32_16x16x32_bf16 v[64:67], v[40:43], v[120:123], v[64:67]
    v_mfma_f32_16x16x32_bf16 v[68:71], v[40:43], v[124:127], v[68:71]
    v_mfma_f32_16x16x32_bf16 v[76:79], v[44:47], v[124:127], v[76:79]
    v_mfma_f32_16x16x32_bf16 v[72:75], v[44:47], v[120:123], v[72:75]
    s_waitcnt lgkmcnt(0)
    s_nop 0
    v_mfma_f32_16x16x32_bf16 v[48:51], v[16:19], v[128:131], v[48:51]
    ds_read_b64_tr_b16 v[136:137], v10 offset:57344
    ds_read_b64_tr_b16 v[138:139], v10 offset:58368
    v_mfma_f32_16x16x32_bf16 v[52:55], v[16:19], v[132:135], v[52:55]
    ds_read_b128 v[32:35], v9 offset:49152
    ds_read_b64_tr_b16 v[140:141], v11 offset:57344
    v_mfma_f32_16x16x32_bf16 v[60:63], v[20:23], v[132:135], v[60:63]
    ds_read_b64_tr_b16 v[142:143], v11 offset:58368
    ds_read_b128 v[36:39], v9 offset:51200
    v_mfma_f32_16x16x32_bf16 v[56:59], v[20:23], v[128:131], v[56:59]
    ds_read_b128 v[40:43], v9 offset:53248
    ds_read_b128 v[44:47], v9 offset:55296
    v_mfma_f32_16x16x32_bf16 v[64:67], v[24:27], v[128:131], v[64:67]
    v_mfma_f32_16x16x32_bf16 v[68:71], v[24:27], v[132:135], v[68:71]
    v_mfma_f32_16x16x32_bf16 v[76:79], v[28:31], v[132:135], v[76:79]
    v_mfma_f32_16x16x32_bf16 v[72:75], v[28:31], v[128:131], v[72:75]
    s_waitcnt lgkmcnt(0)
    s_barrier
    v_mfma_f32_16x16x32_bf16 v[48:51], v[32:35], v[136:139], v[48:51]
    ds_read_b64_tr_b16 v[144:145], v6 offset:0
    ds_read_b64_tr_b16 v[146:147], v6 offset:1024
    v_mfma_f32_16x16x32_bf16 v[52:55], v[32:35], v[140:143], v[52:55]
    ds_read_b128 v[16:19], v4 offset:0
    ds_read_b64_tr_b16 v[148:149], v7 offset:0
    v_mfma_f32_16x16x32_bf16 v[60:63], v[36:39], v[140:143], v[60:63]
    ds_read_b64_tr_b16 v[150:151], v7 offset:1024
    ds_read_b128 v[20:23], v4 offset:2048
    v_mfma_f32_16x16x32_bf16 v[56:59], v[36:39], v[136:139], v[56:59]
    ds_read_b128 v[24:27], v4 offset:4096
    ds_read_b128 v[28:31], v4 offset:6144
    v_mfma_f32_16x16x32_bf16 v[64:67], v[40:43], v[136:139], v[64:67]
    v_mfma_f32_16x16x32_bf16 v[68:71], v[40:43], v[140:143], v[68:71]
    v_mfma_f32_16x16x32_bf16 v[76:79], v[44:47], v[140:143], v[76:79]
    v_mfma_f32_16x16x32_bf16 v[72:75], v[44:47], v[136:139], v[72:75]
    s_waitcnt lgkmcnt(0)
    s_nop 0
    v_mfma_f32_16x16x32_bf16 v[48:51], v[16:19], v[144:147], v[48:51]
    ds_read_b64_tr_b16 v[152:153], v6 offset:8192
    ds_read_b64_tr_b16 v[154:155], v6 offset:9216
    v_mfma_f32_16x16x32_bf16 v[52:55], v[16:19], v[148:151], v[52:55]
    ds_read_b128 v[32:35], v5 offset:0
    ds_read_b64_tr_b16 v[156:157], v7 offset:8192
    v_mfma_f32_16x16x32_bf16 v[60:63], v[20:23], v[148:151], v[60:63]
    ds_read_b64_tr_b16 v[158:159], v7 offset:9216
    ds_read_b128 v[36:39], v5 offset:2048
    v_mfma_f32_16x16x32_bf16 v[56:59], v[20:23], v[144:147], v[56:59]
    ds_read_b128 v[40:43], v5 offset:4096
    ds_read_b128 v[44:47], v5 offset:6144
    v_mfma_f32_16x16x32_bf16 v[64:67], v[24:27], v[144:147], v[64:67]
    v_mfma_f32_16x16x32_bf16 v[68:71], v[24:27], v[148:151], v[68:71]
    v_mfma_f32_16x16x32_bf16 v[76:79], v[28:31], v[148:151], v[76:79]
    v_mfma_f32_16x16x32_bf16 v[72:75], v[28:31], v[144:147], v[72:75]
    s_waitcnt lgkmcnt(0)
    s_barrier
    v_mfma_f32_16x16x32_bf16 v[48:51], v[32:35], v[152:155], v[48:51]
    ds_read_b64_tr_b16 v[160:161], v6 offset:24576
    ds_read_b64_tr_b16 v[162:163], v6 offset:25600
    v_mfma_f32_16x16x32_bf16 v[52:55], v[32:35], v[156:159], v[52:55]
    ds_read_b128 v[16:19], v4 offset:24576
    ds_read_b64_tr_b16 v[164:165], v7 offset:24576
    v_mfma_f32_16x16x32_bf16 v[60:63], v[36:39], v[156:159], v[60:63]
    ds_read_b64_tr_b16 v[166:167], v7 offset:25600
    ds_read_b128 v[20:23], v4 offset:26624
    v_mfma_f32_16x16x32_bf16 v[56:59], v[36:39], v[152:155], v[56:59]
    ds_read_b128 v[24:27], v4 offset:28672
    ds_read_b128 v[28:31], v4 offset:30720
    v_mfma_f32_16x16x32_bf16 v[64:67], v[40:43], v[152:155], v[64:67]
    v_mfma_f32_16x16x32_bf16 v[68:71], v[40:43], v[156:159], v[68:71]
    v_mfma_f32_16x16x32_bf16 v[76:79], v[44:47], v[156:159], v[76:79]
    v_mfma_f32_16x16x32_bf16 v[72:75], v[44:47], v[152:155], v[72:75]
    s_waitcnt lgkmcnt(0)
    s_nop 0
    v_mfma_f32_16x16x32_bf16 v[48:51], v[16:19], v[160:163], v[48:51]
    ds_read_b64_tr_b16 v[168:169], v6 offset:32768
    ds_read_b64_tr_b16 v[170:171], v6 offset:33792
    v_mfma_f32_16x16x32_bf16 v[52:55], v[16:19], v[164:167], v[52:55]
    ds_read_b128 v[32:35], v5 offset:24576
    ds_read_b64_tr_b16 v[172:173], v7 offset:32768
    v_mfma_f32_16x16x32_bf16 v[60:63], v[20:23], v[164:167], v[60:63]
    ds_read_b64_tr_b16 v[174:175], v7 offset:33792
    ds_read_b128 v[36:39], v5 offset:26624
    v_mfma_f32_16x16x32_bf16 v[56:59], v[20:23], v[160:163], v[56:59]
    ds_read_b128 v[40:43], v5 offset:28672
    ds_read_b128 v[44:47], v5 offset:30720
    v_mfma_f32_16x16x32_bf16 v[64:67], v[24:27], v[160:163], v[64:67]
    v_mfma_f32_16x16x32_bf16 v[68:71], v[24:27], v[164:167], v[68:71]
    v_mfma_f32_16x16x32_bf16 v[76:79], v[28:31], v[164:167], v[76:79]
    v_mfma_f32_16x16x32_bf16 v[72:75], v[28:31], v[160:163], v[72:75]
    s_waitcnt lgkmcnt(0)
    s_barrier
    v_mfma_f32_16x16x32_bf16 v[48:51], v[32:35], v[168:171], v[48:51]
    ds_read_b64_tr_b16 v[176:177], v6 offset:49152
    ds_read_b64_tr_b16 v[178:179], v6 offset:50176
    v_mfma_f32_16x16x32_bf16 v[52:55], v[32:35], v[172:175], v[52:55]
    ds_read_b128 v[16:19], v4 offset:49152
    ds_read_b64_tr_b16 v[180:181], v7 offset:49152
    v_mfma_f32_16x16x32_bf16 v[60:63], v[36:39], v[172:175], v[60:63]
    ds_read_b64_tr_b16 v[182:183], v7 offset:50176
    ds_read_b128 v[20:23], v4 offset:51200
    v_mfma_f32_16x16x32_bf16 v[56:59], v[36:39], v[168:171], v[56:59]
    ds_read_b128 v[24:27], v4 offset:53248
    ds_read_b128 v[28:31], v4 offset:55296
    v_mfma_f32_16x16x32_bf16 v[64:67], v[40:43], v[168:171], v[64:67]
    v_mfma_f32_16x16x32_bf16 v[68:71], v[40:43], v[172:175], v[68:71]
    v_mfma_f32_16x16x32_bf16 v[76:79], v[44:47], v[172:175], v[76:79]
    v_mfma_f32_16x16x32_bf16 v[72:75], v[44:47], v[168:171], v[72:75]
    s_waitcnt lgkmcnt(0)
    s_nop 0
    v_mfma_f32_16x16x32_bf16 v[48:51], v[16:19], v[176:179], v[48:51]
    ds_read_b64_tr_b16 v[184:185], v6 offset:57344
    ds_read_b64_tr_b16 v[186:187], v6 offset:58368
    v_mfma_f32_16x16x32_bf16 v[52:55], v[16:19], v[180:183], v[52:55]
    ds_read_b128 v[32:35], v5 offset:49152
    ds_read_b64_tr_b16 v[188:189], v7 offset:57344
    v_mfma_f32_16x16x32_bf16 v[60:63], v[20:23], v[180:183], v[60:63]
    ds_read_b64_tr_b16 v[190:191], v7 offset:58368
    ds_read_b128 v[36:39], v5 offset:51200
    v_mfma_f32_16x16x32_bf16 v[56:59], v[20:23], v[176:179], v[56:59]
    ds_read_b128 v[40:43], v5 offset:53248
    ds_read_b128 v[44:47], v5 offset:55296
    v_mfma_f32_16x16x32_bf16 v[64:67], v[24:27], v[176:179], v[64:67]
    v_mfma_f32_16x16x32_bf16 v[68:71], v[24:27], v[180:183], v[68:71]
    v_mfma_f32_16x16x32_bf16 v[76:79], v[28:31], v[180:183], v[76:79]
    v_mfma_f32_16x16x32_bf16 v[72:75], v[28:31], v[176:179], v[72:75]
    s_waitcnt lgkmcnt(0)
    s_barrier
    v_mfma_f32_16x16x32_bf16 v[48:51], v[32:35], v[184:187], v[48:51]
    ds_read_b64_tr_b16 v[192:193], v10 offset:0
    ds_read_b64_tr_b16 v[194:195], v10 offset:1024
    v_mfma_f32_16x16x32_bf16 v[52:55], v[32:35], v[188:191], v[52:55]
    ds_read_b128 v[16:19], v8 offset:0
    ds_read_b64_tr_b16 v[196:197], v11 offset:0
    v_mfma_f32_16x16x32_bf16 v[60:63], v[36:39], v[188:191], v[60:63]
    ds_read_b64_tr_b16 v[198:199], v11 offset:1024
    ds_read_b128 v[20:23], v8 offset:2048
    v_mfma_f32_16x16x32_bf16 v[56:59], v[36:39], v[184:187], v[56:59]
    ds_read_b128 v[24:27], v8 offset:4096
    ds_read_b128 v[28:31], v8 offset:6144
    v_mfma_f32_16x16x32_bf16 v[64:67], v[40:43], v[184:187], v[64:67]
    v_mfma_f32_16x16x32_bf16 v[68:71], v[40:43], v[188:191], v[68:71]
    v_mfma_f32_16x16x32_bf16 v[76:79], v[44:47], v[188:191], v[76:79]
    v_mfma_f32_16x16x32_bf16 v[72:75], v[44:47], v[184:187], v[72:75]
    s_waitcnt lgkmcnt(0)
    s_nop 0
    v_mfma_f32_16x16x32_bf16 v[48:51], v[16:19], v[192:195], v[48:51]
    ds_read_b64_tr_b16 v[200:201], v10 offset:8192
    ds_read_b64_tr_b16 v[202:203], v10 offset:9216
    v_mfma_f32_16x16x32_bf16 v[52:55], v[16:19], v[196:199], v[52:55]
    ds_read_b128 v[32:35], v9 offset:0
    ds_read_b64_tr_b16 v[204:205], v11 offset:8192
    v_mfma_f32_16x16x32_bf16 v[60:63], v[20:23], v[196:199], v[60:63]
    ds_read_b64_tr_b16 v[206:207], v11 offset:9216
    ds_read_b128 v[36:39], v9 offset:2048
    v_mfma_f32_16x16x32_bf16 v[56:59], v[20:23], v[192:195], v[56:59]
    ds_read_b128 v[40:43], v9 offset:4096
    ds_read_b128 v[44:47], v9 offset:6144
    v_mfma_f32_16x16x32_bf16 v[64:67], v[24:27], v[192:195], v[64:67]
    v_mfma_f32_16x16x32_bf16 v[68:71], v[24:27], v[196:199], v[68:71]
    v_mfma_f32_16x16x32_bf16 v[76:79], v[28:31], v[196:199], v[76:79]
    v_mfma_f32_16x16x32_bf16 v[72:75], v[28:31], v[192:195], v[72:75]
    s_waitcnt lgkmcnt(0)
    s_barrier
    v_add_u32 v6, 8192, v6
    v_add_u32 v7, 8192, v7
    v_mfma_f32_16x16x32_bf16 v[48:51], v[32:35], v[200:203], v[48:51]
    ds_read_b64_tr_b16 v[208:209], v10 offset:24576
    ds_read_b64_tr_b16 v[210:211], v10 offset:25600
    v_mfma_f32_16x16x32_bf16 v[52:55], v[32:35], v[204:207], v[52:55]
    ds_read_b128 v[16:19], v8 offset:24576
    ds_read_b64_tr_b16 v[212:213], v11 offset:24576
    v_mfma_f32_16x16x32_bf16 v[60:63], v[36:39], v[204:207], v[60:63]
    ds_read_b64_tr_b16 v[214:215], v11 offset:25600
    ds_read_b128 v[20:23], v8 offset:26624
    v_mfma_f32_16x16x32_bf16 v[56:59], v[36:39], v[200:203], v[56:59]
    ds_read_b128 v[24:27], v8 offset:28672
    ds_read_b128 v[28:31], v8 offset:30720
    v_mfma_f32_16x16x32_bf16 v[64:67], v[40:43], v[200:203], v[64:67]
    v_mfma_f32_16x16x32_bf16 v[68:71], v[40:43], v[204:207], v[68:71]
    v_mfma_f32_16x16x32_bf16 v[76:79], v[44:47], v[204:207], v[76:79]
    v_mfma_f32_16x16x32_bf16 v[72:75], v[44:47], v[200:203], v[72:75]
    s_waitcnt lgkmcnt(0)
    s_nop 0
    v_mfma_f32_16x16x32_bf16 v[48:51], v[16:19], v[208:211], v[48:51]
    ds_read_b64_tr_b16 v[216:217], v10 offset:32768
    ds_read_b64_tr_b16 v[218:219], v10 offset:33792
    v_mfma_f32_16x16x32_bf16 v[52:55], v[16:19], v[212:215], v[52:55]
    ds_read_b128 v[32:35], v9 offset:24576
    ds_read_b64_tr_b16 v[220:221], v11 offset:32768
    v_mfma_f32_16x16x32_bf16 v[60:63], v[20:23], v[212:215], v[60:63]
    ds_read_b64_tr_b16 v[222:223], v11 offset:33792
    ds_read_b128 v[36:39], v9 offset:26624
    v_mfma_f32_16x16x32_bf16 v[56:59], v[20:23], v[208:211], v[56:59]
    ds_read_b128 v[40:43], v9 offset:28672
    ds_read_b128 v[44:47], v9 offset:30720
    v_mfma_f32_16x16x32_bf16 v[64:67], v[24:27], v[208:211], v[64:67]
    v_mfma_f32_16x16x32_bf16 v[68:71], v[24:27], v[212:215], v[68:71]
    v_mfma_f32_16x16x32_bf16 v[76:79], v[28:31], v[212:215], v[76:79]
    v_mfma_f32_16x16x32_bf16 v[72:75], v[28:31], v[208:211], v[72:75]
    s_waitcnt lgkmcnt(0)
    s_barrier
    v_mfma_f32_16x16x32_bf16 v[48:51], v[32:35], v[216:219], v[48:51]
    ds_read_b64_tr_b16 v[224:225], v10 offset:49152
    ds_read_b64_tr_b16 v[226:227], v10 offset:50176
    v_mfma_f32_16x16x32_bf16 v[52:55], v[32:35], v[220:223], v[52:55]
    ds_read_b128 v[16:19], v8 offset:49152
    ds_read_b64_tr_b16 v[228:229], v11 offset:49152
    v_mfma_f32_16x16x32_bf16 v[60:63], v[36:39], v[220:223], v[60:63]
    ds_read_b64_tr_b16 v[230:231], v11 offset:50176
    ds_read_b128 v[20:23], v8 offset:51200
    v_mfma_f32_16x16x32_bf16 v[56:59], v[36:39], v[216:219], v[56:59]
    ds_read_b128 v[24:27], v8 offset:53248
    ds_read_b128 v[28:31], v8 offset:55296
    v_mfma_f32_16x16x32_bf16 v[64:67], v[40:43], v[216:219], v[64:67]
    v_mfma_f32_16x16x32_bf16 v[68:71], v[40:43], v[220:223], v[68:71]
    v_mfma_f32_16x16x32_bf16 v[76:79], v[44:47], v[220:223], v[76:79]
    v_mfma_f32_16x16x32_bf16 v[72:75], v[44:47], v[216:219], v[72:75]
    s_waitcnt lgkmcnt(0)
    s_nop 0
    v_mfma_f32_16x16x32_bf16 v[48:51], v[16:19], v[224:227], v[48:51]
    ds_read_b64_tr_b16 v[232:233], v10 offset:57344
    ds_read_b64_tr_b16 v[234:235], v10 offset:58368
    v_mfma_f32_16x16x32_bf16 v[52:55], v[16:19], v[228:231], v[52:55]
    ds_read_b128 v[32:35], v9 offset:49152
    ds_read_b64_tr_b16 v[236:237], v11 offset:57344
    v_mfma_f32_16x16x32_bf16 v[60:63], v[20:23], v[228:231], v[60:63]
    ds_read_b64_tr_b16 v[238:239], v11 offset:58368
    ds_read_b128 v[36:39], v9 offset:51200
    v_mfma_f32_16x16x32_bf16 v[56:59], v[20:23], v[224:227], v[56:59]
    ds_read_b128 v[40:43], v9 offset:53248
    ds_read_b128 v[44:47], v9 offset:55296
    v_mfma_f32_16x16x32_bf16 v[64:67], v[24:27], v[224:227], v[64:67]
    v_mfma_f32_16x16x32_bf16 v[68:71], v[24:27], v[228:231], v[68:71]
    v_mfma_f32_16x16x32_bf16 v[76:79], v[28:31], v[228:231], v[76:79]
    v_mfma_f32_16x16x32_bf16 v[72:75], v[28:31], v[224:227], v[72:75]
    s_waitcnt lgkmcnt(0)
    s_barrier
    v_mfma_f32_16x16x32_bf16 v[48:51], v[32:35], v[232:235], v[48:51]
    ds_read_b64_tr_b16 v[240:241], v6 offset:49152
    ds_read_b64_tr_b16 v[242:243], v6 offset:50176
    v_mfma_f32_16x16x32_bf16 v[52:55], v[32:35], v[236:239], v[52:55]
    ds_read_b128 v[16:19], v4 offset:57344
    ds_read_b64_tr_b16 v[244:245], v7 offset:49152
    v_mfma_f32_16x16x32_bf16 v[60:63], v[36:39], v[236:239], v[60:63]
    ds_read_b64_tr_b16 v[246:247], v7 offset:50176
    ds_read_b128 v[20:23], v4 offset:59392
    v_mfma_f32_16x16x32_bf16 v[56:59], v[36:39], v[232:235], v[56:59]
    ds_read_b128 v[24:27], v4 offset:61440
    ds_read_b128 v[28:31], v4 offset:63488
    v_mfma_f32_16x16x32_bf16 v[64:67], v[40:43], v[232:235], v[64:67]
    v_mfma_f32_16x16x32_bf16 v[68:71], v[40:43], v[236:239], v[68:71]
    v_mfma_f32_16x16x32_bf16 v[76:79], v[44:47], v[236:239], v[76:79]
    v_mfma_f32_16x16x32_bf16 v[72:75], v[44:47], v[232:235], v[72:75]
    s_waitcnt lgkmcnt(0)
    s_nop 0
    v_mfma_f32_16x16x32_bf16 v[48:51], v[16:19], v[240:243], v[48:51]
    ds_read_b64_tr_b16 v[248:249], v6 offset:57344
    ds_read_b64_tr_b16 v[250:251], v6 offset:58368
    v_mfma_f32_16x16x32_bf16 v[52:55], v[16:19], v[244:247], v[52:55]
    ds_read_b128 v[32:35], v5 offset:57344
    ds_read_b64_tr_b16 v[252:253], v7 offset:57344
    v_mfma_f32_16x16x32_bf16 v[60:63], v[20:23], v[244:247], v[60:63]
    ds_read_b64_tr_b16 v[254:255], v7 offset:58368
    ds_read_b128 v[36:39], v5 offset:59392
    v_mfma_f32_16x16x32_bf16 v[56:59], v[20:23], v[240:243], v[56:59]
    ds_read_b128 v[40:43], v5 offset:61440
    ds_read_b128 v[44:47], v5 offset:63488
    v_mfma_f32_16x16x32_bf16 v[64:67], v[24:27], v[240:243], v[64:67]
    v_mfma_f32_16x16x32_bf16 v[68:71], v[24:27], v[244:247], v[68:71]
    v_mfma_f32_16x16x32_bf16 v[76:79], v[28:31], v[244:247], v[76:79]
    v_mfma_f32_16x16x32_bf16 v[72:75], v[28:31], v[240:243], v[72:75]
    s_waitcnt lgkmcnt(0)
    s_nop 0
    v_mfma_f32_16x16x32_bf16 v[48:51], v[32:35], v[248:251], v[48:51]
    v_mfma_f32_16x16x32_bf16 v[52:55], v[32:35], v[252:255], v[52:55]
    v_mfma_f32_16x16x32_bf16 v[60:63], v[36:39], v[252:255], v[60:63]
    v_mfma_f32_16x16x32_bf16 v[56:59], v[36:39], v[248:251], v[56:59]
    v_mfma_f32_16x16x32_bf16 v[64:67], v[40:43], v[248:251], v[64:67]
    v_mfma_f32_16x16x32_bf16 v[68:71], v[40:43], v[252:255], v[68:71]
    v_mfma_f32_16x16x32_bf16 v[76:79], v[44:47], v[252:255], v[76:79]
    v_mfma_f32_16x16x32_bf16 v[72:75], v[44:47], v[248:251], v[72:75]
    v_add_u32 v8, 122880, v8
    v_add_u32 v9, 122880, v9
    s_nop 2
    v_cvt_pk_bf16_f32 v80, v48, v49
    v_cvt_pk_bf16_f32 v81, v50, v51
    v_cvt_pk_bf16_f32 v82, v56, v57
    v_cvt_pk_bf16_f32 v83, v58, v59
    buffer_store_dwordx4 v[80:83], v12, s[44:47], s21 offen offset:0 sc1
    v_cvt_pk_bf16_f32 v84, v52, v53
    v_cvt_pk_bf16_f32 v85, v54, v55
    v_cvt_pk_bf16_f32 v86, v60, v61
    v_cvt_pk_bf16_f32 v87, v62, v63
    buffer_store_dwordx4 v[84:87], v13, s[44:47], s21 offen offset:0 sc1
    v_cvt_pk_bf16_f32 v88, v64, v65
    v_cvt_pk_bf16_f32 v89, v66, v67
    v_cvt_pk_bf16_f32 v90, v72, v73
    v_cvt_pk_bf16_f32 v91, v74, v75
    buffer_store_dwordx4 v[88:91], v12, s[44:47], s21 offen offset:1280 sc1
    v_cvt_pk_bf16_f32 v92, v68, v69
    v_cvt_pk_bf16_f32 v93, v70, v71
    v_cvt_pk_bf16_f32 v94, v76, v77
    v_cvt_pk_bf16_f32 v95, v78, v79
    buffer_store_dwordx4 v[92:95], v13, s[44:47], s21 offen offset:1280 sc1
    s_barrier
    ds_read_b128 v[16:19], v4 offset:0
    ds_read_b128 v[20:23], v4 offset:2048
    ds_read_b128 v[24:27], v4 offset:4096
    ds_read_b128 v[28:31], v4 offset:6144
.p2align 3
    s_waitcnt lgkmcnt(0)
    s_nop 0
    v_mfma_f32_16x16x32_bf16 v[48:51], v[16:19], v[96:99], 0
    ds_read_b128 v[32:35], v5 offset:0
    v_mfma_f32_16x16x32_bf16 v[52:55], v[16:19], v[100:103], 0
    ds_read_b128 v[36:39], v5 offset:2048
    v_mfma_f32_16x16x32_bf16 v[60:63], v[20:23], v[100:103], 0
    ds_read_b128 v[40:43], v5 offset:4096
    v_mfma_f32_16x16x32_bf16 v[56:59], v[20:23], v[96:99], 0
    ds_read_b128 v[44:47], v5 offset:6144
    v_mfma_f32_16x16x32_bf16 v[64:67], v[24:27], v[96:99], 0
    v_mfma_f32_16x16x32_bf16 v[68:71], v[24:27], v[100:103], 0
    v_mfma_f32_16x16x32_bf16 v[76:79], v[28:31], v[100:103], 0
    v_mfma_f32_16x16x32_bf16 v[72:75], v[28:31], v[96:99], 0
    s_waitcnt lgkmcnt(0)
    s_nop 0
    v_mfma_f32_16x16x32_bf16 v[48:51], v[32:35], v[104:107], v[48:51]
    ds_read_b128 v[16:19], v4 offset:8192
    v_mfma_f32_16x16x32_bf16 v[52:55], v[32:35], v[108:111], v[52:55]
    ds_read_b128 v[20:23], v4 offset:10240
    v_mfma_f32_16x16x32_bf16 v[60:63], v[36:39], v[108:111], v[60:63]
    ds_read_b128 v[24:27], v4 offset:12288
    v_mfma_f32_16x16x32_bf16 v[56:59], v[36:39], v[104:107], v[56:59]
    ds_read_b128 v[28:31], v4 offset:14336
    v_mfma_f32_16x16x32_bf16 v[64:67], v[40:43], v[104:107], v[64:67]
    v_mfma_f32_16x16x32_bf16 v[68:71], v[40:43], v[108:111], v[68:71]
    v_mfma_f32_16x16x32_bf16 v[76:79], v[44:47], v[108:111], v[76:79]
    v_mfma_f32_16x16x32_bf16 v[72:75], v[44:47], v[104:107], v[72:75]
    s_waitcnt lgkmcnt(0)
    s_nop 0
    v_mfma_f32_16x16x32_bf16 v[48:51], v[16:19], v[112:115], v[48:51]
    ds_read_b128 v[32:35], v5 offset:8192
    v_mfma_f32_16x16x32_bf16 v[52:55], v[16:19], v[116:119], v[52:55]
    ds_read_b128 v[36:39], v5 offset:10240
    v_mfma_f32_16x16x32_bf16 v[60:63], v[20:23], v[116:119], v[60:63]
    ds_read_b128 v[40:43], v5 offset:12288
    v_mfma_f32_16x16x32_bf16 v[56:59], v[20:23], v[112:115], v[56:59]
    ds_read_b128 v[44:47], v5 offset:14336
    v_mfma_f32_16x16x32_bf16 v[64:67], v[24:27], v[112:115], v[64:67]
    v_mfma_f32_16x16x32_bf16 v[68:71], v[24:27], v[116:119], v[68:71]
    v_mfma_f32_16x16x32_bf16 v[76:79], v[28:31], v[116:119], v[76:79]
    v_mfma_f32_16x16x32_bf16 v[72:75], v[28:31], v[112:115], v[72:75]
    s_waitcnt lgkmcnt(0)
    s_nop 0
    v_mfma_f32_16x16x32_bf16 v[48:51], v[32:35], v[120:123], v[48:51]
    ds_read_b128 v[16:19], v4 offset:16384
    v_mfma_f32_16x16x32_bf16 v[52:55], v[32:35], v[124:127], v[52:55]
    ds_read_b128 v[20:23], v4 offset:18432
    v_mfma_f32_16x16x32_bf16 v[60:63], v[36:39], v[124:127], v[60:63]
    ds_read_b128 v[24:27], v4 offset:20480
    v_mfma_f32_16x16x32_bf16 v[56:59], v[36:39], v[120:123], v[56:59]
    ds_read_b128 v[28:31], v4 offset:22528
    v_mfma_f32_16x16x32_bf16 v[64:67], v[40:43], v[120:123], v[64:67]
    v_mfma_f32_16x16x32_bf16 v[68:71], v[40:43], v[124:127], v[68:71]
    v_mfma_f32_16x16x32_bf16 v[76:79], v[44:47], v[124:127], v[76:79]
    v_mfma_f32_16x16x32_bf16 v[72:75], v[44:47], v[120:123], v[72:75]
    s_waitcnt vmcnt(0) lgkmcnt(0)
    s_barrier
    v_mfma_f32_16x16x32_bf16 v[48:51], v[16:19], v[128:131], v[48:51]
    ds_read_b128 v[32:35], v5 offset:16384
    v_mfma_f32_16x16x32_bf16 v[52:55], v[16:19], v[132:135], v[52:55]
    ds_read_b128 v[36:39], v5 offset:18432
    v_mfma_f32_16x16x32_bf16 v[60:63], v[20:23], v[132:135], v[60:63]
    ds_read_b128 v[40:43], v5 offset:20480
    v_mfma_f32_16x16x32_bf16 v[56:59], v[20:23], v[128:131], v[56:59]
    ds_read_b128 v[44:47], v5 offset:22528
    v_mfma_f32_16x16x32_bf16 v[64:67], v[24:27], v[128:131], v[64:67]
    v_mfma_f32_16x16x32_bf16 v[68:71], v[24:27], v[132:135], v[68:71]
    v_mfma_f32_16x16x32_bf16 v[76:79], v[28:31], v[132:135], v[76:79]
    v_mfma_f32_16x16x32_bf16 v[72:75], v[28:31], v[128:131], v[72:75]
    s_waitcnt lgkmcnt(0)
    v_mfma_f32_16x16x32_bf16 v[48:51], v[32:35], v[136:139], v[48:51]
    s_and_b32 s17, s2, 7
    ds_read_b128 v[16:19], v4 offset:24576
    s_lshl_b32 s17, s17, 2
    v_mfma_f32_16x16x32_bf16 v[52:55], v[32:35], v[140:143], v[52:55]
    s_lshr_b32 s17, 0x75643120, s17
    ds_read_b128 v[20:23], v4 offset:26624
    s_and_b32 s17, s17, 7
    v_mfma_f32_16x16x32_bf16 v[60:63], v[36:39], v[140:143], v[60:63]
    s_lshl_b32 s17, s17, 2
    ds_read_b128 v[24:27], v4 offset:28672
    s_bfe_u32 s3, s2, 0x20003
    v_mfma_f32_16x16x32_bf16 v[56:59], v[36:39], v[136:139], v[56:59]
    s_add_u32 s17, s17, s3
    ds_read_b128 v[28:31], v4 offset:30720
    s_lshr_b32 s29, s2, 5
    v_mfma_f32_16x16x32_bf16 v[64:67], v[40:43], v[136:139], v[64:67]
    s_lshl_b32 s18, s29, 2
    s_and_b32 s3, s16, 2
    s_add_u32 s18, s18, s3
    v_mfma_f32_16x16x32_bf16 v[68:71], v[40:43], v[140:143], v[68:71]
    s_add_u32 s18, s18, 1
    s_and_b32 s19, s16, 1
    s_mul_i32 s20, s19, 5120
    v_mfma_f32_16x16x32_bf16 v[76:79], v[44:47], v[140:143], v[76:79]
    v_and_b32 v2, 31, v1
    v_lshrrev_b32 v3, 5, v1
    v_mfma_f32_16x16x32_bf16 v[72:75], v[44:47], v[136:139], v[72:75]
    v_lshlrev_b32 v14, 3, v2
    v_lshl_add_u32 v122, v3, 9, v14
    s_waitcnt lgkmcnt(0)
    v_mfma_f32_16x16x32_bf16 v[48:51], v[16:19], v[144:147], v[48:51]
    ds_read_b128 v[32:35], v5 offset:24576
    v_add_u32 v133, s20, v122
    v_mfma_f32_16x16x32_bf16 v[52:55], v[16:19], v[148:151], v[52:55]
    ds_read_b128 v[36:39], v5 offset:26624
    v_add_u32 v134, 256, v133
    v_mfma_f32_16x16x32_bf16 v[60:63], v[20:23], v[148:151], v[60:63]
    ds_read_b128 v[40:43], v5 offset:28672
    v_lshlrev_b32 v14, 3, v1
    v_mfma_f32_16x16x32_bf16 v[56:59], v[20:23], v[144:147], v[56:59]
    ds_read_b128 v[44:47], v5 offset:30720
    v_add_u32 v135, s20, v14
    v_mfma_f32_16x16x32_bf16 v[64:67], v[24:27], v[144:147], v[64:67]
    s_lshl_b32 s3, s19, 8
    v_xor_b32 v123, s3, v14
    v_mul_u32_u24 v15, 320, v3
    v_mfma_f32_16x16x32_bf16 v[68:71], v[24:27], v[148:151], v[68:71]
    v_lshl_add_u32 v15, v2, 4, v15
    s_add_u32 s3, s20, 2560
    v_mfma_f32_16x16x32_bf16 v[76:79], v[28:31], v[148:151], v[76:79]
    v_add_u32 v136, s3, v15
    v_add_u32 v137, 40960, v136
    v_mfma_f32_16x16x32_bf16 v[72:75], v[28:31], v[144:147], v[72:75]
    v_lshlrev_b32 v121, 4, v1
    v_mov_b32 v132, 0xdddddddd
    s_waitcnt lgkmcnt(0)
    v_mfma_f32_16x16x32_bf16 v[48:51], v[32:35], v[152:155], v[48:51]
    s_mov_b32 s24, 0x000fffff
    ds_read_b128 v[16:19], v4 offset:32768
    s_mov_b32 s25, 0x000fffff
    v_mfma_f32_16x16x32_bf16 v[52:55], v[32:35], v[156:159], v[52:55]
    ds_read_b128 v[20:23], v4 offset:34816
    v_cmp_eq_u32 vcc, 20, v2
    v_mfma_f32_16x16x32_bf16 v[60:63], v[36:39], v[156:159], v[60:63]
    ds_read_b128 v[24:27], v4 offset:36864
    v_mov_b32 v15, 0x3f803f80
    v_mfma_f32_16x16x32_bf16 v[56:59], v[36:39], v[152:155], v[56:59]
    s_mul_i32 s21, s17, 163840
    ds_read_b128 v[28:31], v4 offset:38912
    v_cndmask_b32 v96, 0, v15, vcc
    v_mfma_f32_16x16x32_bf16 v[64:67], v[40:43], v[152:155], v[64:67]
    s_add_u32 s21, s21, 2621440
    v_mov_b32 v97, v96
    v_mov_b64 v[98:99], v[96:97]
    v_mfma_f32_16x16x32_bf16 v[68:71], v[40:43], v[156:159], v[68:71]
    v_mov_b64 v[100:101], v[96:97]
    v_mov_b64 v[102:103], v[96:97]
    v_mfma_f32_16x16x32_bf16 v[76:79], v[44:47], v[156:159], v[76:79]
    v_mov_b64 v[104:105], v[96:97]
    v_mov_b64 v[106:107], v[96:97]
    v_mfma_f32_16x16x32_bf16 v[72:75], v[44:47], v[152:155], v[72:75]
    v_mov_b64 v[108:109], v[96:97]
    v_mov_b64 v[110:111], v[96:97]
    s_waitcnt lgkmcnt(0)
    v_mfma_f32_16x16x32_bf16 v[48:51], v[16:19], v[160:163], v[48:51]
    s_mul_i32 s26, s18, 2560
    ds_read_b128 v[32:35], v5 offset:32768
    s_mul_i32 s3, s17, 81920
    v_mfma_f32_16x16x32_bf16 v[52:55], v[16:19], v[164:167], v[52:55]
    s_add_u32 s26, s26, s3
    ds_read_b128 v[36:39], v5 offset:34816
    s_lshl_b32 s3, s19, 8
    v_mfma_f32_16x16x32_bf16 v[60:63], v[20:23], v[164:167], v[60:63]
    s_add_u32 s22, s26, s3
    ds_read_b128 v[40:43], v5 offset:36864
    s_xor_b32 s3, s3, 256
    v_mfma_f32_16x16x32_bf16 v[56:59], v[20:23], v[160:163], v[56:59]
    s_add_u32 s23, s26, s3
    ds_read_b128 v[44:47], v5 offset:38912
    s_and_b32 s28, s16, 3
    v_mfma_f32_16x16x32_bf16 v[64:67], v[24:27], v[160:163], v[64:67]
    s_mul_i32 s27, s29, 0
    s_add_u32 s27, s27, s28
    s_mul_i32 s28, s28, 5120
    v_mfma_f32_16x16x32_bf16 v[68:71], v[24:27], v[164:167], v[68:71]
    s_add_u32 s28, s28, 81920
    s_add_u32 s61, s21, 81920
    s_lshl_b32 s30, s18, 1
    v_mfma_f32_16x16x32_bf16 v[76:79], v[28:31], v[164:167], v[76:79]
    s_xor_b32 s31, s19, 1
    s_add_u32 s30, s30, s31
    s_mul_i32 s37, s30, 40960
    v_mfma_f32_16x16x32_bf16 v[72:75], v[28:31], v[160:163], v[72:75]
    s_add_u32 s37, s37, 7864320
    s_lshl_b32 s36, s17, 9
    s_add_u32 s36, s36, s37
    s_waitcnt lgkmcnt(0)
    v_mfma_f32_16x16x32_bf16 v[48:51], v[32:35], v[168:171], v[48:51]
    s_lshl_b32 s3, s17, 7
    ds_read_b128 v[16:19], v8 offset:0
    s_add_u32 s37, s37, s3
    v_mfma_f32_16x16x32_bf16 v[52:55], v[32:35], v[172:175], v[52:55]
    s_add_u32 s37, s37, 16384
    ds_read_b128 v[20:23], v8 offset:2048
    s_lshr_b32 s38, s2, 5
    v_mfma_f32_16x16x32_bf16 v[60:63], v[36:39], v[172:175], v[60:63]
    s_lshl_b32 s38, s38, 12
    ds_read_b128 v[24:27], v8 offset:4096
    s_add_u32 s38, s38, s3
    v_mfma_f32_16x16x32_bf16 v[56:59], v[36:39], v[168:171], v[56:59]
    s_add_u32 s38, s38, 10551296
    ds_read_b128 v[28:31], v8 offset:6144
    s_add_u32 s39, s38, 32768
    v_mfma_f32_16x16x32_bf16 v[64:67], v[40:43], v[168:171], v[64:67]
    v_bfe_u32 v2, v1, 4, 1
    v_mul_u32_u24 v2, 20480, v2
    v_mfma_f32_16x16x32_bf16 v[68:71], v[40:43], v[172:175], v[68:71]
    v_and_b32 v3, 15, v1
    v_lshl_add_u32 v127, v3, 3, v2
    v_mfma_f32_16x16x32_bf16 v[76:79], v[44:47], v[172:175], v[76:79]
    v_lshl_add_u32 v2, v3, 4, v2
    v_lshrrev_b32 v3, 5, v1
    v_mfma_f32_16x16x32_bf16 v[72:75], v[44:47], v[168:171], v[72:75]
    v_lshl_add_u32 v126, v3, 8, v2
    s_mul_i32 s3, s16, 3072
    s_waitcnt lgkmcnt(0)
    v_mfma_f32_16x16x32_bf16 v[48:51], v[16:19], v[176:179], v[48:51]
    s_add_u32 s3, s3, 102400
    ds_read_b128 v[32:35], v9 offset:0
    v_add_u32 v128, s3, v121
    v_mfma_f32_16x16x32_bf16 v[52:55], v[16:19], v[180:183], v[52:55]
    s_xor_b32 s3, s16, 1
    ds_read_b128 v[36:39], v9 offset:2048
    s_mul_i32 s3, s3, 3072
    v_mfma_f32_16x16x32_bf16 v[60:63], v[20:23], v[180:183], v[60:63]
    s_add_u32 s3, s3, 102400
    ds_read_b128 v[40:43], v9 offset:4096
    v_add_u32 v129, s3, v121
    v_mfma_f32_16x16x32_bf16 v[56:59], v[20:23], v[176:179], v[56:59]
    ds_read_b128 v[44:47], v9 offset:6144
    v_mov_b64 v[112:113], -1
    v_mfma_f32_16x16x32_bf16 v[64:67], v[24:27], v[176:179], v[64:67]
    v_mov_b64 v[114:115], -1
    v_mov_b32 v130, 1
    v_mfma_f32_16x16x32_bf16 v[68:71], v[24:27], v[180:183], v[68:71]
    v_mov_b32 v131, 0
    s_lshr_b32 s30, s16, 2
    v_mfma_f32_16x16x32_bf16 v[76:79], v[28:31], v[180:183], v[76:79]
    s_and_b32 s31, s16, 3
    s_mul_i32 s3, s30, 51200
    v_lshrrev_b32 v2, 5, v1
    v_mfma_f32_16x16x32_bf16 v[72:75], v[28:31], v[176:179], v[72:75]
    v_bfe_u32 v3, v1, 4, 1
    v_bfe_u32 v14, v1, 2, 2
    s_waitcnt lgkmcnt(0)
    s_barrier
    v_mfma_f32_16x16x32_bf16 v[48:51], v[32:35], v[184:187], v[48:51]
    ds_read_b128 v[16:19], v8 offset:8192
    v_mul_u32_u24 v15, 20, v2
    v_mfma_f32_16x16x32_bf16 v[52:55], v[32:35], v[188:191], v[52:55]
    ds_read_b128 v[20:23], v8 offset:10240
    v_lshl_add_u32 v15, v3, 2, v15
    v_mfma_f32_16x16x32_bf16 v[60:63], v[36:39], v[188:191], v[60:63]
    ds_read_b128 v[24:27], v8 offset:12288
    v_add_u32 v15, v15, v14
    v_mfma_f32_16x16x32_bf16 v[56:59], v[36:39], v[184:187], v[56:59]
    ds_read_b128 v[28:31], v8 offset:14336
    v_mul_u32_u24 v15, 160, v15
    v_mfma_f32_16x16x32_bf16 v[64:67], v[40:43], v[184:187], v[64:67]
    v_and_b32 v2, 3, v1
    v_lshl_add_u32 v2, v2, 3, s3
    v_mfma_f32_16x16x32_bf16 v[68:71], v[40:43], v[188:191], v[68:71]
    v_add_u32 v138, v15, v2
    v_lshrrev_b32 v3, 4, v1
    v_mfma_f32_16x16x32_bf16 v[76:79], v[44:47], v[188:191], v[76:79]
    v_mul_u32_u24 v15, 20, v3
    v_add3_u32 v15, v15, 16, v14
    v_mfma_f32_16x16x32_bf16 v[72:75], v[44:47], v[184:187], v[72:75]
    v_mul_u32_u24 v15, 160, v15
    v_add_u32 v139, v15, v2
    s_waitcnt lgkmcnt(0)
    v_mfma_f32_16x16x32_bf16 v[48:51], v[16:19], v[192:195], v[48:51]
    s_mul_i32 s3, s31, 5120
    ds_read_b128 v[32:35], v9 offset:8192
    s_add_u32 s3, s3, 143360
    v_mfma_f32_16x16x32_bf16 v[52:55], v[16:19], v[196:199], v[52:55]
    ds_read_b128 v[36:39], v9 offset:10240
    v_add_u32 v140, s3, v121
    v_mfma_f32_16x16x32_bf16 v[60:63], v[20:23], v[196:199], v[60:63]
    s_mul_i32 s3, s31, 3584
    ds_read_b128 v[40:43], v9 offset:12288
    s_add_u32 s3, s3, 102400
    v_mfma_f32_16x16x32_bf16 v[56:59], v[20:23], v[192:195], v[56:59]
    ds_read_b128 v[44:47], v9 offset:14336
    v_and_b32 v2, 15, v1
    v_mfma_f32_16x16x32_bf16 v[64:67], v[24:27], v[192:195], v[64:67]
    v_mul_u32_u24 v2, 176, v2
    v_lshl_add_u32 v2, v3, 3, v2
    v_mfma_f32_16x16x32_bf16 v[68:71], v[24:27], v[196:199], v[68:71]
    v_add_u32 v141, s3, v2
    s_and_b32 s40, s2, 7
    v_mfma_f32_16x16x32_bf16 v[76:79], v[28:31], v[196:199], v[76:79]
    s_lshl_b32 s41, s40, 2
    s_bfe_u32 s30, s2, 0x20003
    s_add_u32 s41, s41, s30
    v_mfma_f32_16x16x32_bf16 v[72:75], v[28:31], v[192:195], v[72:75]
    s_lshl_b32 s40, s40, 12
    s_add_u32 s40, s40, 10551296
    s_lshl_b32 s41, s41, 2
    s_waitcnt lgkmcnt(0)
    v_mfma_f32_16x16x32_bf16 v[48:51], v[32:35], v[200:203], v[48:51]
    s_add_u32 s41, s41, s31
    ds_read_b128 v[16:19], v8 offset:16384
    s_mul_i32 s41, s41, 20480
    v_mfma_f32_16x16x32_bf16 v[52:55], v[32:35], v[204:207], v[52:55]
    ds_read_b128 v[20:23], v8 offset:18432
    v_lshrrev_b32 v2, 1, v1
    v_mfma_f32_16x16x32_bf16 v[60:63], v[36:39], v[204:207], v[60:63]
    ds_read_b128 v[24:27], v8 offset:20480
    v_lshlrev_b32 v145, 7, v2
    v_mfma_f32_16x16x32_bf16 v[56:59], v[36:39], v[200:203], v[56:59]
    ds_read_b128 v[28:31], v8 offset:22528
    v_add_u32 v2, 0, v1
    v_mfma_f32_16x16x32_bf16 v[64:67], v[40:43], v[200:203], v[64:67]
    v_mul_u32_u24 v3, 6554, v2
    v_lshrrev_b32 v3, 16, v3
    v_mfma_f32_16x16x32_bf16 v[68:71], v[40:43], v[204:207], v[68:71]
    v_mul_u32_u24 v14, 1120, v3
    v_lshl_add_u32 v116, v2, 4, v14
    v_mfma_f32_16x16x32_bf16 v[76:79], v[44:47], v[204:207], v[76:79]
    v_add_u32 v14, v2, v3
    v_lshl_add_u32 v142, v14, 4, s3
    v_mfma_f32_16x16x32_bf16 v[72:75], v[44:47], v[200:203], v[72:75]
    v_add_u32 v2, 64, v1
    v_mul_u32_u24 v3, 6554, v2
    s_waitcnt lgkmcnt(0)
    v_mfma_f32_16x16x32_bf16 v[48:51], v[16:19], v[208:211], v[48:51]
    ds_read_b128 v[32:35], v9 offset:16384
    v_lshrrev_b32 v3, 16, v3
    v_mfma_f32_16x16x32_bf16 v[52:55], v[16:19], v[212:215], v[52:55]
    ds_read_b128 v[36:39], v9 offset:18432
    v_mul_u32_u24 v14, 1120, v3
    v_mfma_f32_16x16x32_bf16 v[60:63], v[20:23], v[212:215], v[60:63]
    ds_read_b128 v[40:43], v9 offset:20480
    v_lshl_add_u32 v117, v2, 4, v14
    v_mfma_f32_16x16x32_bf16 v[56:59], v[20:23], v[208:211], v[56:59]
    ds_read_b128 v[44:47], v9 offset:22528
    v_add_u32 v14, v2, v3
    v_mfma_f32_16x16x32_bf16 v[64:67], v[24:27], v[208:211], v[64:67]
    v_lshl_add_u32 v143, v14, 4, s3
    v_add_u32 v2, 128, v1
    v_mfma_f32_16x16x32_bf16 v[68:71], v[24:27], v[212:215], v[68:71]
    v_mul_u32_u24 v3, 6554, v2
    v_lshrrev_b32 v3, 16, v3
    v_mfma_f32_16x16x32_bf16 v[76:79], v[28:31], v[212:215], v[76:79]
    v_mul_u32_u24 v14, 1120, v3
    v_lshl_add_u32 v118, v2, 4, v14
    v_mfma_f32_16x16x32_bf16 v[72:75], v[28:31], v[208:211], v[72:75]
    v_add_u32 v14, v2, v3
    v_lshl_add_u32 v144, v14, 4, s3
    s_waitcnt lgkmcnt(0)
    v_mfma_f32_16x16x32_bf16 v[48:51], v[32:35], v[216:219], v[48:51]
    ds_read_b128 v[16:19], v8 offset:24576
    v_add_u32 v2, 192, v1
    v_mfma_f32_16x16x32_bf16 v[52:55], v[32:35], v[220:223], v[52:55]
    ds_read_b128 v[20:23], v8 offset:26624
    v_mul_u32_u24 v3, 6554, v2
    v_mfma_f32_16x16x32_bf16 v[60:63], v[36:39], v[220:223], v[60:63]
    ds_read_b128 v[24:27], v8 offset:28672
    v_lshrrev_b32 v3, 16, v3
    v_mfma_f32_16x16x32_bf16 v[56:59], v[36:39], v[216:219], v[56:59]
    ds_read_b128 v[28:31], v8 offset:30720
    v_mul_u32_u24 v14, 1120, v3
    v_mfma_f32_16x16x32_bf16 v[64:67], v[40:43], v[216:219], v[64:67]
    v_lshl_add_u32 v119, v2, 4, v14
    v_add_u32 v2, 256, v1
    v_mfma_f32_16x16x32_bf16 v[68:71], v[40:43], v[220:223], v[68:71]
    v_mul_u32_u24 v3, 6554, v2
    v_lshrrev_b32 v3, 16, v3
    v_mfma_f32_16x16x32_bf16 v[76:79], v[44:47], v[220:223], v[76:79]
    v_mul_u32_u24 v14, 1120, v3
    v_lshl_add_u32 v120, v2, 4, v14
    v_mfma_f32_16x16x32_bf16 v[72:75], v[44:47], v[216:219], v[72:75]
    s_mul_i32 s30, s17, 20
    s_add_u32 s31, s30, 19
    s_lshr_b32 s30, s30, 7
    s_waitcnt lgkmcnt(0)
    v_mfma_f32_16x16x32_bf16 v[48:51], v[16:19], v[224:227], v[48:51]
    s_lshr_b32 s31, s31, 7
    ds_read_b128 v[32:35], v9 offset:24576
    s_sub_u32 s31, s31, s30
    v_mfma_f32_16x16x32_bf16 v[52:55], v[16:19], v[228:231], v[52:55]
    ds_read_b128 v[36:39], v9 offset:26624
    v_and_b32 v2, 1, v1
    v_mfma_f32_16x16x32_bf16 v[60:63], v[20:23], v[228:231], v[60:63]
    ds_read_b128 v[40:43], v9 offset:28672
    v_mul_u32_u24 v2, s31, v2
    v_mfma_f32_16x16x32_bf16 v[56:59], v[20:23], v[224:227], v[56:59]
    ds_read_b128 v[44:47], v9 offset:30720
    v_add_u32 v2, s30, v2
    v_mfma_f32_16x16x32_bf16 v[64:67], v[24:27], v[224:227], v[64:67]
    v_lshrrev_b32 v14, 5, v1
    v_mul_u32_u24 v3, 5, v14
    v_mfma_f32_16x16x32_bf16 v[68:71], v[24:27], v[228:231], v[68:71]
    v_add3_u32 v3, v2, v3, 5
    v_bfe_u32 v15, v1, 1, 4
    v_mfma_f32_16x16x32_bf16 v[76:79], v[28:31], v[228:231], v[76:79]
    v_lshl_add_u32 v3, v3, 4, v15
    v_lshlrev_b32 v124, 7, v3
    v_mfma_f32_16x16x32_bf16 v[72:75], v[28:31], v[224:227], v[72:75]
    v_bfe_u32 v2, v1, 4, 1
    v_mul_u32_u24 v2, s31, v2
    s_waitcnt lgkmcnt(0)
    v_mfma_f32_16x16x32_bf16 v[48:51], v[32:35], v[232:235], v[48:51]
    ds_read_b128 v[16:19], v8 offset:32768
    v_add_u32 v2, s30, v2
    v_mfma_f32_16x16x32_bf16 v[52:55], v[32:35], v[236:239], v[52:55]
    s_lshr_b32 s3, s2, 5
    ds_read_b128 v[20:23], v8 offset:34816
    s_lshl_b32 s3, s3, 1
    v_mfma_f32_16x16x32_bf16 v[60:63], v[36:39], v[236:239], v[60:63]
    ds_read_b128 v[24:27], v8 offset:36864
    v_lshl_add_u32 v2, v2, 4, v14
    v_mfma_f32_16x16x32_bf16 v[56:59], v[36:39], v[232:235], v[56:59]
    ds_read_b128 v[28:31], v8 offset:38912
    v_add_u32 v2, s3, v2
    v_mfma_f32_16x16x32_bf16 v[64:67], v[40:43], v[232:235], v[64:67]
    v_lshlrev_b32 v125, 7, v2
    s_mov_b32 s33, 10485760
    v_mfma_f32_16x16x32_bf16 v[68:71], v[40:43], v[236:239], v[68:71]
    v_mov_b64 v[146:147], 0
    v_mov_b64 v[148:149], 0
    v_mfma_f32_16x16x32_bf16 v[76:79], v[44:47], v[236:239], v[76:79]
    v_mov_b64 v[150:151], 0
    v_mov_b64 v[152:153], 0
    v_mfma_f32_16x16x32_bf16 v[72:75], v[44:47], v[232:235], v[72:75]
    v_mov_b64 v[154:155], 0
    v_mov_b64 v[156:157], 0
    s_waitcnt lgkmcnt(0)
    v_mfma_f32_16x16x32_bf16 v[48:51], v[16:19], v[240:243], v[48:51]
    ds_read_b128 v[32:35], v9 offset:32768
    v_mov_b64 v[158:159], 0
    v_mfma_f32_16x16x32_bf16 v[52:55], v[16:19], v[244:247], v[52:55]
    ds_read_b128 v[36:39], v9 offset:34816
    v_mov_b64 v[160:161], 0
    v_mfma_f32_16x16x32_bf16 v[60:63], v[20:23], v[244:247], v[60:63]
    ds_read_b128 v[40:43], v9 offset:36864
    v_mov_b64 v[162:163], 0
    v_mfma_f32_16x16x32_bf16 v[56:59], v[20:23], v[240:243], v[56:59]
    ds_read_b128 v[44:47], v9 offset:38912
    v_mov_b64 v[164:165], 0
    v_mfma_f32_16x16x32_bf16 v[64:67], v[24:27], v[240:243], v[64:67]
    v_mov_b64 v[166:167], 0
    v_mov_b64 v[168:169], 0
    v_mfma_f32_16x16x32_bf16 v[68:71], v[24:27], v[244:247], v[68:71]
    v_mov_b64 v[170:171], 0
    v_mov_b64 v[172:173], 0
    v_mfma_f32_16x16x32_bf16 v[76:79], v[28:31], v[244:247], v[76:79]
    v_mov_b64 v[174:175], 0
    v_mov_b64 v[176:177], 0
    v_mfma_f32_16x16x32_bf16 v[72:75], v[28:31], v[240:243], v[72:75]
    s_waitcnt lgkmcnt(0)
    v_mfma_f32_16x16x32_bf16 v[48:51], v[32:35], v[248:251], v[48:51]
    v_mfma_f32_16x16x32_bf16 v[52:55], v[32:35], v[252:255], v[52:55]
    v_mfma_f32_16x16x32_bf16 v[60:63], v[36:39], v[252:255], v[60:63]
    v_mfma_f32_16x16x32_bf16 v[56:59], v[36:39], v[248:251], v[56:59]
    v_mfma_f32_16x16x32_bf16 v[64:67], v[40:43], v[248:251], v[64:67]
    v_mfma_f32_16x16x32_bf16 v[68:71], v[40:43], v[252:255], v[68:71]
    v_mfma_f32_16x16x32_bf16 v[76:79], v[44:47], v[252:255], v[76:79]
    v_mfma_f32_16x16x32_bf16 v[72:75], v[44:47], v[248:251], v[72:75]
    s_nop 1
    s_nop 2
    v_cvt_pk_bf16_f32 v80, v48, v49
    v_cvt_pk_bf16_f32 v81, v50, v51
    v_cvt_pk_bf16_f32 v82, v56, v57
    v_cvt_pk_bf16_f32 v83, v58, v59
    v_cvt_pk_bf16_f32 v84, v52, v53
    v_cvt_pk_bf16_f32 v85, v54, v55
    v_cvt_pk_bf16_f32 v86, v60, v61
    v_cvt_pk_bf16_f32 v87, v62, v63
    v_cvt_pk_bf16_f32 v88, v64, v65
    v_cvt_pk_bf16_f32 v89, v66, v67
    v_cvt_pk_bf16_f32 v90, v72, v73
    v_cvt_pk_bf16_f32 v91, v74, v75
    v_cvt_pk_bf16_f32 v92, v68, v69
    v_cvt_pk_bf16_f32 v93, v70, v71
    v_cvt_pk_bf16_f32 v94, v76, v77
    v_cvt_pk_bf16_f32 v95, v78, v79
    s_barrier
L_end_v:
    buffer_store_dwordx4 v[80:83], v12, s[44:47], s62 offen offset:0 sc1
    buffer_store_dwordx4 v[84:87], v13, s[44:47], s62 offen offset:0 sc1
    buffer_store_dwordx4 v[88:91], v12, s[44:47], s62 offen offset:1280 sc1
    buffer_store_dwordx4 v[92:95], v13, s[44:47], s62 offen offset:1280 sc1
    s_mov_b32 s63, 1
    s_branch L_late_st
.p2align 12
L_late_st:
    s_setprio 3
    v_mov_b32 v11, 163824
    ds_write_b32 v11, v131
    s_barrier
    s_add_u32 s3, s27, 8
    s_and_b32 s3, s3, 15
    s_mul_i32 s3, s3, 5120
    s_sub_u32 s3, s3, 81920
    s_add_u32 m0, s28, 4294926336
    s_add_u32 s29, s61, s3
    buffer_load_dwordx4 v121, s[44:47], s29 offen sc1 lds
    buffer_load_dwordx4 v121, s[44:47], s29 offen offset:1024 sc1 lds
    buffer_load_dwordx4 v121, s[44:47], s29 offen offset:2048 sc1 lds
    buffer_load_dwordx4 v121, s[44:47], s29 offen offset:3072 sc1 lds
    s_add_u32 m0, s28, 4294930432
    s_add_u32 s29, s29, 4096
    buffer_load_dwordx4 v121, s[44:47], s29 offen sc1 lds
    s_waitcnt vmcnt(5)
    s_cmp_eq_u32 s63, 0
    s_cbranch_scc1 L_late_nofl
    s_add_u32 s6, s42, s60
    s_addc_u32 s7, s43, 0
    s_mov_b32 s5, 1
    s_atomic_add s5, s[6:7], 0x0 glc
L_late_nofl:
    s_add_u32 s3, s27, 12
    s_and_b32 s3, s3, 15
    s_mul_i32 s3, s3, 5120
    s_sub_u32 s3, s3, 81920
    s_add_u32 m0, s28, 4294946816
    s_add_u32 s29, s61, s3
    buffer_load_dwordx4 v121, s[44:47], s29 offen sc1 lds
    buffer_load_dwordx4 v121, s[44:47], s29 offen offset:1024 sc1 lds
    buffer_load_dwordx4 v121, s[44:47], s29 offen offset:2048 sc1 lds
    buffer_load_dwordx4 v121, s[44:47], s29 offen offset:3072 sc1 lds
    s_add_u32 m0, s28, 4294950912
    s_add_u32 s29, s29, 4096
    buffer_load_dwordx4 v121, s[44:47], s29 offen sc1 lds
    s_waitcnt vmcnt(0) lgkmcnt(0)
    s_barrier
    s_mov_b32 s35, 0
    v_mov_b32 v7, 1
    s_cmp_eq_u32 s16, 0
    s_cbranch_scc0 L_gwl
    s_mov_b32 s35, 0
L_poll1l:
    buffer_load_dword v5, v124, s[44:47], s33 offen sc1
    buffer_load_dword v3, v125, s[44:47], s33 offen sc1
L_poll1l_chk:
    s_waitcnt vmcnt(0)
    v_min_u32 v2, v5, v3
    v_cmp_eq_u32 vcc, 4, v2
    s_nop 0
    s_cmp_eq_u64 vcc, -1
    s_cselect_b32 s35, 1048576, s35
    s_add_u32 s35, s35, 1
    s_cmp_lt_u32 s35, 1048576
    s_cbranch_scc1 L_poll1l
L_poll1l_ok:
    ds_write_b32 v11, v7
    s_branch L_gwl_ok
L_gwl:
    s_sleep 3
    ds_read_b32 v7, v11
    s_waitcnt lgkmcnt(0)
    v_readfirstlane_b32 s34, v7
    s_cmp_lg_u32 s34, 0
    s_cselect_b32 s35, 4194304, s35
    s_add_u32 s35, s35, 1
    s_cmp_lt_u32 s35, 4194304
    s_cbranch_scc1 L_gwl
L_gwl_ok:
    s_add_u32 s3, s27, 0
    s_and_b32 s3, s3, 15
    s_mul_i32 s3, s3, 5120
    s_add_u32 m0, s28, 0
    s_add_u32 s29, s61, s3
    buffer_load_dwordx4 v121, s[44:47], s29 offen sc1 lds
    buffer_load_dwordx4 v121, s[44:47], s29 offen offset:1024 sc1 lds
    buffer_load_dwordx4 v121, s[44:47], s29 offen offset:2048 sc1 lds
    buffer_load_dwordx4 v121, s[44:47], s29 offen offset:3072 sc1 lds
    s_add_u32 m0, s28, 4096
    s_add_u32 s29, s29, 4096
    buffer_load_dwordx4 v121, s[44:47], s29 offen sc1 lds
    buffer_load_dwordx2 v[250:251], v123, s[44:47], s26 offen offset:2048 sc1
    buffer_load_dwordx2 v[242:243], v122, s[44:47], s22 offen sc1
    buffer_load_dwordx2 v[244:245], v122, s[44:47], s22 offen offset:1024 sc1
    buffer_load_dwordx2 v[246:247], v122, s[44:47], s23 offen sc1
    buffer_load_dwordx2 v[248:249], v122, s[44:47], s23 offen offset:1024 sc1
    s_waitcnt vmcnt(5) lgkmcnt(0)
    s_waitcnt vmcnt(0)
    ds_read2st64_b64 v[24:27], v135 offset0:4 offset1:24
    ds_read2st64_b64 v[16:19], v133 offset0:0 offset1:2
    ds_read2st64_b64 v[20:23], v134 offset0:0 offset1:2
    s_mov_b64 exec, s[24:25]
    ds_read_b128 v[96:99], v136 offset:0
    ds_read_b128 v[100:103], v136 offset:640
    s_mov_b64 exec, -1
    s_lshr_b32 s3, s2, 5
    s_mul_i32 s30, s3, 160
    s_mul_i32 s3, s16, 40960
    s_add_u32 s30, s30, s3
    s_mul_i32 s32, s16, 5120
    s_waitcnt lgkmcnt(4)
    v_mfma_f32_32x32x4_2b_bf16 v[178:209], v[24:25], v[250:251], 0 cbsz:1 abid:0
    s_nop 15
    s_nop 1
    s_waitcnt lgkmcnt(3)
    v_mfma_f32_32x32x16_bf16 v[178:193], v[16:19], v[242:245], v[178:193]
    v_mfma_f32_32x32x16_bf16 v[194:209], v[16:19], v[246:249], v[194:209]
    s_nop 10
.p2align 3
    v_exp_f32 v178, v178
    v_exp_f32 v179, v179
    s_waitcnt lgkmcnt(0)
    s_barrier
    s_setprio 2
    s_nop 0
    ds_read2st64_b64 v[16:19], v133 offset0:20 offset1:22
    v_exp_f32 v180, v180
    v_exp_f32 v181, v181
    v_exp_f32 v182, v182
    v_exp_f32 v183, v183
    v_mfma_f32_32x32x4_2b_bf16 v[210:241], v[24:25], v[250:251], 0 cbsz:1 abid:1
    v_exp_f32 v184, v184
    v_exp_f32 v185, v185
    v_exp_f32 v186, v186
    v_exp_f32 v187, v187
    v_exp_f32 v188, v188
    v_exp_f32 v189, v189
    v_exp_f32 v190, v190
    v_exp_f32 v191, v191
    v_smfmac_f32_32x32x32_bf16 v[146:161], v[96:99], v[178:185], v132
    s_mov_b64 exec, s[24:25]
    ds_read_b128 v[104:107], v136 offset:1280
    s_mov_b64 exec, -1
    v_exp_f32 v192, v192
    v_exp_f32 v193, v193
    v_exp_f32 v194, v194
    v_exp_f32 v195, v195
    v_smfmac_f32_32x32x32_bf16 v[146:161], v[100:103], v[186:193], v132
    s_mov_b64 exec, s[24:25]
    ds_read_b128 v[108:111], v136 offset:1920
    s_mov_b64 exec, -1
    v_exp_f32 v196, v196
    v_exp_f32 v197, v197
    v_exp_f32 v198, v198
    v_exp_f32 v199, v199
    v_mfma_f32_32x32x16_bf16 v[210:225], v[20:23], v[242:245], v[210:225]
    s_add_u32 s3, s27, 4
    s_and_b32 s3, s3, 15
    s_mul_i32 s3, s3, 5120
    s_add_u32 m0, s28, 20480
    s_add_u32 s29, s61, s3
    buffer_load_dwordx4 v121, s[44:47], s29 offen sc1 lds
    v_exp_f32 v200, v200
    v_exp_f32 v201, v201
    v_exp_f32 v202, v202
    v_exp_f32 v203, v203
    v_smfmac_f32_32x32x32_bf16 v[162:177], v[96:99], v[194:201], v132
    buffer_load_dwordx4 v121, s[44:47], s29 offen offset:1024 sc1 lds
    v_exp_f32 v204, v204
    v_exp_f32 v205, v205
    v_exp_f32 v206, v206
    v_exp_f32 v207, v207
    v_mfma_f32_32x32x16_bf16 v[226:241], v[20:23], v[246:249], v[226:241]
    v_exp_f32 v208, v208
    v_exp_f32 v209, v209
    v_exp_f32 v210, v210
    v_exp_f32 v211, v211
    v_smfmac_f32_32x32x32_bf16 v[162:177], v[100:103], v[202:209], v132
    s_waitcnt lgkmcnt(0)
    s_nop 0
    ds_read2st64_b64 v[20:23], v134 offset0:20 offset1:22
    v_exp_f32 v212, v212
    v_exp_f32 v213, v213
    v_exp_f32 v214, v214
    v_exp_f32 v215, v215
    v_mfma_f32_32x32x4_2b_bf16 v[178:209], v[26:27], v[250:251], 0 cbsz:1 abid:0
    v_exp_f32 v216, v216
    v_exp_f32 v217, v217
    v_exp_f32 v218, v218
    v_exp_f32 v219, v219
    v_exp_f32 v220, v220
    v_exp_f32 v221, v221
    v_exp_f32 v222, v222
    v_exp_f32 v223, v223
    v_smfmac_f32_32x32x32_bf16 v[146:161], v[104:107], v[210:217], v132
    s_mov_b64 exec, s[24:25]
    ds_read_b128 v[96:99], v136 offset:10240
    s_mov_b64 exec, -1
    v_exp_f32 v224, v224
    v_exp_f32 v225, v225
    v_exp_f32 v226, v226
    v_exp_f32 v227, v227
    v_smfmac_f32_32x32x32_bf16 v[146:161], v[108:111], v[218:225], v132
    s_mov_b64 exec, s[24:25]
    ds_read_b128 v[100:103], v136 offset:10880
    s_mov_b64 exec, -1
    v_exp_f32 v228, v228
    v_exp_f32 v229, v229
    v_exp_f32 v230, v230
    v_exp_f32 v231, v231
    v_mfma_f32_32x32x16_bf16 v[178:193], v[16:19], v[242:245], v[178:193]
    buffer_load_dwordx4 v121, s[44:47], s29 offen offset:2048 sc1 lds
    v_exp_f32 v232, v232
    v_exp_f32 v233, v233
    v_exp_f32 v234, v234
    v_exp_f32 v235, v235
    v_smfmac_f32_32x32x32_bf16 v[162:177], v[104:107], v[226:233], v132
    buffer_load_dwordx4 v121, s[44:47], s29 offen offset:3072 sc1 lds
    v_exp_f32 v236, v236
    v_exp_f32 v237, v237
    v_exp_f32 v238, v238
    v_exp_f32 v239, v239
    v_mfma_f32_32x32x16_bf16 v[194:209], v[16:19], v[246:249], v[194:209]
    v_exp_f32 v240, v240
    v_exp_f32 v241, v241
    v_exp_f32 v178, v178
    v_exp_f32 v179, v179
    v_smfmac_f32_32x32x32_bf16 v[162:177], v[108:111], v[234:241], v132
    s_waitcnt lgkmcnt(0)
    s_nop 0
    ds_read2st64_b64 v[16:19], v133 offset0:40 offset1:42
    v_exp_f32 v180, v180
    v_exp_f32 v181, v181
    v_exp_f32 v182, v182
    v_exp_f32 v183, v183
    v_mfma_f32_32x32x4_2b_bf16 v[210:241], v[26:27], v[250:251], 0 cbsz:1 abid:1
    v_exp_f32 v184, v184
    v_exp_f32 v185, v185
    v_exp_f32 v186, v186
    v_exp_f32 v187, v187
    v_exp_f32 v188, v188
    v_exp_f32 v189, v189
    v_exp_f32 v190, v190
    v_exp_f32 v191, v191
    v_smfmac_f32_32x32x32_bf16 v[146:161], v[96:99], v[178:185], v132
    s_mov_b64 exec, s[24:25]
    ds_read_b128 v[104:107], v136 offset:11520
    s_mov_b64 exec, -1
    v_exp_f32 v192, v192
    v_exp_f32 v193, v193
    v_exp_f32 v194, v194
    v_exp_f32 v195, v195
    v_smfmac_f32_32x32x32_bf16 v[146:161], v[100:103], v[186:193], v132
    s_mov_b64 exec, s[24:25]
    ds_read_b128 v[108:111], v136 offset:12160
    s_mov_b64 exec, -1
    v_exp_f32 v196, v196
    v_exp_f32 v197, v197
    v_exp_f32 v198, v198
    v_exp_f32 v199, v199
    v_mfma_f32_32x32x16_bf16 v[210:225], v[20:23], v[242:245], v[210:225]
    s_add_u32 m0, s28, 24576
    s_add_u32 s29, s29, 4096
    buffer_load_dwordx4 v121, s[44:47], s29 offen sc1 lds
    v_exp_f32 v200, v200
    v_exp_f32 v201, v201
    v_exp_f32 v202, v202
    v_exp_f32 v203, v203
    v_smfmac_f32_32x32x32_bf16 v[162:177], v[96:99], v[194:201], v132
    ds_read2st64_b64 v[28:31], v135 offset0:44 offset1:64
    s_add_u32 s3, s27, 8
    s_and_b32 s3, s3, 15
    s_mul_i32 s3, s3, 5120
    s_add_u32 m0, s28, 40960
    s_add_u32 s29, s61, s3
    buffer_load_dwordx4 v121, s[44:47], s29 offen sc1 lds
    v_exp_f32 v204, v204
    v_exp_f32 v205, v205
    v_exp_f32 v206, v206
    v_exp_f32 v207, v207
    v_mfma_f32_32x32x16_bf16 v[226:241], v[20:23], v[246:249], v[226:241]
    v_exp_f32 v208, v208
    v_exp_f32 v209, v209
    v_exp_f32 v210, v210
    v_exp_f32 v211, v211
    v_smfmac_f32_32x32x32_bf16 v[162:177], v[100:103], v[202:209], v132
    s_waitcnt lgkmcnt(0)
    s_nop 0
    ds_read2st64_b64 v[20:23], v134 offset0:40 offset1:42
    v_exp_f32 v212, v212
    v_exp_f32 v213, v213
    v_exp_f32 v214, v214
    v_exp_f32 v215, v215
    v_mfma_f32_32x32x4_2b_bf16 v[178:209], v[28:29], v[250:251], 0 cbsz:1 abid:0
    v_exp_f32 v216, v216
    v_exp_f32 v217, v217
    v_exp_f32 v218, v218
    v_exp_f32 v219, v219
    v_exp_f32 v220, v220
    v_exp_f32 v221, v221
    v_exp_f32 v222, v222
    v_exp_f32 v223, v223
    v_smfmac_f32_32x32x32_bf16 v[146:161], v[104:107], v[210:217], v132
    s_mov_b64 exec, s[24:25]
    ds_read_b128 v[96:99], v136 offset:20480
    s_mov_b64 exec, -1
    v_exp_f32 v224, v224
    v_exp_f32 v225, v225
    v_exp_f32 v226, v226
    v_exp_f32 v227, v227
    v_smfmac_f32_32x32x32_bf16 v[146:161], v[108:111], v[218:225], v132
    s_mov_b64 exec, s[24:25]
    ds_read_b128 v[100:103], v136 offset:21120
    s_mov_b64 exec, -1
    v_exp_f32 v228, v228
    v_exp_f32 v229, v229
    v_exp_f32 v230, v230
    v_exp_f32 v231, v231
    v_mfma_f32_32x32x16_bf16 v[178:193], v[16:19], v[242:245], v[178:193]
    buffer_load_dwordx4 v121, s[44:47], s29 offen offset:1024 sc1 lds
    v_exp_f32 v232, v232
    v_exp_f32 v233, v233
    v_exp_f32 v234, v234
    v_exp_f32 v235, v235
    v_smfmac_f32_32x32x32_bf16 v[162:177], v[104:107], v[226:233], v132
    buffer_load_dwordx4 v121, s[44:47], s29 offen offset:2048 sc1 lds
    v_exp_f32 v236, v236
    v_exp_f32 v237, v237
    v_exp_f32 v238, v238
    v_exp_f32 v239, v239
    v_mfma_f32_32x32x16_bf16 v[194:209], v[16:19], v[246:249], v[194:209]
    v_exp_f32 v240, v240
    v_exp_f32 v241, v241
    v_exp_f32 v178, v178
    v_exp_f32 v179, v179
    v_smfmac_f32_32x32x32_bf16 v[162:177], v[108:111], v[234:241], v132
    s_waitcnt lgkmcnt(0)
    s_nop 0
    ds_read2st64_b64 v[16:19], v133 offset0:60 offset1:62
    v_exp_f32 v180, v180
    v_exp_f32 v181, v181
    v_exp_f32 v182, v182
    v_exp_f32 v183, v183
    v_mfma_f32_32x32x4_2b_bf16 v[210:241], v[28:29], v[250:251], 0 cbsz:1 abid:1
    v_exp_f32 v184, v184
    v_exp_f32 v185, v185
    v_exp_f32 v186, v186
    v_exp_f32 v187, v187
    v_exp_f32 v188, v188
    v_exp_f32 v189, v189
    v_exp_f32 v190, v190
    v_exp_f32 v191, v191
    v_smfmac_f32_32x32x32_bf16 v[146:161], v[96:99], v[178:185], v132
    s_mov_b64 exec, s[24:25]
    ds_read_b128 v[104:107], v136 offset:21760
    s_mov_b64 exec, -1
    v_exp_f32 v192, v192
    v_exp_f32 v193, v193
    v_exp_f32 v194, v194
    v_exp_f32 v195, v195
    v_smfmac_f32_32x32x32_bf16 v[146:161], v[100:103], v[186:193], v132
    s_mov_b64 exec, s[24:25]
    ds_read_b128 v[108:111], v136 offset:22400
    s_mov_b64 exec, -1
    v_exp_f32 v196, v196
    v_exp_f32 v197, v197
    v_exp_f32 v198, v198
    v_exp_f32 v199, v199
    v_mfma_f32_32x32x16_bf16 v[210:225], v[20:23], v[242:245], v[210:225]
    buffer_load_dwordx4 v121, s[44:47], s29 offen offset:3072 sc1 lds
    v_exp_f32 v200, v200
    v_exp_f32 v201, v201
    v_exp_f32 v202, v202
    v_exp_f32 v203, v203
    v_smfmac_f32_32x32x32_bf16 v[162:177], v[96:99], v[194:201], v132
    s_add_u32 m0, s28, 45056
    s_add_u32 s29, s29, 4096
    buffer_load_dwordx4 v121, s[44:47], s29 offen sc1 lds
    v_exp_f32 v204, v204
    v_exp_f32 v205, v205
    v_exp_f32 v206, v206
    v_exp_f32 v207, v207
    v_mfma_f32_32x32x16_bf16 v[226:241], v[20:23], v[246:249], v[226:241]
    v_exp_f32 v208, v208
    v_exp_f32 v209, v209
    v_exp_f32 v210, v210
    v_exp_f32 v211, v211
    v_smfmac_f32_32x32x32_bf16 v[162:177], v[100:103], v[202:209], v132
    s_waitcnt lgkmcnt(0)
    s_nop 0
    ds_read2st64_b64 v[20:23], v134 offset0:60 offset1:62
    v_exp_f32 v212, v212
    v_exp_f32 v213, v213
    v_exp_f32 v214, v214
    v_exp_f32 v215, v215
    v_mfma_f32_32x32x4_2b_bf16 v[178:209], v[30:31], v[250:251], 0 cbsz:1 abid:0
    v_exp_f32 v216, v216
    v_exp_f32 v217, v217
    v_exp_f32 v218, v218
    v_exp_f32 v219, v219
    v_exp_f32 v220, v220
    v_exp_f32 v221, v221
    v_exp_f32 v222, v222
    v_exp_f32 v223, v223
    v_smfmac_f32_32x32x32_bf16 v[146:161], v[104:107], v[210:217], v132
    s_mov_b64 exec, s[24:25]
    ds_read_b128 v[96:99], v136 offset:30720
    s_mov_b64 exec, -1
    v_exp_f32 v224, v224
    v_exp_f32 v225, v225
    v_exp_f32 v226, v226
    v_exp_f32 v227, v227
    v_smfmac_f32_32x32x32_bf16 v[146:161], v[108:111], v[218:225], v132
    s_mov_b64 exec, s[24:25]
    ds_read_b128 v[100:103], v136 offset:31360
    s_mov_b64 exec, -1
    v_exp_f32 v228, v228
    v_exp_f32 v229, v229
    v_exp_f32 v230, v230
    v_exp_f32 v231, v231
    v_mfma_f32_32x32x16_bf16 v[178:193], v[16:19], v[242:245], v[178:193]
    s_add_u32 s3, s27, 12
    s_and_b32 s3, s3, 15
    s_mul_i32 s3, s3, 5120
    s_add_u32 m0, s28, 61440
    s_add_u32 s29, s61, s3
    buffer_load_dwordx4 v121, s[44:47], s29 offen sc1 lds
    v_exp_f32 v232, v232
    v_exp_f32 v233, v233
    v_exp_f32 v234, v234
    v_exp_f32 v235, v235
    v_smfmac_f32_32x32x32_bf16 v[162:177], v[104:107], v[226:233], v132
    buffer_load_dwordx4 v121, s[44:47], s29 offen offset:1024 sc1 lds
    v_exp_f32 v236, v236
    v_exp_f32 v237, v237
    v_exp_f32 v238, v238
    v_exp_f32 v239, v239
    v_mfma_f32_32x32x16_bf16 v[194:209], v[16:19], v[246:249], v[194:209]
    v_exp_f32 v240, v240
    v_exp_f32 v241, v241
    v_exp_f32 v178, v178
    v_exp_f32 v179, v179
    v_smfmac_f32_32x32x32_bf16 v[162:177], v[108:111], v[234:241], v132
    s_waitcnt lgkmcnt(0)
    s_nop 0
    ds_read2st64_b64 v[16:19], v133 offset0:80 offset1:82
    v_exp_f32 v180, v180
    v_exp_f32 v181, v181
    v_exp_f32 v182, v182
    v_exp_f32 v183, v183
    v_mfma_f32_32x32x4_2b_bf16 v[210:241], v[30:31], v[250:251], 0 cbsz:1 abid:1
    v_exp_f32 v184, v184
    v_exp_f32 v185, v185
    v_exp_f32 v186, v186
    v_exp_f32 v187, v187
    v_exp_f32 v188, v188
    v_exp_f32 v189, v189
    v_exp_f32 v190, v190
    v_exp_f32 v191, v191
    v_smfmac_f32_32x32x32_bf16 v[146:161], v[96:99], v[178:185], v132
    s_mov_b64 exec, s[24:25]
    ds_read_b128 v[104:107], v136 offset:32000
    s_mov_b64 exec, -1
    v_exp_f32 v192, v192
    v_exp_f32 v193, v193
    v_exp_f32 v194, v194
    v_exp_f32 v195, v195
    v_smfmac_f32_32x32x32_bf16 v[146:161], v[100:103], v[186:193], v132
    s_mov_b64 exec, s[24:25]
    ds_read_b128 v[108:111], v136 offset:32640
    s_mov_b64 exec, -1
    v_exp_f32 v196, v196
    v_exp_f32 v197, v197
    v_exp_f32 v198, v198
    v_exp_f32 v199, v199
    v_mfma_f32_32x32x16_bf16 v[210:225], v[20:23], v[242:245], v[210:225]
    buffer_load_dwordx4 v121, s[44:47], s29 offen offset:2048 sc1 lds
    v_exp_f32 v200, v200
    v_exp_f32 v201, v201
    v_exp_f32 v202, v202
    v_exp_f32 v203, v203
    v_smfmac_f32_32x32x32_bf16 v[162:177], v[96:99], v[194:201], v132
    ds_read2st64_b64 v[24:27], v135 offset0:84 offset1:104
    buffer_load_dwordx4 v121, s[44:47], s29 offen offset:3072 sc1 lds
    v_exp_f32 v204, v204
    v_exp_f32 v205, v205
    v_exp_f32 v206, v206
    v_exp_f32 v207, v207
    v_mfma_f32_32x32x16_bf16 v[226:241], v[20:23], v[246:249], v[226:241]
    v_exp_f32 v208, v208
    v_exp_f32 v209, v209
    v_exp_f32 v210, v210
    v_exp_f32 v211, v211
    v_smfmac_f32_32x32x32_bf16 v[162:177], v[100:103], v[202:209], v132
    s_waitcnt lgkmcnt(0)
    s_nop 0
    ds_read2st64_b64 v[20:23], v134 offset0:80 offset1:82
    v_exp_f32 v212, v212
    v_exp_f32 v213, v213
    v_exp_f32 v214, v214
    v_exp_f32 v215, v215
    v_mfma_f32_32x32x4_2b_bf16 v[178:209], v[24:25], v[250:251], 0 cbsz:1 abid:0
    v_exp_f32 v216, v216
    v_exp_f32 v217, v217
    v_exp_f32 v218, v218
    v_exp_f32 v219, v219
    v_exp_f32 v220, v220
    v_exp_f32 v221, v221
    v_exp_f32 v222, v222
    v_exp_f32 v223, v223
    v_smfmac_f32_32x32x32_bf16 v[146:161], v[104:107], v[210:217], v132
    s_mov_b64 exec, s[24:25]
    ds_read_b128 v[96:99], v137 offset:0
    s_mov_b64 exec, -1
    v_exp_f32 v224, v224
    v_exp_f32 v225, v225
    v_exp_f32 v226, v226
    v_exp_f32 v227, v227
    v_smfmac_f32_32x32x32_bf16 v[146:161], v[108:111], v[218:225], v132
    s_mov_b64 exec, s[24:25]
    ds_read_b128 v[100:103], v137 offset:640
    s_mov_b64 exec, -1
    v_exp_f32 v228, v228
    v_exp_f32 v229, v229
    v_exp_f32 v230, v230
    v_exp_f32 v231, v231
    v_mfma_f32_32x32x16_bf16 v[178:193], v[16:19], v[242:245], v[178:193]
    s_add_u32 m0, s28, 65536
    s_add_u32 s29, s29, 4096
    buffer_load_dwordx4 v121, s[44:47], s29 offen sc1 lds
    v_exp_f32 v232, v232
    v_exp_f32 v233, v233
    v_exp_f32 v234, v234
    v_exp_f32 v235, v235
    v_smfmac_f32_32x32x32_bf16 v[162:177], v[104:107], v[226:233], v132
    v_exp_f32 v236, v236
    v_exp_f32 v237, v237
    v_exp_f32 v238, v238
    v_exp_f32 v239, v239
    v_mfma_f32_32x32x16_bf16 v[194:209], v[16:19], v[246:249], v[194:209]
    v_exp_f32 v240, v240
    v_exp_f32 v241, v241
    v_exp_f32 v178, v178
    v_exp_f32 v179, v179
    v_smfmac_f32_32x32x32_bf16 v[162:177], v[108:111], v[234:241], v132
    s_waitcnt lgkmcnt(0)
    s_nop 0
    ds_read2st64_b64 v[16:19], v133 offset0:100 offset1:102
    v_exp_f32 v180, v180
    v_exp_f32 v181, v181
    v_exp_f32 v182, v182
    v_exp_f32 v183, v183
    v_mfma_f32_32x32x4_2b_bf16 v[210:241], v[24:25], v[250:251], 0 cbsz:1 abid:1
    v_exp_f32 v184, v184
    v_exp_f32 v185, v185
    v_exp_f32 v186, v186
    v_exp_f32 v187, v187
    v_exp_f32 v188, v188
    v_exp_f32 v189, v189
    v_exp_f32 v190, v190
    v_exp_f32 v191, v191
    v_smfmac_f32_32x32x32_bf16 v[146:161], v[96:99], v[178:185], v132
    s_mov_b64 exec, s[24:25]
    ds_read_b128 v[104:107], v137 offset:1280
    s_mov_b64 exec, -1
    v_exp_f32 v192, v192
    v_exp_f32 v193, v193
    v_exp_f32 v194, v194
    v_exp_f32 v195, v195
    v_smfmac_f32_32x32x32_bf16 v[146:161], v[100:103], v[186:193], v132
    s_mov_b64 exec, s[24:25]
    ds_read_b128 v[108:111], v137 offset:1920
    s_mov_b64 exec, -1
    v_exp_f32 v196, v196
    v_exp_f32 v197, v197
    v_exp_f32 v198, v198
    v_exp_f32 v199, v199
    v_mfma_f32_32x32x16_bf16 v[210:225], v[20:23], v[242:245], v[210:225]
    v_exp_f32 v200, v200
    v_exp_f32 v201, v201
    v_exp_f32 v202, v202
    v_exp_f32 v203, v203
    v_smfmac_f32_32x32x32_bf16 v[162:177], v[96:99], v[194:201], v132
    v_exp_f32 v204, v204
    v_exp_f32 v205, v205
    v_exp_f32 v206, v206
    v_exp_f32 v207, v207
    v_mfma_f32_32x32x16_bf16 v[226:241], v[20:23], v[246:249], v[226:241]
    v_exp_f32 v208, v208
    v_exp_f32 v209, v209
    v_exp_f32 v210, v210
    v_exp_f32 v211, v211
    v_smfmac_f32_32x32x32_bf16 v[162:177], v[100:103], v[202:209], v132
    s_waitcnt lgkmcnt(0)
    s_nop 0
    ds_read2st64_b64 v[20:23], v134 offset0:100 offset1:102
    v_exp_f32 v212, v212
    v_exp_f32 v213, v213
    v_exp_f32 v214, v214
    v_exp_f32 v215, v215
    v_mfma_f32_32x32x4_2b_bf16 v[178:209], v[26:27], v[250:251], 0 cbsz:1 abid:0
    v_exp_f32 v216, v216
    v_exp_f32 v217, v217
    v_exp_f32 v218, v218
    v_exp_f32 v219, v219
    v_exp_f32 v220, v220
    v_exp_f32 v221, v221
    v_exp_f32 v222, v222
    v_exp_f32 v223, v223
    v_smfmac_f32_32x32x32_bf16 v[146:161], v[104:107], v[210:217], v132
    s_mov_b64 exec, s[24:25]
    ds_read_b128 v[96:99], v137 offset:10240
    s_mov_b64 exec, -1
    v_exp_f32 v224, v224
    v_exp_f32 v225, v225
    v_exp_f32 v226, v226
    v_exp_f32 v227, v227
    v_smfmac_f32_32x32x32_bf16 v[146:161], v[108:111], v[218:225], v132
    s_mov_b64 exec, s[24:25]
    ds_read_b128 v[100:103], v137 offset:10880
    s_mov_b64 exec, -1
    v_exp_f32 v228, v228
    v_exp_f32 v229, v229
    v_exp_f32 v230, v230
    v_exp_f32 v231, v231
    v_mfma_f32_32x32x16_bf16 v[178:193], v[16:19], v[242:245], v[178:193]
    buffer_store_dwordx4 v[112:115], v126, s[44:47], s36 offen sc1
    v_exp_f32 v232, v232
    v_exp_f32 v233, v233
    v_exp_f32 v234, v234
    v_exp_f32 v235, v235
    v_smfmac_f32_32x32x32_bf16 v[162:177], v[104:107], v[226:233], v132
    s_mov_b32 exec_hi, 0
    buffer_store_dwordx2 v[112:113], v127, s[44:47], s37 offen sc1
    s_mov_b32 exec_hi, -1
    v_exp_f32 v236, v236
    v_exp_f32 v237, v237
    v_exp_f32 v238, v238
    v_exp_f32 v239, v239
    v_mfma_f32_32x32x16_bf16 v[194:209], v[16:19], v[246:249], v[194:209]
    v_exp_f32 v240, v240
    v_exp_f32 v241, v241
    v_exp_f32 v178, v178
    v_exp_f32 v179, v179
    v_smfmac_f32_32x32x32_bf16 v[162:177], v[108:111], v[234:241], v132
    s_waitcnt lgkmcnt(0)
    s_nop 0
    ds_read2st64_b64 v[16:19], v133 offset0:120 offset1:122
    v_exp_f32 v180, v180
    v_exp_f32 v181, v181
    v_exp_f32 v182, v182
    v_exp_f32 v183, v183
    v_mfma_f32_32x32x4_2b_bf16 v[210:241], v[26:27], v[250:251], 0 cbsz:1 abid:1
    v_exp_f32 v184, v184
    v_exp_f32 v185, v185
    v_exp_f32 v186, v186
    v_exp_f32 v187, v187
    v_exp_f32 v188, v188
    v_exp_f32 v189, v189
    v_exp_f32 v190, v190
    v_exp_f32 v191, v191
    v_smfmac_f32_32x32x32_bf16 v[146:161], v[96:99], v[178:185], v132
    s_mov_b64 exec, s[24:25]
    ds_read_b128 v[104:107], v137 offset:11520
    s_mov_b64 exec, -1
    v_exp_f32 v192, v192
    v_exp_f32 v193, v193
    v_exp_f32 v194, v194
    v_exp_f32 v195, v195
    v_smfmac_f32_32x32x32_bf16 v[146:161], v[100:103], v[186:193], v132
    s_mov_b64 exec, s[24:25]
    ds_read_b128 v[108:111], v137 offset:12160
    s_mov_b64 exec, -1
    v_exp_f32 v196, v196
    v_exp_f32 v197, v197
    v_exp_f32 v198, v198
    v_exp_f32 v199, v199
    v_mfma_f32_32x32x16_bf16 v[210:225], v[20:23], v[242:245], v[210:225]
    v_exp_f32 v200, v200
    v_exp_f32 v201, v201
    v_exp_f32 v202, v202
    v_exp_f32 v203, v203
    v_smfmac_f32_32x32x32_bf16 v[162:177], v[96:99], v[194:201], v132
    ds_read2st64_b64 v[28:31], v135 offset0:124 offset1:144
    v_exp_f32 v204, v204
    v_exp_f32 v205, v205
    v_exp_f32 v206, v206
    v_exp_f32 v207, v207
    v_mfma_f32_32x32x16_bf16 v[226:241], v[20:23], v[246:249], v[226:241]
    v_exp_f32 v208, v208
    v_exp_f32 v209, v209
    v_exp_f32 v210, v210
    v_exp_f32 v211, v211
    v_smfmac_f32_32x32x32_bf16 v[162:177], v[100:103], v[202:209], v132
    s_waitcnt lgkmcnt(0)
    s_nop 0
    ds_read2st64_b64 v[20:23], v134 offset0:120 offset1:122
    v_exp_f32 v212, v212
    v_exp_f32 v213, v213
    v_exp_f32 v214, v214
    v_exp_f32 v215, v215
    v_mfma_f32_32x32x4_2b_bf16 v[178:209], v[28:29], v[250:251], 0 cbsz:1 abid:0
    v_exp_f32 v216, v216
    v_exp_f32 v217, v217
    v_exp_f32 v218, v218
    v_exp_f32 v219, v219
    v_exp_f32 v220, v220
    v_exp_f32 v221, v221
    v_exp_f32 v222, v222
    v_exp_f32 v223, v223
    v_smfmac_f32_32x32x32_bf16 v[146:161], v[104:107], v[210:217], v132
    s_mov_b64 exec, s[24:25]
    ds_read_b128 v[96:99], v137 offset:20480
    s_mov_b64 exec, -1
    v_exp_f32 v224, v224
    v_exp_f32 v225, v225
    v_exp_f32 v226, v226
    v_exp_f32 v227, v227
    v_smfmac_f32_32x32x32_bf16 v[146:161], v[108:111], v[218:225], v132
    s_mov_b64 exec, s[24:25]
    ds_read_b128 v[100:103], v137 offset:21120
    s_mov_b64 exec, -1
    v_exp_f32 v228, v228
    v_exp_f32 v229, v229
    v_exp_f32 v230, v230
    v_exp_f32 v231, v231
    v_mfma_f32_32x32x16_bf16 v[178:193], v[16:19], v[242:245], v[178:193]
    v_exp_f32 v232, v232
    v_exp_f32 v233, v233
    v_exp_f32 v234, v234
    v_exp_f32 v235, v235
    v_smfmac_f32_32x32x32_bf16 v[162:177], v[104:107], v[226:233], v132
    v_exp_f32 v236, v236
    v_exp_f32 v237, v237
    v_exp_f32 v238, v238
    v_exp_f32 v239, v239
    v_mfma_f32_32x32x16_bf16 v[194:209], v[16:19], v[246:249], v[194:209]
    v_exp_f32 v240, v240
    v_exp_f32 v241, v241
    v_exp_f32 v178, v178
    v_exp_f32 v179, v179
    v_smfmac_f32_32x32x32_bf16 v[162:177], v[108:111], v[234:241], v132
    s_waitcnt lgkmcnt(0)
    s_nop 0
    ds_read2st64_b64 v[16:19], v133 offset0:140 offset1:142
    v_exp_f32 v180, v180
    v_exp_f32 v181, v181
    v_exp_f32 v182, v182
    v_exp_f32 v183, v183
    v_mfma_f32_32x32x4_2b_bf16 v[210:241], v[28:29], v[250:251], 0 cbsz:1 abid:1
    v_exp_f32 v184, v184
    v_exp_f32 v185, v185
    v_exp_f32 v186, v186
    v_exp_f32 v187, v187
    v_exp_f32 v188, v188
    v_exp_f32 v189, v189
    v_exp_f32 v190, v190
    v_exp_f32 v191, v191
    v_smfmac_f32_32x32x32_bf16 v[146:161], v[96:99], v[178:185], v132
    s_mov_b64 exec, s[24:25]
    ds_read_b128 v[104:107], v137 offset:21760
    s_mov_b64 exec, -1
    v_exp_f32 v192, v192
    v_exp_f32 v193, v193
    v_exp_f32 v194, v194
    v_exp_f32 v195, v195
    v_smfmac_f32_32x32x32_bf16 v[146:161], v[100:103], v[186:193], v132
    s_mov_b64 exec, s[24:25]
    ds_read_b128 v[108:111], v137 offset:22400
    s_mov_b64 exec, -1
    v_exp_f32 v196, v196
    v_exp_f32 v197, v197
    v_exp_f32 v198, v198
    v_exp_f32 v199, v199
    v_mfma_f32_32x32x16_bf16 v[210:225], v[20:23], v[242:245], v[210:225]
    v_exp_f32 v200, v200
    v_exp_f32 v201, v201
    v_exp_f32 v202, v202
    v_exp_f32 v203, v203
    v_smfmac_f32_32x32x32_bf16 v[162:177], v[96:99], v[194:201], v132
    v_exp_f32 v204, v204
    v_exp_f32 v205, v205
    v_exp_f32 v206, v206
    v_exp_f32 v207, v207
    v_mfma_f32_32x32x16_bf16 v[226:241], v[20:23], v[246:249], v[226:241]
    v_exp_f32 v208, v208
    v_exp_f32 v209, v209
    v_exp_f32 v210, v210
    v_exp_f32 v211, v211
    v_smfmac_f32_32x32x32_bf16 v[162:177], v[100:103], v[202:209], v132
    s_waitcnt lgkmcnt(0)
    s_nop 0
    ds_read2st64_b64 v[20:23], v134 offset0:140 offset1:142
    v_exp_f32 v212, v212
    v_exp_f32 v213, v213
    v_exp_f32 v214, v214
    v_exp_f32 v215, v215
    v_mfma_f32_32x32x4_2b_bf16 v[178:209], v[30:31], v[250:251], 0 cbsz:1 abid:0
    v_exp_f32 v216, v216
    v_exp_f32 v217, v217
    v_exp_f32 v218, v218
    v_exp_f32 v219, v219
    v_exp_f32 v220, v220
    v_exp_f32 v221, v221
    v_exp_f32 v222, v222
    v_exp_f32 v223, v223
    v_smfmac_f32_32x32x32_bf16 v[146:161], v[104:107], v[210:217], v132
    s_mov_b64 exec, s[24:25]
    ds_read_b128 v[96:99], v137 offset:30720
    s_mov_b64 exec, -1
    v_exp_f32 v224, v224
    v_exp_f32 v225, v225
    v_exp_f32 v226, v226
    v_exp_f32 v227, v227
    v_smfmac_f32_32x32x32_bf16 v[146:161], v[108:111], v[218:225], v132
    s_mov_b64 exec, s[24:25]
    ds_read_b128 v[100:103], v137 offset:31360
    s_mov_b64 exec, -1
    v_exp_f32 v228, v228
    v_exp_f32 v229, v229
    v_exp_f32 v230, v230
    v_exp_f32 v231, v231
    v_mfma_f32_32x32x16_bf16 v[178:193], v[16:19], v[242:245], v[178:193]
    v_exp_f32 v232, v232
    v_exp_f32 v233, v233
    v_exp_f32 v234, v234
    v_exp_f32 v235, v235
    v_smfmac_f32_32x32x32_bf16 v[162:177], v[104:107], v[226:233], v132
    v_exp_f32 v236, v236
    v_exp_f32 v237, v237
    v_exp_f32 v238, v238
    v_exp_f32 v239, v239
    v_mfma_f32_32x32x16_bf16 v[194:209], v[16:19], v[246:249], v[194:209]
    v_exp_f32 v240, v240
    v_exp_f32 v241, v241
    v_exp_f32 v178, v178
    v_exp_f32 v179, v179
    v_smfmac_f32_32x32x32_bf16 v[162:177], v[108:111], v[234:241], v132
    s_waitcnt lgkmcnt(0)
    s_nop 0
    v_add_u32 v133, 81920, v133
    v_add_u32 v134, 81920, v134
    v_add_u32 v135, 81920, v135
    v_add_u32 v136, 81920, v136
    ds_read2st64_b64 v[16:19], v133 offset0:0 offset1:2
    v_exp_f32 v180, v180
    v_exp_f32 v181, v181
    v_exp_f32 v182, v182
    v_exp_f32 v183, v183
    v_mfma_f32_32x32x4_2b_bf16 v[210:241], v[30:31], v[250:251], 0 cbsz:1 abid:1
    v_exp_f32 v184, v184
    v_exp_f32 v185, v185
    v_exp_f32 v186, v186
    v_exp_f32 v187, v187
    v_exp_f32 v188, v188
    v_exp_f32 v189, v189
    v_exp_f32 v190, v190
    v_exp_f32 v191, v191
    v_smfmac_f32_32x32x32_bf16 v[146:161], v[96:99], v[178:185], v132
    s_mov_b64 exec, s[24:25]
    ds_read_b128 v[104:107], v137 offset:32000
    s_mov_b64 exec, -1
    v_exp_f32 v192, v192
    v_exp_f32 v193, v193
    v_exp_f32 v194, v194
    v_exp_f32 v195, v195
    v_smfmac_f32_32x32x32_bf16 v[146:161], v[100:103], v[186:193], v132
    s_mov_b64 exec, s[24:25]
    ds_read_b128 v[108:111], v137 offset:32640
    s_mov_b64 exec, -1
    v_exp_f32 v196, v196
    v_exp_f32 v197, v197
    v_exp_f32 v198, v198
    v_exp_f32 v199, v199
    v_mfma_f32_32x32x16_bf16 v[210:225], v[20:23], v[242:245], v[210:225]
    v_exp_f32 v200, v200
    v_exp_f32 v201, v201
    v_exp_f32 v202, v202
    v_exp_f32 v203, v203
    v_smfmac_f32_32x32x32_bf16 v[162:177], v[96:99], v[194:201], v132
    ds_read2st64_b64 v[24:27], v135 offset0:4 offset1:24
    v_exp_f32 v204, v204
    v_exp_f32 v205, v205
    v_exp_f32 v206, v206
    v_exp_f32 v207, v207
    v_mfma_f32_32x32x16_bf16 v[226:241], v[20:23], v[246:249], v[226:241]
    v_exp_f32 v208, v208
    v_exp_f32 v209, v209
    v_exp_f32 v210, v210
    v_exp_f32 v211, v211
    v_smfmac_f32_32x32x32_bf16 v[162:177], v[100:103], v[202:209], v132
    s_waitcnt lgkmcnt(0)
    s_nop 0
    ds_read2st64_b64 v[20:23], v134 offset0:0 offset1:2
    v_exp_f32 v212, v212
    v_exp_f32 v213, v213
    v_exp_f32 v214, v214
    v_exp_f32 v215, v215
    v_mfma_f32_32x32x4_2b_bf16 v[178:209], v[24:25], v[250:251], 0 cbsz:1 abid:0
    v_exp_f32 v216, v216
    v_exp_f32 v217, v217
    v_exp_f32 v218, v218
    v_exp_f32 v219, v219
    v_exp_f32 v220, v220
    v_exp_f32 v221, v221
    v_exp_f32 v222, v222
    v_exp_f32 v223, v223
    v_smfmac_f32_32x32x32_bf16 v[146:161], v[104:107], v[210:217], v132
    s_mov_b64 exec, s[24:25]
    ds_read_b128 v[96:99], v136 offset:0
    s_mov_b64 exec, -1
    v_exp_f32 v224, v224
    v_exp_f32 v225, v225
    v_exp_f32 v226, v226
    v_exp_f32 v227, v227
    v_smfmac_f32_32x32x32_bf16 v[146:161], v[108:111], v[218:225], v132
    s_mov_b64 exec, s[24:25]
    ds_read_b128 v[100:103], v136 offset:640
    s_mov_b64 exec, -1
    v_exp_f32 v228, v228
    v_exp_f32 v229, v229
    v_exp_f32 v230, v230
    v_exp_f32 v231, v231
    v_mfma_f32_32x32x16_bf16 v[178:193], v[16:19], v[242:245], v[178:193]
    v_exp_f32 v232, v232
    v_exp_f32 v233, v233
    v_exp_f32 v234, v234
    v_exp_f32 v235, v235
    v_smfmac_f32_32x32x32_bf16 v[162:177], v[104:107], v[226:233], v132
    v_exp_f32 v236, v236
    v_exp_f32 v237, v237
    v_exp_f32 v238, v238
    v_exp_f32 v239, v239
    v_mfma_f32_32x32x16_bf16 v[194:209], v[16:19], v[246:249], v[194:209]
    v_exp_f32 v240, v240
    v_exp_f32 v241, v241
    v_exp_f32 v178, v178
    v_exp_f32 v179, v179
    v_smfmac_f32_32x32x32_bf16 v[162:177], v[108:111], v[234:241], v132
    s_waitcnt lgkmcnt(0)
    s_nop 0
    v_add_u32 v137, 81920, v137
    ds_read2st64_b64 v[16:19], v133 offset0:20 offset1:22
    v_exp_f32 v180, v180
    v_exp_f32 v181, v181
    v_exp_f32 v182, v182
    v_exp_f32 v183, v183
    v_mfma_f32_32x32x4_2b_bf16 v[210:241], v[24:25], v[250:251], 0 cbsz:1 abid:1
    v_exp_f32 v184, v184
    v_exp_f32 v185, v185
    v_exp_f32 v186, v186
    v_exp_f32 v187, v187
    v_exp_f32 v188, v188
    v_exp_f32 v189, v189
    v_exp_f32 v190, v190
    v_exp_f32 v191, v191
    v_smfmac_f32_32x32x32_bf16 v[146:161], v[96:99], v[178:185], v132
    s_mov_b64 exec, s[24:25]
    ds_read_b128 v[104:107], v136 offset:1280
    s_mov_b64 exec, -1
    v_exp_f32 v192, v192
    v_exp_f32 v193, v193
    v_exp_f32 v194, v194
    v_exp_f32 v195, v195
    v_smfmac_f32_32x32x32_bf16 v[146:161], v[100:103], v[186:193], v132
    s_mov_b64 exec, s[24:25]
    ds_read_b128 v[108:111], v136 offset:1920
    s_mov_b64 exec, -1
    v_exp_f32 v196, v196
    v_exp_f32 v197, v197
    v_exp_f32 v198, v198
    v_exp_f32 v199, v199
    v_mfma_f32_32x32x16_bf16 v[210:225], v[20:23], v[242:245], v[210:225]
    v_exp_f32 v200, v200
    v_exp_f32 v201, v201
    v_exp_f32 v202, v202
    v_exp_f32 v203, v203
    v_smfmac_f32_32x32x32_bf16 v[162:177], v[96:99], v[194:201], v132
    v_exp_f32 v204, v204
    v_exp_f32 v205, v205
    v_exp_f32 v206, v206
    v_exp_f32 v207, v207
    v_mfma_f32_32x32x16_bf16 v[226:241], v[20:23], v[246:249], v[226:241]
    v_exp_f32 v208, v208
    v_exp_f32 v209, v209
    v_exp_f32 v210, v210
    v_exp_f32 v211, v211
    v_smfmac_f32_32x32x32_bf16 v[162:177], v[100:103], v[202:209], v132
    s_waitcnt lgkmcnt(0)
    s_nop 0
    ds_read2st64_b64 v[20:23], v134 offset0:20 offset1:22
    v_exp_f32 v212, v212
    v_exp_f32 v213, v213
    v_exp_f32 v214, v214
    v_exp_f32 v215, v215
    v_mfma_f32_32x32x4_2b_bf16 v[178:209], v[26:27], v[250:251], 0 cbsz:1 abid:0
    v_exp_f32 v216, v216
    v_exp_f32 v217, v217
    v_exp_f32 v218, v218
    v_exp_f32 v219, v219
    v_exp_f32 v220, v220
    v_exp_f32 v221, v221
    v_exp_f32 v222, v222
    v_exp_f32 v223, v223
    v_smfmac_f32_32x32x32_bf16 v[146:161], v[104:107], v[210:217], v132
    s_mov_b64 exec, s[24:25]
    ds_read_b128 v[96:99], v136 offset:10240
    s_mov_b64 exec, -1
    v_exp_f32 v224, v224
    v_exp_f32 v225, v225
    v_exp_f32 v226, v226
    v_exp_f32 v227, v227
    v_smfmac_f32_32x32x32_bf16 v[146:161], v[108:111], v[218:225], v132
    s_mov_b64 exec, s[24:25]
    ds_read_b128 v[100:103], v136 offset:10880
    s_mov_b64 exec, -1
    v_exp_f32 v228, v228
    v_exp_f32 v229, v229
    v_exp_f32 v230, v230
    v_exp_f32 v231, v231
    v_mfma_f32_32x32x16_bf16 v[178:193], v[16:19], v[242:245], v[178:193]
    v_exp_f32 v232, v232
    v_exp_f32 v233, v233
    v_exp_f32 v234, v234
    v_exp_f32 v235, v235
    v_smfmac_f32_32x32x32_bf16 v[162:177], v[104:107], v[226:233], v132
    v_exp_f32 v236, v236
    v_exp_f32 v237, v237
    v_exp_f32 v238, v238
    v_exp_f32 v239, v239
    v_mfma_f32_32x32x16_bf16 v[194:209], v[16:19], v[246:249], v[194:209]
    v_exp_f32 v240, v240
    v_exp_f32 v241, v241
    v_exp_f32 v178, v178
    v_exp_f32 v179, v179
    v_smfmac_f32_32x32x32_bf16 v[162:177], v[108:111], v[234:241], v132
    s_waitcnt vmcnt(0) lgkmcnt(0)
    s_barrier
    s_setprio 2
    s_nop 0
    ds_read2st64_b64 v[16:19], v133 offset0:40 offset1:42
    v_exp_f32 v180, v180
    v_exp_f32 v181, v181
    v_exp_f32 v182, v182
    v_exp_f32 v183, v183
    v_mfma_f32_32x32x4_2b_bf16 v[210:241], v[26:27], v[250:251], 0 cbsz:1 abid:1
    v_exp_f32 v184, v184
    v_exp_f32 v185, v185
    v_exp_f32 v186, v186
    v_exp_f32 v187, v187
    v_exp_f32 v188, v188
    v_exp_f32 v189, v189
    v_exp_f32 v190, v190
    v_exp_f32 v191, v191
    v_smfmac_f32_32x32x32_bf16 v[146:161], v[96:99], v[178:185], v132
    s_mov_b64 exec, s[24:25]
    ds_read_b128 v[104:107], v136 offset:11520
    s_mov_b64 exec, -1
    v_exp_f32 v192, v192
    v_exp_f32 v193, v193
    v_exp_f32 v194, v194
    v_exp_f32 v195, v195
    v_smfmac_f32_32x32x32_bf16 v[146:161], v[100:103], v[186:193], v132
    s_mov_b64 exec, s[24:25]
    ds_read_b128 v[108:111], v136 offset:12160
    s_mov_b64 exec, -1
    v_exp_f32 v196, v196
    v_exp_f32 v197, v197
    v_exp_f32 v198, v198
    v_exp_f32 v199, v199
    v_mfma_f32_32x32x16_bf16 v[210:225], v[20:23], v[242:245], v[210:225]
    s_add_u32 s31, s30, 0
    s_add_u32 m0, s32, 0
    s_nop 0
    buffer_load_dwordx4 v116, s[48:51], s31 offen lds
    s_nop 0
    v_exp_f32 v200, v200
    v_exp_f32 v201, v201
    v_exp_f32 v202, v202
    v_exp_f32 v203, v203
    v_smfmac_f32_32x32x32_bf16 v[162:177], v[96:99], v[194:201], v132
    ds_read2st64_b64 v[28:31], v135 offset0:44 offset1:64
    s_add_u32 m0, s32, 1024
    s_nop 0
    buffer_load_dwordx4 v117, s[48:51], s31 offen lds
    s_nop 0
    v_exp_f32 v204, v204
    v_exp_f32 v205, v205
    v_exp_f32 v206, v206
    v_exp_f32 v207, v207
    v_mfma_f32_32x32x16_bf16 v[226:241], v[20:23], v[246:249], v[226:241]
    v_exp_f32 v208, v208
    v_exp_f32 v209, v209
    v_exp_f32 v210, v210
    v_exp_f32 v211, v211
    v_smfmac_f32_32x32x32_bf16 v[162:177], v[100:103], v[202:209], v132
    s_waitcnt lgkmcnt(0)
    s_nop 0
    ds_read2st64_b64 v[20:23], v134 offset0:40 offset1:42
    v_exp_f32 v212, v212
    v_exp_f32 v213, v213
    v_exp_f32 v214, v214
    v_exp_f32 v215, v215
    v_mfma_f32_32x32x4_2b_bf16 v[178:209], v[28:29], v[250:251], 0 cbsz:1 abid:0
    v_exp_f32 v216, v216
    v_exp_f32 v217, v217
    v_exp_f32 v218, v218
    v_exp_f32 v219, v219
    v_exp_f32 v220, v220
    v_exp_f32 v221, v221
    v_exp_f32 v222, v222
    v_exp_f32 v223, v223
    v_smfmac_f32_32x32x32_bf16 v[146:161], v[104:107], v[210:217], v132
    s_mov_b64 exec, s[24:25]
    ds_read_b128 v[96:99], v136 offset:20480
    s_mov_b64 exec, -1
    v_exp_f32 v224, v224
    v_exp_f32 v225, v225
    v_exp_f32 v226, v226
    v_exp_f32 v227, v227
    v_smfmac_f32_32x32x32_bf16 v[146:161], v[108:111], v[218:225], v132
    s_mov_b64 exec, s[24:25]
    ds_read_b128 v[100:103], v136 offset:21120
    s_mov_b64 exec, -1
    v_exp_f32 v228, v228
    v_exp_f32 v229, v229
    v_exp_f32 v230, v230
    v_exp_f32 v231, v231
    v_mfma_f32_32x32x16_bf16 v[178:193], v[16:19], v[242:245], v[178:193]
    s_add_u32 m0, s32, 2048
    s_nop 0
    buffer_load_dwordx4 v118, s[48:51], s31 offen lds
    s_nop 0
    v_exp_f32 v232, v232
    v_exp_f32 v233, v233
    v_exp_f32 v234, v234
    v_exp_f32 v235, v235
    v_smfmac_f32_32x32x32_bf16 v[162:177], v[104:107], v[226:233], v132
    s_add_u32 m0, s32, 3072
    s_nop 0
    buffer_load_dwordx4 v119, s[48:51], s31 offen lds
    s_nop 0
    v_exp_f32 v236, v236
    v_exp_f32 v237, v237
    v_exp_f32 v238, v238
    v_exp_f32 v239, v239
    v_mfma_f32_32x32x16_bf16 v[194:209], v[16:19], v[246:249], v[194:209]
    v_exp_f32 v240, v240
    v_exp_f32 v241, v241
    v_exp_f32 v178, v178
    v_exp_f32 v179, v179
    v_smfmac_f32_32x32x32_bf16 v[162:177], v[108:111], v[234:241], v132
    s_waitcnt lgkmcnt(0)
    s_nop 0
    ds_read2st64_b64 v[16:19], v133 offset0:60 offset1:62
    v_exp_f32 v180, v180
    v_exp_f32 v181, v181
    v_exp_f32 v182, v182
    v_exp_f32 v183, v183
    v_mfma_f32_32x32x4_2b_bf16 v[210:241], v[28:29], v[250:251], 0 cbsz:1 abid:1
    v_exp_f32 v184, v184
    v_exp_f32 v185, v185
    v_exp_f32 v186, v186
    v_exp_f32 v187, v187
    v_exp_f32 v188, v188
    v_exp_f32 v189, v189
    v_exp_f32 v190, v190
    v_exp_f32 v191, v191
    v_smfmac_f32_32x32x32_bf16 v[146:161], v[96:99], v[178:185], v132
    s_mov_b64 exec, s[24:25]
    ds_read_b128 v[104:107], v136 offset:21760
    s_mov_b64 exec, -1
    v_exp_f32 v192, v192
    v_exp_f32 v193, v193
    v_exp_f32 v194, v194
    v_exp_f32 v195, v195
    v_smfmac_f32_32x32x32_bf16 v[146:161], v[100:103], v[186:193], v132
    s_mov_b64 exec, s[24:25]
    ds_read_b128 v[108:111], v136 offset:22400
    s_mov_b64 exec, -1
    v_exp_f32 v196, v196
    v_exp_f32 v197, v197
    v_exp_f32 v198, v198
    v_exp_f32 v199, v199
    v_mfma_f32_32x32x16_bf16 v[210:225], v[20:23], v[242:245], v[210:225]
    s_add_u32 m0, s32, 4096
    s_nop 0
    buffer_load_dwordx4 v120, s[48:51], s31 offen lds
    s_nop 0
    v_exp_f32 v200, v200
    v_exp_f32 v201, v201
    v_exp_f32 v202, v202
    v_exp_f32 v203, v203
    v_smfmac_f32_32x32x32_bf16 v[162:177], v[96:99], v[194:201], v132
    s_add_u32 s31, s30, 327680
    s_add_u32 m0, s32, 40960
    s_nop 0
    buffer_load_dwordx4 v116, s[48:51], s31 offen lds
    s_nop 0
    v_exp_f32 v204, v204
    v_exp_f32 v205, v205
    v_exp_f32 v206, v206
    v_exp_f32 v207, v207
    v_mfma_f32_32x32x16_bf16 v[226:241], v[20:23], v[246:249], v[226:241]
    v_exp_f32 v208, v208
    v_exp_f32 v209, v209
    v_exp_f32 v210, v210
    v_exp_f32 v211, v211
    v_smfmac_f32_32x32x32_bf16 v[162:177], v[100:103], v[202:209], v132
    s_waitcnt lgkmcnt(0)
    s_nop 0
    ds_read2st64_b64 v[20:23], v134 offset0:60 offset1:62
    v_exp_f32 v212, v212
    v_exp_f32 v213, v213
    v_exp_f32 v214, v214
    v_exp_f32 v215, v215
    v_mfma_f32_32x32x4_2b_bf16 v[178:209], v[30:31], v[250:251], 0 cbsz:1 abid:0
    v_exp_f32 v216, v216
    v_exp_f32 v217, v217
    v_exp_f32 v218, v218
    v_exp_f32 v219, v219
    v_exp_f32 v220, v220
    v_exp_f32 v221, v221
    v_exp_f32 v222, v222
    v_exp_f32 v223, v223
    v_smfmac_f32_32x32x32_bf16 v[146:161], v[104:107], v[210:217], v132
    s_mov_b64 exec, s[24:25]
    ds_read_b128 v[96:99], v136 offset:30720
    s_mov_b64 exec, -1
    v_exp_f32 v224, v224
    v_exp_f32 v225, v225
    v_exp_f32 v226, v226
    v_exp_f32 v227, v227
    v_smfmac_f32_32x32x32_bf16 v[146:161], v[108:111], v[218:225], v132
    s_mov_b64 exec, s[24:25]
    ds_read_b128 v[100:103], v136 offset:31360
    s_mov_b64 exec, -1
    v_exp_f32 v228, v228
    v_exp_f32 v229, v229
    v_exp_f32 v230, v230
    v_exp_f32 v231, v231
    v_mfma_f32_32x32x16_bf16 v[178:193], v[16:19], v[242:245], v[178:193]
    s_add_u32 m0, s32, 41984
    s_nop 0
    buffer_load_dwordx4 v117, s[48:51], s31 offen lds
    s_nop 0
    v_exp_f32 v232, v232
    v_exp_f32 v233, v233
    v_exp_f32 v234, v234
    v_exp_f32 v235, v235
    v_smfmac_f32_32x32x32_bf16 v[162:177], v[104:107], v[226:233], v132
    s_add_u32 m0, s32, 43008
    s_nop 0
    buffer_load_dwordx4 v118, s[48:51], s31 offen lds
    s_nop 0
    v_exp_f32 v236, v236
    v_exp_f32 v237, v237
    v_exp_f32 v238, v238
    v_exp_f32 v239, v239
    v_mfma_f32_32x32x16_bf16 v[194:209], v[16:19], v[246:249], v[194:209]
    v_exp_f32 v240, v240
    v_exp_f32 v241, v241
    v_exp_f32 v178, v178
    v_exp_f32 v179, v179
    v_smfmac_f32_32x32x32_bf16 v[162:177], v[108:111], v[234:241], v132
    s_waitcnt lgkmcnt(0)
    s_nop 0
    ds_read2st64_b64 v[16:19], v133 offset0:80 offset1:82
    v_exp_f32 v180, v180
    v_exp_f32 v181, v181
    v_exp_f32 v182, v182
    v_exp_f32 v183, v183
    v_mfma_f32_32x32x4_2b_bf16 v[210:241], v[30:31], v[250:251], 0 cbsz:1 abid:1
    v_exp_f32 v184, v184
    v_exp_f32 v185, v185
    v_exp_f32 v186, v186
    v_exp_f32 v187, v187
    v_exp_f32 v188, v188
    v_exp_f32 v189, v189
    v_exp_f32 v190, v190
    v_exp_f32 v191, v191
    v_smfmac_f32_32x32x32_bf16 v[146:161], v[96:99], v[178:185], v132
    s_mov_b64 exec, s[24:25]
    ds_read_b128 v[104:107], v136 offset:32000
    s_mov_b64 exec, -1
    v_exp_f32 v192, v192
    v_exp_f32 v193, v193
    v_exp_f32 v194, v194
    v_exp_f32 v195, v195
    v_smfmac_f32_32x32x32_bf16 v[146:161], v[100:103], v[186:193], v132
    s_mov_b64 exec, s[24:25]
    ds_read_b128 v[108:111], v136 offset:32640
    s_mov_b64 exec, -1
    v_exp_f32 v196, v196
    v_exp_f32 v197, v197
    v_exp_f32 v198, v198
    v_exp_f32 v199, v199
    v_mfma_f32_32x32x16_bf16 v[210:225], v[20:23], v[242:245], v[210:225]
    s_add_u32 m0, s32, 44032
    s_nop 0
    buffer_load_dwordx4 v119, s[48:51], s31 offen lds
    s_nop 0
    v_exp_f32 v200, v200
    v_exp_f32 v201, v201
    v_exp_f32 v202, v202
    v_exp_f32 v203, v203
    v_smfmac_f32_32x32x32_bf16 v[162:177], v[96:99], v[194:201], v132
    ds_read2st64_b64 v[24:27], v135 offset0:84 offset1:104
    s_add_u32 m0, s32, 45056
    s_nop 0
    buffer_load_dwordx4 v120, s[48:51], s31 offen lds
    s_nop 0
    v_exp_f32 v204, v204
    v_exp_f32 v205, v205
    v_exp_f32 v206, v206
    v_exp_f32 v207, v207
    v_mfma_f32_32x32x16_bf16 v[226:241], v[20:23], v[246:249], v[226:241]
    v_exp_f32 v208, v208
    v_exp_f32 v209, v209
    v_exp_f32 v210, v210
    v_exp_f32 v211, v211
    v_smfmac_f32_32x32x32_bf16 v[162:177], v[100:103], v[202:209], v132
    s_waitcnt lgkmcnt(0)
    s_nop 0
    ds_read2st64_b64 v[20:23], v134 offset0:80 offset1:82
    v_exp_f32 v212, v212
    v_exp_f32 v213, v213
    v_exp_f32 v214, v214
    v_exp_f32 v215, v215
    v_mfma_f32_32x32x4_2b_bf16 v[178:209], v[24:25], v[250:251], 0 cbsz:1 abid:0
    v_exp_f32 v216, v216
    v_exp_f32 v217, v217
    v_exp_f32 v218, v218
    v_exp_f32 v219, v219
    v_exp_f32 v220, v220
    v_exp_f32 v221, v221
    v_exp_f32 v222, v222
    v_exp_f32 v223, v223
    v_smfmac_f32_32x32x32_bf16 v[146:161], v[104:107], v[210:217], v132
    s_mov_b64 exec, s[24:25]
    ds_read_b128 v[96:99], v137 offset:0
    s_mov_b64 exec, -1
    v_exp_f32 v224, v224
    v_exp_f32 v225, v225
    v_exp_f32 v226, v226
    v_exp_f32 v227, v227
    v_smfmac_f32_32x32x32_bf16 v[146:161], v[108:111], v[218:225], v132
    s_mov_b64 exec, s[24:25]
    ds_read_b128 v[100:103], v137 offset:640
    s_mov_b64 exec, -1
    v_exp_f32 v228, v228
    v_exp_f32 v229, v229
    v_exp_f32 v230, v230
    v_exp_f32 v231, v231
    v_mfma_f32_32x32x16_bf16 v[178:193], v[16:19], v[242:245], v[178:193]
    v_exp_f32 v232, v232
    v_exp_f32 v233, v233
    v_exp_f32 v234, v234
    v_exp_f32 v235, v235
    v_smfmac_f32_32x32x32_bf16 v[162:177], v[104:107], v[226:233], v132
    v_exp_f32 v236, v236
    v_exp_f32 v237, v237
    v_exp_f32 v238, v238
    v_exp_f32 v239, v239
    v_mfma_f32_32x32x16_bf16 v[194:209], v[16:19], v[246:249], v[194:209]
    v_exp_f32 v240, v240
    v_exp_f32 v241, v241
    v_exp_f32 v178, v178
    v_exp_f32 v179, v179
    v_smfmac_f32_32x32x32_bf16 v[162:177], v[108:111], v[234:241], v132
    s_waitcnt lgkmcnt(0)
    s_nop 0
    ds_read2st64_b64 v[16:19], v133 offset0:100 offset1:102
    v_exp_f32 v180, v180
    v_exp_f32 v181, v181
    v_exp_f32 v182, v182
    v_exp_f32 v183, v183
    v_mfma_f32_32x32x4_2b_bf16 v[210:241], v[24:25], v[250:251], 0 cbsz:1 abid:1
    v_exp_f32 v184, v184
    v_exp_f32 v185, v185
    v_exp_f32 v186, v186
    v_exp_f32 v187, v187
    v_exp_f32 v188, v188
    v_exp_f32 v189, v189
    v_exp_f32 v190, v190
    v_exp_f32 v191, v191
    v_smfmac_f32_32x32x32_bf16 v[146:161], v[96:99], v[178:185], v132
    s_mov_b64 exec, s[24:25]
    ds_read_b128 v[104:107], v137 offset:1280
    s_mov_b64 exec, -1
    v_exp_f32 v192, v192
    v_exp_f32 v193, v193
    v_exp_f32 v194, v194
    v_exp_f32 v195, v195
    v_smfmac_f32_32x32x32_bf16 v[146:161], v[100:103], v[186:193], v132
    s_mov_b64 exec, s[24:25]
    ds_read_b128 v[108:111], v137 offset:1920
    s_mov_b64 exec, -1
    v_exp_f32 v196, v196
    v_exp_f32 v197, v197
    v_exp_f32 v198, v198
    v_exp_f32 v199, v199
    v_mfma_f32_32x32x16_bf16 v[210:225], v[20:23], v[242:245], v[210:225]
    v_exp_f32 v200, v200
    v_exp_f32 v201, v201
    v_exp_f32 v202, v202
    v_exp_f32 v203, v203
    v_smfmac_f32_32x32x32_bf16 v[162:177], v[96:99], v[194:201], v132
    v_exp_f32 v204, v204
    v_exp_f32 v205, v205
    v_exp_f32 v206, v206
    v_exp_f32 v207, v207
    v_mfma_f32_32x32x16_bf16 v[226:241], v[20:23], v[246:249], v[226:241]
    v_exp_f32 v208, v208
    v_exp_f32 v209, v209
    v_exp_f32 v210, v210
    v_exp_f32 v211, v211
    v_smfmac_f32_32x32x32_bf16 v[162:177], v[100:103], v[202:209], v132
    s_waitcnt lgkmcnt(0)
    s_setprio 0
    ds_read2st64_b64 v[20:23], v134 offset0:100 offset1:102
    v_exp_f32 v212, v212
    v_exp_f32 v213, v213
    v_exp_f32 v214, v214
    v_exp_f32 v215, v215
    v_mfma_f32_32x32x4_2b_bf16 v[178:209], v[26:27], v[250:251], 0 cbsz:1 abid:0
    v_exp_f32 v216, v216
    v_exp_f32 v217, v217
    v_exp_f32 v218, v218
    v_exp_f32 v219, v219
    v_exp_f32 v220, v220
    v_exp_f32 v221, v221
    v_exp_f32 v222, v222
    v_exp_f32 v223, v223
    v_smfmac_f32_32x32x32_bf16 v[146:161], v[104:107], v[210:217], v132
    s_mov_b64 exec, s[24:25]
    ds_read_b128 v[96:99], v137 offset:10240
    s_mov_b64 exec, -1
    v_exp_f32 v224, v224
    v_exp_f32 v225, v225
    v_exp_f32 v226, v226
    v_exp_f32 v227, v227
    v_smfmac_f32_32x32x32_bf16 v[146:161], v[108:111], v[218:225], v132
    s_mov_b64 exec, s[24:25]
    ds_read_b128 v[100:103], v137 offset:10880
    s_mov_b64 exec, -1
    v_exp_f32 v228, v228
    v_exp_f32 v229, v229
    v_exp_f32 v230, v230
    v_exp_f32 v231, v231
    v_mfma_f32_32x32x16_bf16 v[178:193], v[16:19], v[242:245], v[178:193]
    v_exp_f32 v232, v232
    v_exp_f32 v233, v233
    v_exp_f32 v234, v234
    v_exp_f32 v235, v235
    v_smfmac_f32_32x32x32_bf16 v[162:177], v[104:107], v[226:233], v132
    v_exp_f32 v236, v236
    v_exp_f32 v237, v237
    v_exp_f32 v238, v238
    v_exp_f32 v239, v239
    v_mfma_f32_32x32x16_bf16 v[194:209], v[16:19], v[246:249], v[194:209]
    v_exp_f32 v240, v240
    v_exp_f32 v241, v241
    v_exp_f32 v178, v178
    v_exp_f32 v179, v179
    v_smfmac_f32_32x32x32_bf16 v[162:177], v[108:111], v[234:241], v132
    s_waitcnt lgkmcnt(0)
    s_barrier
    s_setprio 3
    s_nop 0
    ds_read2st64_b64 v[16:19], v133 offset0:120 offset1:122
    v_exp_f32 v180, v180
    v_exp_f32 v181, v181
    v_exp_f32 v182, v182
    v_exp_f32 v183, v183
    v_mfma_f32_32x32x4_2b_bf16 v[210:241], v[26:27], v[250:251], 0 cbsz:1 abid:1
    v_exp_f32 v184, v184
    v_exp_f32 v185, v185
    v_exp_f32 v186, v186
    v_exp_f32 v187, v187
    v_exp_f32 v188, v188
    v_exp_f32 v189, v189
    v_exp_f32 v190, v190
    v_exp_f32 v191, v191
    v_smfmac_f32_32x32x32_bf16 v[146:161], v[96:99], v[178:185], v132
    s_mov_b64 exec, s[24:25]
    ds_read_b128 v[104:107], v137 offset:11520
    s_mov_b64 exec, -1
    v_exp_f32 v192, v192
    v_exp_f32 v193, v193
    v_exp_f32 v194, v194
    v_exp_f32 v195, v195
    v_smfmac_f32_32x32x32_bf16 v[146:161], v[100:103], v[186:193], v132
    s_mov_b64 exec, s[24:25]
    ds_read_b128 v[108:111], v137 offset:12160
    s_mov_b64 exec, -1
    v_exp_f32 v196, v196
    v_exp_f32 v197, v197
    v_exp_f32 v198, v198
    v_exp_f32 v199, v199
    v_mfma_f32_32x32x16_bf16 v[210:225], v[20:23], v[242:245], v[210:225]
    s_add_u32 s31, s30, 655360
    s_add_u32 m0, s32, 81920
    s_nop 0
    buffer_load_dwordx4 v116, s[48:51], s31 offen lds
    s_nop 0
    v_exp_f32 v200, v200
    v_exp_f32 v201, v201
    v_exp_f32 v202, v202
    v_exp_f32 v203, v203
    v_smfmac_f32_32x32x32_bf16 v[162:177], v[96:99], v[194:201], v132
    ds_read2st64_b64 v[28:31], v135 offset0:124 offset1:144
    s_add_u32 m0, s32, 82944
    s_nop 0
    buffer_load_dwordx4 v117, s[48:51], s31 offen lds
    s_nop 0
    v_exp_f32 v204, v204
    v_exp_f32 v205, v205
    v_exp_f32 v206, v206
    v_exp_f32 v207, v207
    v_mfma_f32_32x32x16_bf16 v[226:241], v[20:23], v[246:249], v[226:241]
    v_exp_f32 v208, v208
    v_exp_f32 v209, v209
    v_exp_f32 v210, v210
    v_exp_f32 v211, v211
    v_smfmac_f32_32x32x32_bf16 v[162:177], v[100:103], v[202:209], v132
    s_waitcnt lgkmcnt(0)
    s_nop 0
    ds_read2st64_b64 v[20:23], v134 offset0:120 offset1:122
    v_exp_f32 v212, v212
    v_exp_f32 v213, v213
    v_exp_f32 v214, v214
    v_exp_f32 v215, v215
    v_mfma_f32_32x32x4_2b_bf16 v[178:209], v[28:29], v[250:251], 0 cbsz:1 abid:0
    v_exp_f32 v216, v216
    v_exp_f32 v217, v217
    v_exp_f32 v218, v218
    v_exp_f32 v219, v219
    v_exp_f32 v220, v220
    v_exp_f32 v221, v221
    v_exp_f32 v222, v222
    v_exp_f32 v223, v223
    v_smfmac_f32_32x32x32_bf16 v[146:161], v[104:107], v[210:217], v132
    s_mov_b64 exec, s[24:25]
    ds_read_b128 v[96:99], v137 offset:20480
    s_mov_b64 exec, -1
    v_exp_f32 v224, v224
    v_exp_f32 v225, v225
    v_exp_f32 v226, v226
    v_exp_f32 v227, v227
    v_smfmac_f32_32x32x32_bf16 v[146:161], v[108:111], v[218:225], v132
    s_mov_b64 exec, s[24:25]
    ds_read_b128 v[100:103], v137 offset:21120
    s_mov_b64 exec, -1
    v_exp_f32 v228, v228
    v_exp_f32 v229, v229
    v_exp_f32 v230, v230
    v_exp_f32 v231, v231
    v_mfma_f32_32x32x16_bf16 v[178:193], v[16:19], v[242:245], v[178:193]
    s_add_u32 m0, s32, 83968
    s_nop 0
    buffer_load_dwordx4 v118, s[48:51], s31 offen lds
    s_nop 0
    v_exp_f32 v232, v232
    v_exp_f32 v233, v233
    v_exp_f32 v234, v234
    v_exp_f32 v235, v235
    v_smfmac_f32_32x32x32_bf16 v[162:177], v[104:107], v[226:233], v132
    s_add_u32 m0, s32, 84992
    s_nop 0
    buffer_load_dwordx4 v119, s[48:51], s31 offen lds
    s_nop 0
    v_exp_f32 v236, v236
    v_exp_f32 v237, v237
    v_exp_f32 v238, v238
    v_exp_f32 v239, v239
    v_mfma_f32_32x32x16_bf16 v[194:209], v[16:19], v[246:249], v[194:209]
    v_exp_f32 v240, v240
    v_exp_f32 v241, v241
    v_exp_f32 v178, v178
    v_exp_f32 v179, v179
    v_smfmac_f32_32x32x32_bf16 v[162:177], v[108:111], v[234:241], v132
    s_waitcnt lgkmcnt(0)
    s_nop 0
    ds_read2st64_b64 v[16:19], v133 offset0:140 offset1:142
    v_exp_f32 v180, v180
    v_exp_f32 v181, v181
    v_exp_f32 v182, v182
    v_exp_f32 v183, v183
    v_mfma_f32_32x32x4_2b_bf16 v[210:241], v[28:29], v[250:251], 0 cbsz:1 abid:1
    v_exp_f32 v184, v184
    v_exp_f32 v185, v185
    v_exp_f32 v186, v186
    v_exp_f32 v187, v187
    v_exp_f32 v188, v188
    v_exp_f32 v189, v189
    v_exp_f32 v190, v190
    v_exp_f32 v191, v191
    v_smfmac_f32_32x32x32_bf16 v[146:161], v[96:99], v[178:185], v132
    s_mov_b64 exec, s[24:25]
    ds_read_b128 v[104:107], v137 offset:21760
    s_mov_b64 exec, -1
    v_exp_f32 v192, v192
    v_exp_f32 v193, v193
    v_exp_f32 v194, v194
    v_exp_f32 v195, v195
    v_smfmac_f32_32x32x32_bf16 v[146:161], v[100:103], v[186:193], v132
    s_mov_b64 exec, s[24:25]
    ds_read_b128 v[108:111], v137 offset:22400
    s_mov_b64 exec, -1
    v_exp_f32 v196, v196
    v_exp_f32 v197, v197
    v_exp_f32 v198, v198
    v_exp_f32 v199, v199
    v_mfma_f32_32x32x16_bf16 v[210:225], v[20:23], v[242:245], v[210:225]
    s_add_u32 m0, s32, 86016
    s_nop 0
    buffer_load_dwordx4 v120, s[48:51], s31 offen lds
    s_nop 0
    v_exp_f32 v200, v200
    v_exp_f32 v201, v201
    v_exp_f32 v202, v202
    v_exp_f32 v203, v203
    v_smfmac_f32_32x32x32_bf16 v[162:177], v[96:99], v[194:201], v132
    v_exp_f32 v204, v204
    v_exp_f32 v205, v205
    v_exp_f32 v206, v206
    v_exp_f32 v207, v207
    v_mfma_f32_32x32x16_bf16 v[226:241], v[20:23], v[246:249], v[226:241]
    v_exp_f32 v208, v208
    v_exp_f32 v209, v209
    v_exp_f32 v210, v210
    v_exp_f32 v211, v211
    v_smfmac_f32_32x32x32_bf16 v[162:177], v[100:103], v[202:209], v132
    s_waitcnt lgkmcnt(0)
    s_setprio 2
    ds_read2st64_b64 v[20:23], v134 offset0:140 offset1:142
    v_exp_f32 v212, v212
    v_exp_f32 v213, v213
    v_exp_f32 v214, v214
    v_exp_f32 v215, v215
    v_mfma_f32_32x32x4_2b_bf16 v[178:209], v[30:31], v[250:251], 0 cbsz:1 abid:0
    v_exp_f32 v216, v216
    v_exp_f32 v217, v217
    v_exp_f32 v218, v218
    v_exp_f32 v219, v219
    v_exp_f32 v220, v220
    v_exp_f32 v221, v221
    v_exp_f32 v222, v222
    v_exp_f32 v223, v223
    v_smfmac_f32_32x32x32_bf16 v[146:161], v[104:107], v[210:217], v132
    s_mov_b64 exec, s[24:25]
    ds_read_b128 v[96:99], v137 offset:30720
    s_mov_b64 exec, -1
    v_exp_f32 v224, v224
    v_exp_f32 v225, v225
    v_exp_f32 v226, v226
    v_exp_f32 v227, v227
    v_smfmac_f32_32x32x32_bf16 v[146:161], v[108:111], v[218:225], v132
    s_mov_b64 exec, s[24:25]
    ds_read_b128 v[100:103], v137 offset:31360
    s_mov_b64 exec, -1
    v_exp_f32 v228, v228
    v_exp_f32 v229, v229
    v_exp_f32 v230, v230
    v_exp_f32 v231, v231
    v_mfma_f32_32x32x16_bf16 v[178:193], v[16:19], v[242:245], v[178:193]
    v_exp_f32 v232, v232
    v_exp_f32 v233, v233
    v_exp_f32 v234, v234
    v_exp_f32 v235, v235
    v_smfmac_f32_32x32x32_bf16 v[162:177], v[104:107], v[226:233], v132
    v_exp_f32 v236, v236
    v_exp_f32 v237, v237
    v_exp_f32 v238, v238
    v_exp_f32 v239, v239
    v_mfma_f32_32x32x16_bf16 v[194:209], v[16:19], v[246:249], v[194:209]
    v_exp_f32 v240, v240
    v_exp_f32 v241, v241
    v_exp_f32 v178, v178
    v_exp_f32 v179, v179
    v_smfmac_f32_32x32x32_bf16 v[162:177], v[108:111], v[234:241], v132
    s_waitcnt lgkmcnt(0)
    s_setprio 1
    v_exp_f32 v180, v180
    v_exp_f32 v181, v181
    v_exp_f32 v182, v182
    v_exp_f32 v183, v183
    v_mfma_f32_32x32x4_2b_bf16 v[210:241], v[30:31], v[250:251], 0 cbsz:1 abid:1
    v_exp_f32 v184, v184
    v_exp_f32 v185, v185
    v_exp_f32 v186, v186
    v_exp_f32 v187, v187
    v_exp_f32 v188, v188
    v_exp_f32 v189, v189
    v_exp_f32 v190, v190
    v_exp_f32 v191, v191
    v_smfmac_f32_32x32x32_bf16 v[146:161], v[96:99], v[178:185], v132
    s_mov_b64 exec, s[24:25]
    ds_read_b128 v[104:107], v137 offset:32000
    s_mov_b64 exec, -1
    v_exp_f32 v192, v192
    v_exp_f32 v193, v193
    v_exp_f32 v194, v194
    v_exp_f32 v195, v195
    v_smfmac_f32_32x32x32_bf16 v[146:161], v[100:103], v[186:193], v132
    s_mov_b64 exec, s[24:25]
    ds_read_b128 v[108:111], v137 offset:32640
    s_mov_b64 exec, -1
    v_exp_f32 v196, v196
    v_exp_f32 v197, v197
    v_exp_f32 v198, v198
    v_exp_f32 v199, v199
    v_mfma_f32_32x32x16_bf16 v[210:225], v[20:23], v[242:245], v[210:225]
    v_exp_f32 v200, v200
    v_exp_f32 v201, v201
    v_exp_f32 v202, v202
    v_exp_f32 v203, v203
    v_smfmac_f32_32x32x32_bf16 v[162:177], v[96:99], v[194:201], v132
    v_exp_f32 v204, v204
    v_exp_f32 v205, v205
    v_exp_f32 v206, v206
    v_exp_f32 v207, v207
    v_mfma_f32_32x32x16_bf16 v[226:241], v[20:23], v[246:249], v[226:241]
    v_exp_f32 v208, v208
    v_exp_f32 v209, v209
    v_exp_f32 v210, v210
    v_exp_f32 v211, v211
    v_smfmac_f32_32x32x32_bf16 v[162:177], v[100:103], v[202:209], v132
    s_waitcnt lgkmcnt(0)
    s_setprio 0
    v_exp_f32 v212, v212
    v_exp_f32 v213, v213
    v_exp_f32 v214, v214
    v_exp_f32 v215, v215
    v_exp_f32 v216, v216
    v_exp_f32 v217, v217
    v_exp_f32 v218, v218
    v_exp_f32 v219, v219
    v_exp_f32 v220, v220
    v_exp_f32 v221, v221
    v_exp_f32 v222, v222
    v_exp_f32 v223, v223
    v_smfmac_f32_32x32x32_bf16 v[146:161], v[104:107], v[210:217], v132
    v_exp_f32 v224, v224
    v_exp_f32 v225, v225
    v_exp_f32 v226, v226
    v_exp_f32 v227, v227
    v_smfmac_f32_32x32x32_bf16 v[146:161], v[108:111], v[218:225], v132
    v_exp_f32 v228, v228
    v_exp_f32 v229, v229
    v_exp_f32 v230, v230
    v_exp_f32 v231, v231
    v_exp_f32 v232, v232
    v_exp_f32 v233, v233
    v_exp_f32 v234, v234
    v_exp_f32 v235, v235
    v_smfmac_f32_32x32x32_bf16 v[162:177], v[104:107], v[226:233], v132
    v_exp_f32 v236, v236
    v_exp_f32 v237, v237
    v_exp_f32 v238, v238
    v_exp_f32 v239, v239
    ds_write_b128 v128, v[154:157] offset:2048
    ds_write_b128 v128, v[146:149] offset:0
    ds_write_b128 v128, v[150:153] offset:1024
    v_exp_f32 v240, v240
    v_exp_f32 v241, v241
    s_branch L_epi
.p2align 12
.fill 32, 4, 0xbf800000
L_early:
    s_mov_b32 s35, 0
    v_mov_b32 v7, 1
    s_cmp_eq_u32 s16, 5
    s_cbranch_scc0 L_gwe
    s_mov_b32 s35, 0
L_poll1e:
    buffer_load_dword v5, v124, s[44:47], s33 offen sc1
    buffer_load_dword v3, v125, s[44:47], s33 offen sc1
L_poll1e_chk:
    s_waitcnt vmcnt(0)
L_poll1e_first:
    s_waitcnt vmcnt(2)
    v_and_b32 v2, v5, v3
    v_cmp_ne_u32 vcc, 0, v2
    s_nop 0
    s_cmp_eq_u64 vcc, -1
    s_cselect_b32 s35, 1048576, s35
    s_add_u32 s35, s35, 1
    s_cmp_lt_u32 s35, 1048576
    s_cbranch_scc1 L_poll1e
L_poll1e_ok:
    ds_write_b32 v11, v7
    s_branch L_gwe_ok
L_gwe:
    s_sleep 1
    ds_read_b32 v7, v11
    s_waitcnt lgkmcnt(0)
    v_readfirstlane_b32 s34, v7
    s_cmp_lg_u32 s34, 0
    s_cselect_b32 s35, 4194304, s35
    s_add_u32 s35, s35, 1
    s_cmp_lt_u32 s35, 4194304
    s_cbranch_scc1 L_gwe
L_gwe_ok:
    s_add_u32 s3, s27, 0
    s_and_b32 s3, s3, 15
    s_mul_i32 s3, s3, 5120
    s_add_u32 m0, s28, 0
    s_add_u32 s29, s61, s3
    buffer_load_dwordx4 v121, s[44:47], s29 offen sc1 lds
    buffer_load_dwordx4 v121, s[44:47], s29 offen offset:1024 sc1 lds
    buffer_load_dwordx4 v121, s[44:47], s29 offen offset:2048 sc1 lds
    buffer_load_dwordx4 v121, s[44:47], s29 offen offset:3072 sc1 lds
    s_add_u32 m0, s28, 4096
    s_add_u32 s29, s29, 4096
    buffer_load_dwordx4 v121, s[44:47], s29 offen sc1 lds
    buffer_load_dwordx2 v[250:251], v123, s[44:47], s26 offen offset:2048 sc1
    buffer_load_dwordx2 v[242:243], v122, s[44:47], s22 offen sc1
    buffer_load_dwordx2 v[244:245], v122, s[44:47], s22 offen offset:1024 sc1
    buffer_load_dwordx2 v[246:247], v122, s[44:47], s23 offen sc1
    buffer_load_dwordx2 v[248:249], v122, s[44:47], s23 offen offset:1024 sc1
    s_waitcnt vmcnt(5)
    s_add_u32 s3, s27, 4
    s_and_b32 s3, s3, 15
    s_mul_i32 s3, s3, 5120
    s_add_u32 m0, s28, 20480
    s_add_u32 s29, s61, s3
    buffer_load_dwordx4 v121, s[44:47], s29 offen sc1 lds
    buffer_load_dwordx4 v121, s[44:47], s29 offen offset:1024 sc1 lds
    buffer_load_dwordx4 v121, s[44:47], s29 offen offset:2048 sc1 lds
    buffer_load_dwordx4 v121, s[44:47], s29 offen offset:3072 sc1 lds
    s_add_u32 m0, s28, 24576
    s_add_u32 s29, s29, 4096
    buffer_load_dwordx4 v121, s[44:47], s29 offen sc1 lds
    s_waitcnt vmcnt(5) lgkmcnt(0)
    s_barrier
    s_setprio 3
    ds_read2st64_b64 v[24:27], v135 offset0:4 offset1:24
    ds_read2st64_b64 v[16:19], v133 offset0:0 offset1:2
    ds_read2st64_b64 v[20:23], v134 offset0:0 offset1:2
    s_mov_b64 exec, s[24:25]
    ds_read_b128 v[96:99], v136 offset:0
    ds_read_b128 v[100:103], v136 offset:640
    s_mov_b64 exec, -1
    s_lshr_b32 s3, s2, 5
    s_mul_i32 s30, s3, 160
    s_mul_i32 s3, s16, 40960
    s_add_u32 s30, s30, s3
    s_mul_i32 s32, s16, 5120
    s_waitcnt lgkmcnt(4)
    v_mfma_f32_32x32x4_2b_bf16 v[178:209], v[24:25], v[250:251], 0 cbsz:1 abid:0
    s_nop 15
    s_nop 1
    s_waitcnt lgkmcnt(3)
    v_mfma_f32_32x32x16_bf16 v[178:193], v[16:19], v[242:245], v[178:193]
    v_mfma_f32_32x32x16_bf16 v[194:209], v[16:19], v[246:249], v[194:209]
    s_nop 10
.p2align 3
    v_exp_f32 v178, v178
    v_exp_f32 v179, v179
    s_waitcnt lgkmcnt(0)
    s_nop 0
    ds_read2st64_b64 v[16:19], v133 offset0:20 offset1:22
    v_exp_f32 v180, v180
    v_exp_f32 v181, v181
    v_exp_f32 v182, v182
    v_exp_f32 v183, v183
    v_mfma_f32_32x32x4_2b_bf16 v[210:241], v[24:25], v[250:251], 0 cbsz:1 abid:1
    v_exp_f32 v184, v184
    v_exp_f32 v185, v185
    v_exp_f32 v186, v186
    v_exp_f32 v187, v187
    v_exp_f32 v188, v188
    v_exp_f32 v189, v189
    v_exp_f32 v190, v190
    v_exp_f32 v191, v191
    v_smfmac_f32_32x32x32_bf16 v[146:161], v[96:99], v[178:185], v132
    s_mov_b64 exec, s[24:25]
    ds_read_b128 v[104:107], v136 offset:1280
    ds_read_b128 v[108:111], v136 offset:1920
    s_mov_b64 exec, -1
    v_exp_f32 v192, v192
    v_exp_f32 v193, v193
    v_exp_f32 v194, v194
    v_exp_f32 v195, v195
    v_smfmac_f32_32x32x32_bf16 v[146:161], v[100:103], v[186:193], v132
    v_exp_f32 v196, v196
    v_exp_f32 v197, v197
    v_exp_f32 v198, v198
    v_exp_f32 v199, v199
    v_mfma_f32_32x32x16_bf16 v[210:225], v[20:23], v[242:245], v[210:225]
    v_exp_f32 v200, v200
    v_exp_f32 v201, v201
    v_exp_f32 v202, v202
    v_exp_f32 v203, v203
    v_smfmac_f32_32x32x32_bf16 v[162:177], v[96:99], v[194:201], v132
    v_exp_f32 v204, v204
    v_exp_f32 v205, v205
    v_exp_f32 v206, v206
    v_exp_f32 v207, v207
    v_mfma_f32_32x32x16_bf16 v[226:241], v[20:23], v[246:249], v[226:241]
    v_exp_f32 v208, v208
    v_exp_f32 v209, v209
    v_exp_f32 v210, v210
    v_exp_f32 v211, v211
    v_smfmac_f32_32x32x32_bf16 v[162:177], v[100:103], v[202:209], v132
    s_waitcnt lgkmcnt(0)
    s_nop 0
    ds_read2st64_b64 v[20:23], v134 offset0:20 offset1:22
    v_exp_f32 v212, v212
    v_exp_f32 v213, v213
    v_exp_f32 v214, v214
    v_exp_f32 v215, v215
    v_mfma_f32_32x32x4_2b_bf16 v[178:209], v[26:27], v[250:251], 0 cbsz:1 abid:0
    v_exp_f32 v216, v216
    v_exp_f32 v217, v217
    v_exp_f32 v218, v218
    v_exp_f32 v219, v219
    v_exp_f32 v220, v220
    v_exp_f32 v221, v221
    v_exp_f32 v222, v222
    v_exp_f32 v223, v223
    v_smfmac_f32_32x32x32_bf16 v[146:161], v[104:107], v[210:217], v132
    s_mov_b64 exec, s[24:25]
    ds_read_b128 v[96:99], v136 offset:10240
    ds_read_b128 v[100:103], v136 offset:10880
    s_mov_b64 exec, -1
    v_exp_f32 v224, v224
    v_exp_f32 v225, v225
    v_exp_f32 v226, v226
    v_exp_f32 v227, v227
    v_smfmac_f32_32x32x32_bf16 v[146:161], v[108:111], v[218:225], v132
    v_exp_f32 v228, v228
    v_exp_f32 v229, v229
    v_exp_f32 v230, v230
    v_exp_f32 v231, v231
    v_mfma_f32_32x32x16_bf16 v[178:193], v[16:19], v[242:245], v[178:193]
    v_exp_f32 v232, v232
    v_exp_f32 v233, v233
    v_exp_f32 v234, v234
    v_exp_f32 v235, v235
    v_smfmac_f32_32x32x32_bf16 v[162:177], v[104:107], v[226:233], v132
    v_exp_f32 v236, v236
    v_exp_f32 v237, v237
    v_exp_f32 v238, v238
    v_exp_f32 v239, v239
    v_mfma_f32_32x32x16_bf16 v[194:209], v[16:19], v[246:249], v[194:209]
    v_exp_f32 v240, v240
    v_exp_f32 v241, v241
    v_exp_f32 v178, v178
    v_exp_f32 v179, v179
    v_smfmac_f32_32x32x32_bf16 v[162:177], v[108:111], v[234:241], v132
    s_waitcnt vmcnt(0) lgkmcnt(0)
    s_barrier
    ds_read2st64_b64 v[16:19], v133 offset0:40 offset1:42
    v_exp_f32 v180, v180
    v_exp_f32 v181, v181
    v_exp_f32 v182, v182
    v_exp_f32 v183, v183
    v_mfma_f32_32x32x4_2b_bf16 v[210:241], v[26:27], v[250:251], 0 cbsz:1 abid:1
    v_exp_f32 v184, v184
    v_exp_f32 v185, v185
    v_exp_f32 v186, v186
    v_exp_f32 v187, v187
    v_exp_f32 v188, v188
    v_exp_f32 v189, v189
    v_exp_f32 v190, v190
    v_exp_f32 v191, v191
    v_smfmac_f32_32x32x32_bf16 v[146:161], v[96:99], v[178:185], v132
    s_mov_b64 exec, s[24:25]
    ds_read_b128 v[104:107], v136 offset:11520
    ds_read_b128 v[108:111], v136 offset:12160
    s_mov_b64 exec, -1
    v_exp_f32 v192, v192
    v_exp_f32 v193, v193
    v_exp_f32 v194, v194
    v_exp_f32 v195, v195
    v_smfmac_f32_32x32x32_bf16 v[146:161], v[100:103], v[186:193], v132
    v_exp_f32 v196, v196
    v_exp_f32 v197, v197
    v_exp_f32 v198, v198
    v_exp_f32 v199, v199
    v_mfma_f32_32x32x16_bf16 v[210:225], v[20:23], v[242:245], v[210:225]
    v_exp_f32 v200, v200
    v_exp_f32 v201, v201
    v_exp_f32 v202, v202
    v_exp_f32 v203, v203
    v_smfmac_f32_32x32x32_bf16 v[162:177], v[96:99], v[194:201], v132
    ds_read2st64_b64 v[28:31], v135 offset0:44 offset1:64
    v_exp_f32 v204, v204
    v_exp_f32 v205, v205
    v_exp_f32 v206, v206
    v_exp_f32 v207, v207
    v_mfma_f32_32x32x16_bf16 v[226:241], v[20:23], v[246:249], v[226:241]
    v_exp_f32 v208, v208
    v_exp_f32 v209, v209
    v_exp_f32 v210, v210
    v_exp_f32 v211, v211
    v_smfmac_f32_32x32x32_bf16 v[162:177], v[100:103], v[202:209], v132
    s_waitcnt lgkmcnt(0)
    s_nop 0
    ds_read2st64_b64 v[20:23], v134 offset0:40 offset1:42
    v_exp_f32 v212, v212
    v_exp_f32 v213, v213
    v_exp_f32 v214, v214
    v_exp_f32 v215, v215
    v_mfma_f32_32x32x4_2b_bf16 v[178:209], v[28:29], v[250:251], 0 cbsz:1 abid:0
    v_exp_f32 v216, v216
    v_exp_f32 v217, v217
    v_exp_f32 v218, v218
    v_exp_f32 v219, v219
    v_exp_f32 v220, v220
    v_exp_f32 v221, v221
    v_exp_f32 v222, v222
    v_exp_f32 v223, v223
    v_smfmac_f32_32x32x32_bf16 v[146:161], v[104:107], v[210:217], v132
    s_mov_b64 exec, s[24:25]
    ds_read_b128 v[96:99], v136 offset:20480
    ds_read_b128 v[100:103], v136 offset:21120
    s_mov_b64 exec, -1
    v_exp_f32 v224, v224
    v_exp_f32 v225, v225
    v_exp_f32 v226, v226
    v_exp_f32 v227, v227
    v_smfmac_f32_32x32x32_bf16 v[146:161], v[108:111], v[218:225], v132
    v_exp_f32 v228, v228
    v_exp_f32 v229, v229
    v_exp_f32 v230, v230
    v_exp_f32 v231, v231
    v_mfma_f32_32x32x16_bf16 v[178:193], v[16:19], v[242:245], v[178:193]
    v_exp_f32 v232, v232
    v_exp_f32 v233, v233
    v_exp_f32 v234, v234
    v_exp_f32 v235, v235
    v_smfmac_f32_32x32x32_bf16 v[162:177], v[104:107], v[226:233], v132
    v_exp_f32 v236, v236
    v_exp_f32 v237, v237
    v_exp_f32 v238, v238
    v_exp_f32 v239, v239
    v_mfma_f32_32x32x16_bf16 v[194:209], v[16:19], v[246:249], v[194:209]
    v_exp_f32 v240, v240
    v_exp_f32 v241, v241
    v_exp_f32 v178, v178
    v_exp_f32 v179, v179
    v_smfmac_f32_32x32x32_bf16 v[162:177], v[108:111], v[234:241], v132
    s_waitcnt lgkmcnt(0)
    s_nop 0
    ds_read2st64_b64 v[16:19], v133 offset0:60 offset1:62
    v_exp_f32 v180, v180
    v_exp_f32 v181, v181
    v_exp_f32 v182, v182
    v_exp_f32 v183, v183
    v_mfma_f32_32x32x4_2b_bf16 v[210:241], v[28:29], v[250:251], 0 cbsz:1 abid:1
    v_exp_f32 v184, v184
    v_exp_f32 v185, v185
    v_exp_f32 v186, v186
    v_exp_f32 v187, v187
    v_exp_f32 v188, v188
    v_exp_f32 v189, v189
    v_exp_f32 v190, v190
    v_exp_f32 v191, v191
    v_smfmac_f32_32x32x32_bf16 v[146:161], v[96:99], v[178:185], v132
    s_mov_b64 exec, s[24:25]
    ds_read_b128 v[104:107], v136 offset:21760
    ds_read_b128 v[108:111], v136 offset:22400
    s_mov_b64 exec, -1
    v_exp_f32 v192, v192
    v_exp_f32 v193, v193
    v_exp_f32 v194, v194
    v_exp_f32 v195, v195
    v_smfmac_f32_32x32x32_bf16 v[146:161], v[100:103], v[186:193], v132
    v_exp_f32 v196, v196
    v_exp_f32 v197, v197
    v_exp_f32 v198, v198
    v_exp_f32 v199, v199
    v_mfma_f32_32x32x16_bf16 v[210:225], v[20:23], v[242:245], v[210:225]
    v_exp_f32 v200, v200
    v_exp_f32 v201, v201
    v_exp_f32 v202, v202
    v_exp_f32 v203, v203
    v_smfmac_f32_32x32x32_bf16 v[162:177], v[96:99], v[194:201], v132
    v_exp_f32 v204, v204
    v_exp_f32 v205, v205
    v_exp_f32 v206, v206
    v_exp_f32 v207, v207
    v_mfma_f32_32x32x16_bf16 v[226:241], v[20:23], v[246:249], v[226:241]
    v_exp_f32 v208, v208
    v_exp_f32 v209, v209
    v_exp_f32 v210, v210
    v_exp_f32 v211, v211
    v_smfmac_f32_32x32x32_bf16 v[162:177], v[100:103], v[202:209], v132
    s_waitcnt lgkmcnt(0)
    s_nop 0
    ds_read2st64_b64 v[20:23], v134 offset0:60 offset1:62
    v_exp_f32 v212, v212
    v_exp_f32 v213, v213
    v_exp_f32 v214, v214
    v_exp_f32 v215, v215
    v_mfma_f32_32x32x4_2b_bf16 v[178:209], v[30:31], v[250:251], 0 cbsz:1 abid:0
    v_exp_f32 v216, v216
    v_exp_f32 v217, v217
    v_exp_f32 v218, v218
    v_exp_f32 v219, v219
    v_exp_f32 v220, v220
    v_exp_f32 v221, v221
    v_exp_f32 v222, v222
    v_exp_f32 v223, v223
    v_smfmac_f32_32x32x32_bf16 v[146:161], v[104:107], v[210:217], v132
    s_mov_b64 exec, s[24:25]
    ds_read_b128 v[96:99], v136 offset:30720
    ds_read_b128 v[100:103], v136 offset:31360
    s_mov_b64 exec, -1
    v_exp_f32 v224, v224
    v_exp_f32 v225, v225
    v_exp_f32 v226, v226
    v_exp_f32 v227, v227
    v_smfmac_f32_32x32x32_bf16 v[146:161], v[108:111], v[218:225], v132
    v_exp_f32 v228, v228
    v_exp_f32 v229, v229
    v_exp_f32 v230, v230
    v_exp_f32 v231, v231
    v_mfma_f32_32x32x16_bf16 v[178:193], v[16:19], v[242:245], v[178:193]
    v_exp_f32 v232, v232
    v_exp_f32 v233, v233
    v_exp_f32 v234, v234
    v_exp_f32 v235, v235
    v_smfmac_f32_32x32x32_bf16 v[162:177], v[104:107], v[226:233], v132
    v_exp_f32 v236, v236
    v_exp_f32 v237, v237
    v_exp_f32 v238, v238
    v_exp_f32 v239, v239
    v_mfma_f32_32x32x16_bf16 v[194:209], v[16:19], v[246:249], v[194:209]
    v_exp_f32 v240, v240
    v_exp_f32 v241, v241
    v_exp_f32 v178, v178
    v_exp_f32 v179, v179
    v_smfmac_f32_32x32x32_bf16 v[162:177], v[108:111], v[234:241], v132
    s_waitcnt lgkmcnt(0)
    s_barrier
    ds_read2st64_b64 v[16:19], v133 offset0:80 offset1:82
    v_exp_f32 v180, v180
    v_exp_f32 v181, v181
    v_exp_f32 v182, v182
    v_exp_f32 v183, v183
    v_mfma_f32_32x32x4_2b_bf16 v[210:241], v[30:31], v[250:251], 0 cbsz:1 abid:1
    v_exp_f32 v184, v184
    v_exp_f32 v185, v185
    v_exp_f32 v186, v186
    v_exp_f32 v187, v187
    v_exp_f32 v188, v188
    v_exp_f32 v189, v189
    v_exp_f32 v190, v190
    v_exp_f32 v191, v191
    v_smfmac_f32_32x32x32_bf16 v[146:161], v[96:99], v[178:185], v132
    s_mov_b64 exec, s[24:25]
    ds_read_b128 v[104:107], v136 offset:32000
    ds_read_b128 v[108:111], v136 offset:32640
    s_mov_b64 exec, -1
    v_exp_f32 v192, v192
    v_exp_f32 v193, v193
    v_exp_f32 v194, v194
    v_exp_f32 v195, v195
    v_smfmac_f32_32x32x32_bf16 v[146:161], v[100:103], v[186:193], v132
    v_exp_f32 v196, v196
    v_exp_f32 v197, v197
    v_exp_f32 v198, v198
    v_exp_f32 v199, v199
    v_mfma_f32_32x32x16_bf16 v[210:225], v[20:23], v[242:245], v[210:225]
    v_exp_f32 v200, v200
    v_exp_f32 v201, v201
    v_exp_f32 v202, v202
    v_exp_f32 v203, v203
    v_smfmac_f32_32x32x32_bf16 v[162:177], v[96:99], v[194:201], v132
    ds_read2st64_b64 v[24:27], v135 offset0:84 offset1:104
    v_exp_f32 v204, v204
    v_exp_f32 v205, v205
    v_exp_f32 v206, v206
    v_exp_f32 v207, v207
    v_mfma_f32_32x32x16_bf16 v[226:241], v[20:23], v[246:249], v[226:241]
    v_exp_f32 v208, v208
    v_exp_f32 v209, v209
    v_exp_f32 v210, v210
    v_exp_f32 v211, v211
    v_smfmac_f32_32x32x32_bf16 v[162:177], v[100:103], v[202:209], v132
    s_waitcnt lgkmcnt(0)
    s_nop 0
    ds_read2st64_b64 v[20:23], v134 offset0:80 offset1:82
    v_exp_f32 v212, v212
    v_exp_f32 v213, v213
    v_exp_f32 v214, v214
    v_exp_f32 v215, v215
    v_mfma_f32_32x32x4_2b_bf16 v[178:209], v[24:25], v[250:251], 0 cbsz:1 abid:0
    v_exp_f32 v216, v216
    v_exp_f32 v217, v217
    v_exp_f32 v218, v218
    v_exp_f32 v219, v219
    v_exp_f32 v220, v220
    v_exp_f32 v221, v221
    v_exp_f32 v222, v222
    v_exp_f32 v223, v223
    v_smfmac_f32_32x32x32_bf16 v[146:161], v[104:107], v[210:217], v132
    s_mov_b64 exec, s[24:25]
    ds_read_b128 v[96:99], v137 offset:0
    ds_read_b128 v[100:103], v137 offset:640
    s_mov_b64 exec, -1
    v_exp_f32 v224, v224
    v_exp_f32 v225, v225
    v_exp_f32 v226, v226
    v_exp_f32 v227, v227
    v_smfmac_f32_32x32x32_bf16 v[146:161], v[108:111], v[218:225], v132
    v_exp_f32 v228, v228
    v_exp_f32 v229, v229
    v_exp_f32 v230, v230
    v_exp_f32 v231, v231
    v_mfma_f32_32x32x16_bf16 v[178:193], v[16:19], v[242:245], v[178:193]
    v_exp_f32 v232, v232
    v_exp_f32 v233, v233
    v_exp_f32 v234, v234
    v_exp_f32 v235, v235
    v_smfmac_f32_32x32x32_bf16 v[162:177], v[104:107], v[226:233], v132
    v_exp_f32 v236, v236
    v_exp_f32 v237, v237
    v_exp_f32 v238, v238
    v_exp_f32 v239, v239
    v_mfma_f32_32x32x16_bf16 v[194:209], v[16:19], v[246:249], v[194:209]
    v_exp_f32 v240, v240
    v_exp_f32 v241, v241
    v_exp_f32 v178, v178
    v_exp_f32 v179, v179
    v_smfmac_f32_32x32x32_bf16 v[162:177], v[108:111], v[234:241], v132
    s_waitcnt lgkmcnt(0)
    s_nop 0
    ds_read2st64_b64 v[16:19], v133 offset0:100 offset1:102
    v_exp_f32 v180, v180
    v_exp_f32 v181, v181
    v_exp_f32 v182, v182
    v_exp_f32 v183, v183
    v_mfma_f32_32x32x4_2b_bf16 v[210:241], v[24:25], v[250:251], 0 cbsz:1 abid:1
    v_exp_f32 v184, v184
    v_exp_f32 v185, v185
    v_exp_f32 v186, v186
    v_exp_f32 v187, v187
    v_exp_f32 v188, v188
    v_exp_f32 v189, v189
    v_exp_f32 v190, v190
    v_exp_f32 v191, v191
    v_smfmac_f32_32x32x32_bf16 v[146:161], v[96:99], v[178:185], v132
    s_mov_b64 exec, s[24:25]
    ds_read_b128 v[104:107], v137 offset:1280
    ds_read_b128 v[108:111], v137 offset:1920
    s_mov_b64 exec, -1
    v_exp_f32 v192, v192
    v_exp_f32 v193, v193
    v_exp_f32 v194, v194
    v_exp_f32 v195, v195
    v_smfmac_f32_32x32x32_bf16 v[146:161], v[100:103], v[186:193], v132
    v_exp_f32 v196, v196
    v_exp_f32 v197, v197
    v_exp_f32 v198, v198
    v_exp_f32 v199, v199
    v_mfma_f32_32x32x16_bf16 v[210:225], v[20:23], v[242:245], v[210:225]
    v_exp_f32 v200, v200
    v_exp_f32 v201, v201
    v_exp_f32 v202, v202
    v_exp_f32 v203, v203
    v_smfmac_f32_32x32x32_bf16 v[162:177], v[96:99], v[194:201], v132
    v_exp_f32 v204, v204
    v_exp_f32 v205, v205
    v_exp_f32 v206, v206
    v_exp_f32 v207, v207
    v_mfma_f32_32x32x16_bf16 v[226:241], v[20:23], v[246:249], v[226:241]
    v_exp_f32 v208, v208
    v_exp_f32 v209, v209
    v_exp_f32 v210, v210
    v_exp_f32 v211, v211
    v_smfmac_f32_32x32x32_bf16 v[162:177], v[100:103], v[202:209], v132
    s_waitcnt lgkmcnt(0)
    s_nop 0
    ds_read2st64_b64 v[20:23], v134 offset0:100 offset1:102
    v_exp_f32 v212, v212
    v_exp_f32 v213, v213
    v_exp_f32 v214, v214
    v_exp_f32 v215, v215
    v_mfma_f32_32x32x4_2b_bf16 v[178:209], v[26:27], v[250:251], 0 cbsz:1 abid:0
    v_exp_f32 v216, v216
    v_exp_f32 v217, v217
    v_exp_f32 v218, v218
    v_exp_f32 v219, v219
    v_exp_f32 v220, v220
    v_exp_f32 v221, v221
    v_exp_f32 v222, v222
    v_exp_f32 v223, v223
    v_smfmac_f32_32x32x32_bf16 v[146:161], v[104:107], v[210:217], v132
    s_mov_b64 exec, s[24:25]
    ds_read_b128 v[96:99], v137 offset:10240
    ds_read_b128 v[100:103], v137 offset:10880
    s_mov_b64 exec, -1
    v_exp_f32 v224, v224
    v_exp_f32 v225, v225
    v_exp_f32 v226, v226
    v_exp_f32 v227, v227
    v_smfmac_f32_32x32x32_bf16 v[146:161], v[108:111], v[218:225], v132
    v_exp_f32 v228, v228
    v_exp_f32 v229, v229
    v_exp_f32 v230, v230
    v_exp_f32 v231, v231
    v_mfma_f32_32x32x16_bf16 v[178:193], v[16:19], v[242:245], v[178:193]
    v_exp_f32 v232, v232
    v_exp_f32 v233, v233
    v_exp_f32 v234, v234
    v_exp_f32 v235, v235
    v_smfmac_f32_32x32x32_bf16 v[162:177], v[104:107], v[226:233], v132
    v_exp_f32 v236, v236
    v_exp_f32 v237, v237
    v_exp_f32 v238, v238
    v_exp_f32 v239, v239
    v_mfma_f32_32x32x16_bf16 v[194:209], v[16:19], v[246:249], v[194:209]
    v_exp_f32 v240, v240
    v_exp_f32 v241, v241
    v_exp_f32 v178, v178
    v_exp_f32 v179, v179
    v_smfmac_f32_32x32x32_bf16 v[162:177], v[108:111], v[234:241], v132
    s_waitcnt lgkmcnt(0)
    s_nop 0
    ds_read2st64_b64 v[16:19], v133 offset0:120 offset1:122
    v_exp_f32 v180, v180
    v_exp_f32 v181, v181
    v_exp_f32 v182, v182
    v_exp_f32 v183, v183
    v_mfma_f32_32x32x4_2b_bf16 v[210:241], v[26:27], v[250:251], 0 cbsz:1 abid:1
    v_exp_f32 v184, v184
    v_exp_f32 v185, v185
    v_exp_f32 v186, v186
    v_exp_f32 v187, v187
    v_exp_f32 v188, v188
    v_exp_f32 v189, v189
    v_exp_f32 v190, v190
    v_exp_f32 v191, v191
    v_smfmac_f32_32x32x32_bf16 v[146:161], v[96:99], v[178:185], v132
    s_mov_b64 exec, s[24:25]
    ds_read_b128 v[104:107], v137 offset:11520
    ds_read_b128 v[108:111], v137 offset:12160
    s_mov_b64 exec, -1
    v_exp_f32 v192, v192
    v_exp_f32 v193, v193
    v_exp_f32 v194, v194
    v_exp_f32 v195, v195
    v_smfmac_f32_32x32x32_bf16 v[146:161], v[100:103], v[186:193], v132
    v_exp_f32 v196, v196
    v_exp_f32 v197, v197
    v_exp_f32 v198, v198
    v_exp_f32 v199, v199
    v_mfma_f32_32x32x16_bf16 v[210:225], v[20:23], v[242:245], v[210:225]
    v_exp_f32 v200, v200
    v_exp_f32 v201, v201
    v_exp_f32 v202, v202
    v_exp_f32 v203, v203
    v_smfmac_f32_32x32x32_bf16 v[162:177], v[96:99], v[194:201], v132
    ds_read2st64_b64 v[28:31], v135 offset0:124 offset1:144
    v_exp_f32 v204, v204
    v_exp_f32 v205, v205
    v_exp_f32 v206, v206
    v_exp_f32 v207, v207
    v_mfma_f32_32x32x16_bf16 v[226:241], v[20:23], v[246:249], v[226:241]
    v_exp_f32 v208, v208
    v_exp_f32 v209, v209
    v_exp_f32 v210, v210
    v_exp_f32 v211, v211
    v_smfmac_f32_32x32x32_bf16 v[162:177], v[100:103], v[202:209], v132
    s_waitcnt lgkmcnt(0)
    s_nop 0
    ds_read2st64_b64 v[20:23], v134 offset0:120 offset1:122
    v_exp_f32 v212, v212
    v_exp_f32 v213, v213
    v_exp_f32 v214, v214
    v_exp_f32 v215, v215
    v_mfma_f32_32x32x4_2b_bf16 v[178:209], v[28:29], v[250:251], 0 cbsz:1 abid:0
    v_exp_f32 v216, v216
    v_exp_f32 v217, v217
    v_exp_f32 v218, v218
    v_exp_f32 v219, v219
    v_exp_f32 v220, v220
    v_exp_f32 v221, v221
    v_exp_f32 v222, v222
    v_exp_f32 v223, v223
    v_smfmac_f32_32x32x32_bf16 v[146:161], v[104:107], v[210:217], v132
    s_mov_b64 exec, s[24:25]
    ds_read_b128 v[96:99], v137 offset:20480
    ds_read_b128 v[100:103], v137 offset:21120
    s_mov_b64 exec, -1
    v_exp_f32 v224, v224
    v_exp_f32 v225, v225
    v_exp_f32 v226, v226
    v_exp_f32 v227, v227
    v_smfmac_f32_32x32x32_bf16 v[146:161], v[108:111], v[218:225], v132
    v_exp_f32 v228, v228
    v_exp_f32 v229, v229
    v_exp_f32 v230, v230
    v_exp_f32 v231, v231
    v_mfma_f32_32x32x16_bf16 v[178:193], v[16:19], v[242:245], v[178:193]
    v_exp_f32 v232, v232
    v_exp_f32 v233, v233
    v_exp_f32 v234, v234
    v_exp_f32 v235, v235
    v_smfmac_f32_32x32x32_bf16 v[162:177], v[104:107], v[226:233], v132
    v_exp_f32 v236, v236
    v_exp_f32 v237, v237
    v_exp_f32 v238, v238
    v_exp_f32 v239, v239
    v_mfma_f32_32x32x16_bf16 v[194:209], v[16:19], v[246:249], v[194:209]
    v_exp_f32 v240, v240
    v_exp_f32 v241, v241
    v_exp_f32 v178, v178
    v_exp_f32 v179, v179
    v_smfmac_f32_32x32x32_bf16 v[162:177], v[108:111], v[234:241], v132
    s_waitcnt lgkmcnt(0)
    s_nop 0
    ds_read2st64_b64 v[16:19], v133 offset0:140 offset1:142
    v_exp_f32 v180, v180
    v_exp_f32 v181, v181
    v_exp_f32 v182, v182
    v_exp_f32 v183, v183
    v_mfma_f32_32x32x4_2b_bf16 v[210:241], v[28:29], v[250:251], 0 cbsz:1 abid:1
    v_exp_f32 v184, v184
    v_exp_f32 v185, v185
    v_exp_f32 v186, v186
    v_exp_f32 v187, v187
    v_exp_f32 v188, v188
    v_exp_f32 v189, v189
    v_exp_f32 v190, v190
    v_exp_f32 v191, v191
    v_smfmac_f32_32x32x32_bf16 v[146:161], v[96:99], v[178:185], v132
    s_mov_b64 exec, s[24:25]
    ds_read_b128 v[104:107], v137 offset:21760
    ds_read_b128 v[108:111], v137 offset:22400
    s_mov_b64 exec, -1
    v_exp_f32 v192, v192
    v_exp_f32 v193, v193
    v_exp_f32 v194, v194
    v_exp_f32 v195, v195
    v_smfmac_f32_32x32x32_bf16 v[146:161], v[100:103], v[186:193], v132
    v_exp_f32 v196, v196
    v_exp_f32 v197, v197
    v_exp_f32 v198, v198
    v_exp_f32 v199, v199
    v_mfma_f32_32x32x16_bf16 v[210:225], v[20:23], v[242:245], v[210:225]
    v_exp_f32 v200, v200
    v_exp_f32 v201, v201
    v_exp_f32 v202, v202
    v_exp_f32 v203, v203
    v_smfmac_f32_32x32x32_bf16 v[162:177], v[96:99], v[194:201], v132
    v_exp_f32 v204, v204
    v_exp_f32 v205, v205
    v_exp_f32 v206, v206
    v_exp_f32 v207, v207
    v_mfma_f32_32x32x16_bf16 v[226:241], v[20:23], v[246:249], v[226:241]
    v_exp_f32 v208, v208
    v_exp_f32 v209, v209
    v_exp_f32 v210, v210
    v_exp_f32 v211, v211
    v_smfmac_f32_32x32x32_bf16 v[162:177], v[100:103], v[202:209], v132
    s_waitcnt lgkmcnt(0)
    s_nop 0
    ds_read2st64_b64 v[20:23], v134 offset0:140 offset1:142
    v_exp_f32 v212, v212
    v_exp_f32 v213, v213
    v_exp_f32 v214, v214
    v_exp_f32 v215, v215
    v_mfma_f32_32x32x4_2b_bf16 v[178:209], v[30:31], v[250:251], 0 cbsz:1 abid:0
    v_exp_f32 v216, v216
    v_exp_f32 v217, v217
    v_exp_f32 v218, v218
    v_exp_f32 v219, v219
    v_exp_f32 v220, v220
    v_exp_f32 v221, v221
    v_exp_f32 v222, v222
    v_exp_f32 v223, v223
    v_smfmac_f32_32x32x32_bf16 v[146:161], v[104:107], v[210:217], v132
    s_mov_b64 exec, s[24:25]
    ds_read_b128 v[96:99], v137 offset:30720
    ds_read_b128 v[100:103], v137 offset:31360
    s_mov_b64 exec, -1
    v_exp_f32 v224, v224
    v_exp_f32 v225, v225
    v_exp_f32 v226, v226
    v_exp_f32 v227, v227
    v_smfmac_f32_32x32x32_bf16 v[146:161], v[108:111], v[218:225], v132
    v_exp_f32 v228, v228
    v_exp_f32 v229, v229
    v_exp_f32 v230, v230
    v_exp_f32 v231, v231
    v_mfma_f32_32x32x16_bf16 v[178:193], v[16:19], v[242:245], v[178:193]
    v_exp_f32 v232, v232
    v_exp_f32 v233, v233
    v_exp_f32 v234, v234
    v_exp_f32 v235, v235
    v_smfmac_f32_32x32x32_bf16 v[162:177], v[104:107], v[226:233], v132
    v_exp_f32 v236, v236
    v_exp_f32 v237, v237
    v_exp_f32 v238, v238
    v_exp_f32 v239, v239
    v_mfma_f32_32x32x16_bf16 v[194:209], v[16:19], v[246:249], v[194:209]
    v_exp_f32 v240, v240
    v_exp_f32 v241, v241
    v_exp_f32 v178, v178
    v_exp_f32 v179, v179
    v_smfmac_f32_32x32x32_bf16 v[162:177], v[108:111], v[234:241], v132
    s_waitcnt lgkmcnt(0)
    s_barrier
    s_setprio 1
    s_nop 0
    v_add_u32 v133, 81920, v133
    v_add_u32 v134, 81920, v134
    v_add_u32 v135, 81920, v135
    v_add_u32 v136, 81920, v136
    ds_read2st64_b64 v[16:19], v133 offset0:0 offset1:2
    v_exp_f32 v180, v180
    v_exp_f32 v181, v181
    v_exp_f32 v182, v182
    v_exp_f32 v183, v183
    v_mfma_f32_32x32x4_2b_bf16 v[210:241], v[30:31], v[250:251], 0 cbsz:1 abid:1
    v_exp_f32 v184, v184
    v_exp_f32 v185, v185
    v_exp_f32 v186, v186
    v_exp_f32 v187, v187
    v_exp_f32 v188, v188
    v_exp_f32 v189, v189
    v_exp_f32 v190, v190
    v_exp_f32 v191, v191
    v_smfmac_f32_32x32x32_bf16 v[146:161], v[96:99], v[178:185], v132
    s_mov_b64 exec, s[24:25]
    ds_read_b128 v[104:107], v137 offset:32000
    ds_read_b128 v[108:111], v137 offset:32640
    s_mov_b64 exec, -1
    v_exp_f32 v192, v192
    v_exp_f32 v193, v193
    v_exp_f32 v194, v194
    v_exp_f32 v195, v195
    v_smfmac_f32_32x32x32_bf16 v[146:161], v[100:103], v[186:193], v132
    v_exp_f32 v196, v196
    v_exp_f32 v197, v197
    v_exp_f32 v198, v198
    v_exp_f32 v199, v199
    v_mfma_f32_32x32x16_bf16 v[210:225], v[20:23], v[242:245], v[210:225]
    v_exp_f32 v200, v200
    v_exp_f32 v201, v201
    v_exp_f32 v202, v202
    v_exp_f32 v203, v203
    v_smfmac_f32_32x32x32_bf16 v[162:177], v[96:99], v[194:201], v132
    ds_read2st64_b64 v[24:27], v135 offset0:4 offset1:24
    v_exp_f32 v204, v204
    v_exp_f32 v205, v205
    v_exp_f32 v206, v206
    v_exp_f32 v207, v207
    v_mfma_f32_32x32x16_bf16 v[226:241], v[20:23], v[246:249], v[226:241]
    v_exp_f32 v208, v208
    v_exp_f32 v209, v209
    v_exp_f32 v210, v210
    v_exp_f32 v211, v211
    v_smfmac_f32_32x32x32_bf16 v[162:177], v[100:103], v[202:209], v132
    s_waitcnt lgkmcnt(0)
    s_nop 0
    ds_read2st64_b64 v[20:23], v134 offset0:0 offset1:2
    v_exp_f32 v212, v212
    v_exp_f32 v213, v213
    v_exp_f32 v214, v214
    v_exp_f32 v215, v215
    v_mfma_f32_32x32x4_2b_bf16 v[178:209], v[24:25], v[250:251], 0 cbsz:1 abid:0
    v_exp_f32 v216, v216
    v_exp_f32 v217, v217
    v_exp_f32 v218, v218
    v_exp_f32 v219, v219
    v_exp_f32 v220, v220
    v_exp_f32 v221, v221
    v_exp_f32 v222, v222
    v_exp_f32 v223, v223
    v_smfmac_f32_32x32x32_bf16 v[146:161], v[104:107], v[210:217], v132
    s_mov_b64 exec, s[24:25]
    ds_read_b128 v[96:99], v136 offset:0
    ds_read_b128 v[100:103], v136 offset:640
    s_mov_b64 exec, -1
    v_exp_f32 v224, v224
    v_exp_f32 v225, v225
    v_exp_f32 v226, v226
    v_exp_f32 v227, v227
    v_smfmac_f32_32x32x32_bf16 v[146:161], v[108:111], v[218:225], v132
    v_exp_f32 v228, v228
    v_exp_f32 v229, v229
    v_exp_f32 v230, v230
    v_exp_f32 v231, v231
    v_mfma_f32_32x32x16_bf16 v[178:193], v[16:19], v[242:245], v[178:193]
    v_exp_f32 v232, v232
    v_exp_f32 v233, v233
    v_exp_f32 v234, v234
    v_exp_f32 v235, v235
    v_smfmac_f32_32x32x32_bf16 v[162:177], v[104:107], v[226:233], v132
    v_exp_f32 v236, v236
    v_exp_f32 v237, v237
    v_exp_f32 v238, v238
    v_exp_f32 v239, v239
    v_mfma_f32_32x32x16_bf16 v[194:209], v[16:19], v[246:249], v[194:209]
    v_exp_f32 v240, v240
    v_exp_f32 v241, v241
    v_exp_f32 v178, v178
    v_exp_f32 v179, v179
    v_smfmac_f32_32x32x32_bf16 v[162:177], v[108:111], v[234:241], v132
    s_waitcnt lgkmcnt(0)
    s_nop 0
    v_add_u32 v137, 81920, v137
    ds_read2st64_b64 v[16:19], v133 offset0:20 offset1:22
    v_exp_f32 v180, v180
    v_exp_f32 v181, v181
    v_exp_f32 v182, v182
    v_exp_f32 v183, v183
    v_mfma_f32_32x32x4_2b_bf16 v[210:241], v[24:25], v[250:251], 0 cbsz:1 abid:1
    v_exp_f32 v184, v184
    v_exp_f32 v185, v185
    v_exp_f32 v186, v186
    v_exp_f32 v187, v187
    v_exp_f32 v188, v188
    v_exp_f32 v189, v189
    v_exp_f32 v190, v190
    v_exp_f32 v191, v191
    v_smfmac_f32_32x32x32_bf16 v[146:161], v[96:99], v[178:185], v132
    s_mov_b64 exec, s[24:25]
    ds_read_b128 v[104:107], v136 offset:1280
    s_mov_b64 exec, -1
    v_exp_f32 v192, v192
    v_exp_f32 v193, v193
    v_exp_f32 v194, v194
    v_exp_f32 v195, v195
    v_smfmac_f32_32x32x32_bf16 v[146:161], v[100:103], v[186:193], v132
    s_mov_b64 exec, s[24:25]
    ds_read_b128 v[108:111], v136 offset:1920
    s_mov_b64 exec, -1
    v_exp_f32 v196, v196
    v_exp_f32 v197, v197
    v_exp_f32 v198, v198
    v_exp_f32 v199, v199
    v_mfma_f32_32x32x16_bf16 v[210:225], v[20:23], v[242:245], v[210:225]
    buffer_store_dwordx4 v[112:115], v126, s[44:47], s36 offen sc1
    v_exp_f32 v200, v200
    v_exp_f32 v201, v201
    v_exp_f32 v202, v202
    v_exp_f32 v203, v203
    v_smfmac_f32_32x32x32_bf16 v[162:177], v[96:99], v[194:201], v132
    s_mov_b32 exec_hi, 0
    buffer_store_dwordx2 v[112:113], v127, s[44:47], s37 offen sc1
    s_mov_b32 exec_hi, -1
    v_exp_f32 v204, v204
    v_exp_f32 v205, v205
    v_exp_f32 v206, v206
    v_exp_f32 v207, v207
    v_mfma_f32_32x32x16_bf16 v[226:241], v[20:23], v[246:249], v[226:241]
    v_exp_f32 v208, v208
    v_exp_f32 v209, v209
    v_exp_f32 v210, v210
    v_exp_f32 v211, v211
    v_smfmac_f32_32x32x32_bf16 v[162:177], v[100:103], v[202:209], v132
    s_waitcnt lgkmcnt(0)
    s_nop 0
    ds_read2st64_b64 v[20:23], v134 offset0:20 offset1:22
    v_exp_f32 v212, v212
    v_exp_f32 v213, v213
    v_exp_f32 v214, v214
    v_exp_f32 v215, v215
    v_mfma_f32_32x32x4_2b_bf16 v[178:209], v[26:27], v[250:251], 0 cbsz:1 abid:0
    v_exp_f32 v216, v216
    v_exp_f32 v217, v217
    v_exp_f32 v218, v218
    v_exp_f32 v219, v219
    v_exp_f32 v220, v220
    v_exp_f32 v221, v221
    v_exp_f32 v222, v222
    v_exp_f32 v223, v223
    v_smfmac_f32_32x32x32_bf16 v[146:161], v[104:107], v[210:217], v132
    s_mov_b64 exec, s[24:25]
    ds_read_b128 v[96:99], v136 offset:10240
    s_mov_b64 exec, -1
    v_exp_f32 v224, v224
    v_exp_f32 v225, v225
    v_exp_f32 v226, v226
    v_exp_f32 v227, v227
    v_smfmac_f32_32x32x32_bf16 v[146:161], v[108:111], v[218:225], v132
    s_mov_b64 exec, s[24:25]
    ds_read_b128 v[100:103], v136 offset:10880
    s_mov_b64 exec, -1
    v_exp_f32 v228, v228
    v_exp_f32 v229, v229
    v_exp_f32 v230, v230
    v_exp_f32 v231, v231
    v_mfma_f32_32x32x16_bf16 v[178:193], v[16:19], v[242:245], v[178:193]
    v_exp_f32 v232, v232
    v_exp_f32 v233, v233
    v_exp_f32 v234, v234
    v_exp_f32 v235, v235
    v_smfmac_f32_32x32x32_bf16 v[162:177], v[104:107], v[226:233], v132
    v_exp_f32 v236, v236
    v_exp_f32 v237, v237
    v_exp_f32 v238, v238
    v_exp_f32 v239, v239
    v_mfma_f32_32x32x16_bf16 v[194:209], v[16:19], v[246:249], v[194:209]
    v_exp_f32 v240, v240
    v_exp_f32 v241, v241
    v_exp_f32 v178, v178
    v_exp_f32 v179, v179
    v_smfmac_f32_32x32x32_bf16 v[162:177], v[108:111], v[234:241], v132
    s_waitcnt vmcnt(0) lgkmcnt(0)
    s_barrier
    s_setprio 3
    s_nop 0
    ds_read2st64_b64 v[16:19], v133 offset0:40 offset1:42
    v_exp_f32 v180, v180
    v_exp_f32 v181, v181
    v_exp_f32 v182, v182
    v_exp_f32 v183, v183
    v_mfma_f32_32x32x4_2b_bf16 v[210:241], v[26:27], v[250:251], 0 cbsz:1 abid:1
    v_exp_f32 v184, v184
    v_exp_f32 v185, v185
    v_exp_f32 v186, v186
    v_exp_f32 v187, v187
    v_exp_f32 v188, v188
    v_exp_f32 v189, v189
    v_exp_f32 v190, v190
    v_exp_f32 v191, v191
    v_smfmac_f32_32x32x32_bf16 v[146:161], v[96:99], v[178:185], v132
    s_mov_b64 exec, s[24:25]
    ds_read_b128 v[104:107], v136 offset:11520
    s_mov_b64 exec, -1
    v_exp_f32 v192, v192
    v_exp_f32 v193, v193
    v_exp_f32 v194, v194
    v_exp_f32 v195, v195
    v_smfmac_f32_32x32x32_bf16 v[146:161], v[100:103], v[186:193], v132
    s_mov_b64 exec, s[24:25]
    ds_read_b128 v[108:111], v136 offset:12160
    s_mov_b64 exec, -1
    v_exp_f32 v196, v196
    v_exp_f32 v197, v197
    v_exp_f32 v198, v198
    v_exp_f32 v199, v199
    v_mfma_f32_32x32x16_bf16 v[210:225], v[20:23], v[242:245], v[210:225]
    s_add_u32 s31, s30, 0
    s_add_u32 m0, s32, 0
    s_nop 0
    buffer_load_dwordx4 v116, s[48:51], s31 offen lds
    s_nop 0
    v_exp_f32 v200, v200
    v_exp_f32 v201, v201
    v_exp_f32 v202, v202
    v_exp_f32 v203, v203
    v_smfmac_f32_32x32x32_bf16 v[162:177], v[96:99], v[194:201], v132
    ds_read2st64_b64 v[28:31], v135 offset0:44 offset1:64
    s_add_u32 m0, s32, 1024
    s_nop 0
    buffer_load_dwordx4 v117, s[48:51], s31 offen lds
    s_nop 0
    v_exp_f32 v204, v204
    v_exp_f32 v205, v205
    v_exp_f32 v206, v206
    v_exp_f32 v207, v207
    v_mfma_f32_32x32x16_bf16 v[226:241], v[20:23], v[246:249], v[226:241]
    v_exp_f32 v208, v208
    v_exp_f32 v209, v209
    v_exp_f32 v210, v210
    v_exp_f32 v211, v211
    v_smfmac_f32_32x32x32_bf16 v[162:177], v[100:103], v[202:209], v132
    s_waitcnt lgkmcnt(0)
    s_nop 0
    ds_read2st64_b64 v[20:23], v134 offset0:40 offset1:42
    v_exp_f32 v212, v212
    v_exp_f32 v213, v213
    v_exp_f32 v214, v214
    v_exp_f32 v215, v215
    v_mfma_f32_32x32x4_2b_bf16 v[178:209], v[28:29], v[250:251], 0 cbsz:1 abid:0
    v_exp_f32 v216, v216
    v_exp_f32 v217, v217
    v_exp_f32 v218, v218
    v_exp_f32 v219, v219
    v_exp_f32 v220, v220
    v_exp_f32 v221, v221
    v_exp_f32 v222, v222
    v_exp_f32 v223, v223
    v_smfmac_f32_32x32x32_bf16 v[146:161], v[104:107], v[210:217], v132
    s_mov_b64 exec, s[24:25]
    ds_read_b128 v[96:99], v136 offset:20480
    s_mov_b64 exec, -1
    v_exp_f32 v224, v224
    v_exp_f32 v225, v225
    v_exp_f32 v226, v226
    v_exp_f32 v227, v227
    v_smfmac_f32_32x32x32_bf16 v[146:161], v[108:111], v[218:225], v132
    s_mov_b64 exec, s[24:25]
    ds_read_b128 v[100:103], v136 offset:21120
    s_mov_b64 exec, -1
    v_exp_f32 v228, v228
    v_exp_f32 v229, v229
    v_exp_f32 v230, v230
    v_exp_f32 v231, v231
    v_mfma_f32_32x32x16_bf16 v[178:193], v[16:19], v[242:245], v[178:193]
    s_add_u32 m0, s32, 2048
    s_nop 0
    buffer_load_dwordx4 v118, s[48:51], s31 offen lds
    s_nop 0
    v_exp_f32 v232, v232
    v_exp_f32 v233, v233
    v_exp_f32 v234, v234
    v_exp_f32 v235, v235
    v_smfmac_f32_32x32x32_bf16 v[162:177], v[104:107], v[226:233], v132
    s_add_u32 m0, s32, 3072
    s_nop 0
    buffer_load_dwordx4 v119, s[48:51], s31 offen lds
    s_nop 0
    v_exp_f32 v236, v236
    v_exp_f32 v237, v237
    v_exp_f32 v238, v238
    v_exp_f32 v239, v239
    v_mfma_f32_32x32x16_bf16 v[194:209], v[16:19], v[246:249], v[194:209]
    v_exp_f32 v240, v240
    v_exp_f32 v241, v241
    v_exp_f32 v178, v178
    v_exp_f32 v179, v179
    v_smfmac_f32_32x32x32_bf16 v[162:177], v[108:111], v[234:241], v132
    s_waitcnt lgkmcnt(0)
    s_nop 0
    ds_read2st64_b64 v[16:19], v133 offset0:60 offset1:62
    v_exp_f32 v180, v180
    v_exp_f32 v181, v181
    v_exp_f32 v182, v182
    v_exp_f32 v183, v183
    v_mfma_f32_32x32x4_2b_bf16 v[210:241], v[28:29], v[250:251], 0 cbsz:1 abid:1
    v_exp_f32 v184, v184
    v_exp_f32 v185, v185
    v_exp_f32 v186, v186
    v_exp_f32 v187, v187
    v_exp_f32 v188, v188
    v_exp_f32 v189, v189
    v_exp_f32 v190, v190
    v_exp_f32 v191, v191
    v_smfmac_f32_32x32x32_bf16 v[146:161], v[96:99], v[178:185], v132
    s_mov_b64 exec, s[24:25]
    ds_read_b128 v[104:107], v136 offset:21760
    s_mov_b64 exec, -1
    v_exp_f32 v192, v192
    v_exp_f32 v193, v193
    v_exp_f32 v194, v194
    v_exp_f32 v195, v195
    v_smfmac_f32_32x32x32_bf16 v[146:161], v[100:103], v[186:193], v132
    s_mov_b64 exec, s[24:25]
    ds_read_b128 v[108:111], v136 offset:22400
    s_mov_b64 exec, -1
    v_exp_f32 v196, v196
    v_exp_f32 v197, v197
    v_exp_f32 v198, v198
    v_exp_f32 v199, v199
    v_mfma_f32_32x32x16_bf16 v[210:225], v[20:23], v[242:245], v[210:225]
    s_add_u32 m0, s32, 4096
    s_nop 0
    buffer_load_dwordx4 v120, s[48:51], s31 offen lds
    s_nop 0
    v_exp_f32 v200, v200
    v_exp_f32 v201, v201
    v_exp_f32 v202, v202
    v_exp_f32 v203, v203
    v_smfmac_f32_32x32x32_bf16 v[162:177], v[96:99], v[194:201], v132
    s_add_u32 s31, s30, 327680
    s_add_u32 m0, s32, 40960
    s_nop 0
    buffer_load_dwordx4 v116, s[48:51], s31 offen lds
    s_nop 0
    v_exp_f32 v204, v204
    v_exp_f32 v205, v205
    v_exp_f32 v206, v206
    v_exp_f32 v207, v207
    v_mfma_f32_32x32x16_bf16 v[226:241], v[20:23], v[246:249], v[226:241]
    v_exp_f32 v208, v208
    v_exp_f32 v209, v209
    v_exp_f32 v210, v210
    v_exp_f32 v211, v211
    v_smfmac_f32_32x32x32_bf16 v[162:177], v[100:103], v[202:209], v132
    s_waitcnt lgkmcnt(0)
    s_nop 0
    ds_read2st64_b64 v[20:23], v134 offset0:60 offset1:62
    v_exp_f32 v212, v212
    v_exp_f32 v213, v213
    v_exp_f32 v214, v214
    v_exp_f32 v215, v215
    v_mfma_f32_32x32x4_2b_bf16 v[178:209], v[30:31], v[250:251], 0 cbsz:1 abid:0
    v_exp_f32 v216, v216
    v_exp_f32 v217, v217
    v_exp_f32 v218, v218
    v_exp_f32 v219, v219
    v_exp_f32 v220, v220
    v_exp_f32 v221, v221
    v_exp_f32 v222, v222
    v_exp_f32 v223, v223
    v_smfmac_f32_32x32x32_bf16 v[146:161], v[104:107], v[210:217], v132
    s_mov_b64 exec, s[24:25]
    ds_read_b128 v[96:99], v136 offset:30720
    s_mov_b64 exec, -1
    v_exp_f32 v224, v224
    v_exp_f32 v225, v225
    v_exp_f32 v226, v226
    v_exp_f32 v227, v227
    v_smfmac_f32_32x32x32_bf16 v[146:161], v[108:111], v[218:225], v132
    s_mov_b64 exec, s[24:25]
    ds_read_b128 v[100:103], v136 offset:31360
    s_mov_b64 exec, -1
    v_exp_f32 v228, v228
    v_exp_f32 v229, v229
    v_exp_f32 v230, v230
    v_exp_f32 v231, v231
    v_mfma_f32_32x32x16_bf16 v[178:193], v[16:19], v[242:245], v[178:193]
    s_add_u32 m0, s32, 41984
    s_nop 0
    buffer_load_dwordx4 v117, s[48:51], s31 offen lds
    s_nop 0
    v_exp_f32 v232, v232
    v_exp_f32 v233, v233
    v_exp_f32 v234, v234
    v_exp_f32 v235, v235
    v_smfmac_f32_32x32x32_bf16 v[162:177], v[104:107], v[226:233], v132
    s_add_u32 m0, s32, 43008
    s_nop 0
    buffer_load_dwordx4 v118, s[48:51], s31 offen lds
    s_nop 0
    v_exp_f32 v236, v236
    v_exp_f32 v237, v237
    v_exp_f32 v238, v238
    v_exp_f32 v239, v239
    v_mfma_f32_32x32x16_bf16 v[194:209], v[16:19], v[246:249], v[194:209]
    v_exp_f32 v240, v240
    v_exp_f32 v241, v241
    v_exp_f32 v178, v178
    v_exp_f32 v179, v179
    v_smfmac_f32_32x32x32_bf16 v[162:177], v[108:111], v[234:241], v132
    s_waitcnt lgkmcnt(0)
    s_nop 0
    ds_read2st64_b64 v[16:19], v133 offset0:80 offset1:82
    v_exp_f32 v180, v180
    v_exp_f32 v181, v181
    v_exp_f32 v182, v182
    v_exp_f32 v183, v183
    v_mfma_f32_32x32x4_2b_bf16 v[210:241], v[30:31], v[250:251], 0 cbsz:1 abid:1
    v_exp_f32 v184, v184
    v_exp_f32 v185, v185
    v_exp_f32 v186, v186
    v_exp_f32 v187, v187
    v_exp_f32 v188, v188
    v_exp_f32 v189, v189
    v_exp_f32 v190, v190
    v_exp_f32 v191, v191
    v_smfmac_f32_32x32x32_bf16 v[146:161], v[96:99], v[178:185], v132
    s_mov_b64 exec, s[24:25]
    ds_read_b128 v[104:107], v136 offset:32000
    s_mov_b64 exec, -1
    v_exp_f32 v192, v192
    v_exp_f32 v193, v193
    v_exp_f32 v194, v194
    v_exp_f32 v195, v195
    v_smfmac_f32_32x32x32_bf16 v[146:161], v[100:103], v[186:193], v132
    s_mov_b64 exec, s[24:25]
    ds_read_b128 v[108:111], v136 offset:32640
    s_mov_b64 exec, -1
    v_exp_f32 v196, v196
    v_exp_f32 v197, v197
    v_exp_f32 v198, v198
    v_exp_f32 v199, v199
    v_mfma_f32_32x32x16_bf16 v[210:225], v[20:23], v[242:245], v[210:225]
    s_add_u32 m0, s32, 44032
    s_nop 0
    buffer_load_dwordx4 v119, s[48:51], s31 offen lds
    s_nop 0
    v_exp_f32 v200, v200
    v_exp_f32 v201, v201
    v_exp_f32 v202, v202
    v_exp_f32 v203, v203
    v_smfmac_f32_32x32x32_bf16 v[162:177], v[96:99], v[194:201], v132
    ds_read2st64_b64 v[24:27], v135 offset0:84 offset1:104
    s_add_u32 m0, s32, 45056
    s_nop 0
    buffer_load_dwordx4 v120, s[48:51], s31 offen lds
    s_nop 0
    v_exp_f32 v204, v204
    v_exp_f32 v205, v205
    v_exp_f32 v206, v206
    v_exp_f32 v207, v207
    v_mfma_f32_32x32x16_bf16 v[226:241], v[20:23], v[246:249], v[226:241]
    v_exp_f32 v208, v208
    v_exp_f32 v209, v209
    v_exp_f32 v210, v210
    v_exp_f32 v211, v211
    v_smfmac_f32_32x32x32_bf16 v[162:177], v[100:103], v[202:209], v132
    s_waitcnt lgkmcnt(0)
    s_nop 0
    ds_read2st64_b64 v[20:23], v134 offset0:80 offset1:82
    v_exp_f32 v212, v212
    v_exp_f32 v213, v213
    v_exp_f32 v214, v214
    v_exp_f32 v215, v215
    v_mfma_f32_32x32x4_2b_bf16 v[178:209], v[24:25], v[250:251], 0 cbsz:1 abid:0
    v_exp_f32 v216, v216
    v_exp_f32 v217, v217
    v_exp_f32 v218, v218
    v_exp_f32 v219, v219
    v_exp_f32 v220, v220
    v_exp_f32 v221, v221
    v_exp_f32 v222, v222
    v_exp_f32 v223, v223
    v_smfmac_f32_32x32x32_bf16 v[146:161], v[104:107], v[210:217], v132
    s_mov_b64 exec, s[24:25]
    ds_read_b128 v[96:99], v137 offset:0
    s_mov_b64 exec, -1
    v_exp_f32 v224, v224
    v_exp_f32 v225, v225
    v_exp_f32 v226, v226
    v_exp_f32 v227, v227
    v_smfmac_f32_32x32x32_bf16 v[146:161], v[108:111], v[218:225], v132
    s_mov_b64 exec, s[24:25]
    ds_read_b128 v[100:103], v137 offset:640
    s_mov_b64 exec, -1
    v_exp_f32 v228, v228
    v_exp_f32 v229, v229
    v_exp_f32 v230, v230
    v_exp_f32 v231, v231
    v_mfma_f32_32x32x16_bf16 v[178:193], v[16:19], v[242:245], v[178:193]
    s_cmp_eq_u32 s16, 4
    s_cbranch_scc0 L_r_set
    s_mov_b64 exec, 1
    buffer_store_dword v130, v131, s[44:47], s38 offen sc1
    s_mov_b64 exec, -1
L_r_set:
    v_exp_f32 v232, v232
    v_exp_f32 v233, v233
    v_exp_f32 v234, v234
    v_exp_f32 v235, v235
    v_smfmac_f32_32x32x32_bf16 v[162:177], v[104:107], v[226:233], v132
    v_exp_f32 v236, v236
    v_exp_f32 v237, v237
    v_exp_f32 v238, v238
    v_exp_f32 v239, v239
    v_mfma_f32_32x32x16_bf16 v[194:209], v[16:19], v[246:249], v[194:209]
    v_exp_f32 v240, v240
    v_exp_f32 v241, v241
    v_exp_f32 v178, v178
    v_exp_f32 v179, v179
    v_smfmac_f32_32x32x32_bf16 v[162:177], v[108:111], v[234:241], v132
    s_waitcnt lgkmcnt(0)
    s_setprio 1
    ds_read2st64_b64 v[16:19], v133 offset0:100 offset1:102
    v_exp_f32 v180, v180
    v_exp_f32 v181, v181
    v_exp_f32 v182, v182
    v_exp_f32 v183, v183
    v_mfma_f32_32x32x4_2b_bf16 v[210:241], v[24:25], v[250:251], 0 cbsz:1 abid:1
    v_exp_f32 v184, v184
    v_exp_f32 v185, v185
    v_exp_f32 v186, v186
    v_exp_f32 v187, v187
    v_exp_f32 v188, v188
    v_exp_f32 v189, v189
    v_exp_f32 v190, v190
    v_exp_f32 v191, v191
    v_smfmac_f32_32x32x32_bf16 v[146:161], v[96:99], v[178:185], v132
    s_mov_b64 exec, s[24:25]
    ds_read_b128 v[104:107], v137 offset:1280
    s_mov_b64 exec, -1
    v_exp_f32 v192, v192
    v_exp_f32 v193, v193
    v_exp_f32 v194, v194
    v_exp_f32 v195, v195
    v_smfmac_f32_32x32x32_bf16 v[146:161], v[100:103], v[186:193], v132
    s_mov_b64 exec, s[24:25]
    ds_read_b128 v[108:111], v137 offset:1920
    s_mov_b64 exec, -1
    v_exp_f32 v196, v196
    v_exp_f32 v197, v197
    v_exp_f32 v198, v198
    v_exp_f32 v199, v199
    v_mfma_f32_32x32x16_bf16 v[210:225], v[20:23], v[242:245], v[210:225]
    v_exp_f32 v200, v200
    v_exp_f32 v201, v201
    v_exp_f32 v202, v202
    v_exp_f32 v203, v203
    v_smfmac_f32_32x32x32_bf16 v[162:177], v[96:99], v[194:201], v132
    v_exp_f32 v204, v204
    v_exp_f32 v205, v205
    v_exp_f32 v206, v206
    v_exp_f32 v207, v207
    v_mfma_f32_32x32x16_bf16 v[226:241], v[20:23], v[246:249], v[226:241]
    v_exp_f32 v208, v208
    v_exp_f32 v209, v209
    v_exp_f32 v210, v210
    v_exp_f32 v211, v211
    v_smfmac_f32_32x32x32_bf16 v[162:177], v[100:103], v[202:209], v132
    s_waitcnt lgkmcnt(0)
    s_nop 0
    ds_read2st64_b64 v[20:23], v134 offset0:100 offset1:102
    v_exp_f32 v212, v212
    v_exp_f32 v213, v213
    v_exp_f32 v214, v214
    v_exp_f32 v215, v215
    v_mfma_f32_32x32x4_2b_bf16 v[178:209], v[26:27], v[250:251], 0 cbsz:1 abid:0
    v_exp_f32 v216, v216
    v_exp_f32 v217, v217
    v_exp_f32 v218, v218
    v_exp_f32 v219, v219
    v_exp_f32 v220, v220
    v_exp_f32 v221, v221
    v_exp_f32 v222, v222
    v_exp_f32 v223, v223
    v_smfmac_f32_32x32x32_bf16 v[146:161], v[104:107], v[210:217], v132
    s_mov_b64 exec, s[24:25]
    ds_read_b128 v[96:99], v137 offset:10240
    s_mov_b64 exec, -1
    v_exp_f32 v224, v224
    v_exp_f32 v225, v225
    v_exp_f32 v226, v226
    v_exp_f32 v227, v227
    v_smfmac_f32_32x32x32_bf16 v[146:161], v[108:111], v[218:225], v132
    s_mov_b64 exec, s[24:25]
    ds_read_b128 v[100:103], v137 offset:10880
    s_mov_b64 exec, -1
    v_exp_f32 v228, v228
    v_exp_f32 v229, v229
    v_exp_f32 v230, v230
    v_exp_f32 v231, v231
    v_mfma_f32_32x32x16_bf16 v[178:193], v[16:19], v[242:245], v[178:193]
    v_exp_f32 v232, v232
    v_exp_f32 v233, v233
    v_exp_f32 v234, v234
    v_exp_f32 v235, v235
    v_smfmac_f32_32x32x32_bf16 v[162:177], v[104:107], v[226:233], v132
    v_exp_f32 v236, v236
    v_exp_f32 v237, v237
    v_exp_f32 v238, v238
    v_exp_f32 v239, v239
    v_mfma_f32_32x32x16_bf16 v[194:209], v[16:19], v[246:249], v[194:209]
    v_exp_f32 v240, v240
    v_exp_f32 v241, v241
    v_exp_f32 v178, v178
    v_exp_f32 v179, v179
    v_smfmac_f32_32x32x32_bf16 v[162:177], v[108:111], v[234:241], v132
    s_waitcnt lgkmcnt(0)
    s_barrier
    s_setprio 3
    s_nop 0
    ds_read2st64_b64 v[16:19], v133 offset0:120 offset1:122
    v_exp_f32 v180, v180
    v_exp_f32 v181, v181
    v_exp_f32 v182, v182
    v_exp_f32 v183, v183
    v_mfma_f32_32x32x4_2b_bf16 v[210:241], v[26:27], v[250:251], 0 cbsz:1 abid:1
    v_exp_f32 v184, v184
    v_exp_f32 v185, v185
    v_exp_f32 v186, v186
    v_exp_f32 v187, v187
    v_exp_f32 v188, v188
    v_exp_f32 v189, v189
    v_exp_f32 v190, v190
    v_exp_f32 v191, v191
    v_smfmac_f32_32x32x32_bf16 v[146:161], v[96:99], v[178:185], v132
    s_mov_b64 exec, s[24:25]
    ds_read_b128 v[104:107], v137 offset:11520
    s_mov_b64 exec, -1
    v_exp_f32 v192, v192
    v_exp_f32 v193, v193
    v_exp_f32 v194, v194
    v_exp_f32 v195, v195
    v_smfmac_f32_32x32x32_bf16 v[146:161], v[100:103], v[186:193], v132
    s_mov_b64 exec, s[24:25]
    ds_read_b128 v[108:111], v137 offset:12160
    s_mov_b64 exec, -1
    v_exp_f32 v196, v196
    v_exp_f32 v197, v197
    v_exp_f32 v198, v198
    v_exp_f32 v199, v199
    v_mfma_f32_32x32x16_bf16 v[210:225], v[20:23], v[242:245], v[210:225]
    v_exp_f32 v200, v200
    v_exp_f32 v201, v201
    v_exp_f32 v202, v202
    v_exp_f32 v203, v203
    v_smfmac_f32_32x32x32_bf16 v[162:177], v[96:99], v[194:201], v132
    ds_read2st64_b64 v[28:31], v135 offset0:124 offset1:144
    v_exp_f32 v204, v204
    v_exp_f32 v205, v205
    v_exp_f32 v206, v206
    v_exp_f32 v207, v207
    v_mfma_f32_32x32x16_bf16 v[226:241], v[20:23], v[246:249], v[226:241]
    v_exp_f32 v208, v208
    v_exp_f32 v209, v209
    v_exp_f32 v210, v210
    v_exp_f32 v211, v211
    v_smfmac_f32_32x32x32_bf16 v[162:177], v[100:103], v[202:209], v132
    s_waitcnt lgkmcnt(0)
    s_nop 0
    ds_read2st64_b64 v[20:23], v134 offset0:120 offset1:122
    v_exp_f32 v212, v212
    v_exp_f32 v213, v213
    v_exp_f32 v214, v214
    v_exp_f32 v215, v215
    v_mfma_f32_32x32x4_2b_bf16 v[178:209], v[28:29], v[250:251], 0 cbsz:1 abid:0
    v_exp_f32 v216, v216
    v_exp_f32 v217, v217
    v_exp_f32 v218, v218
    v_exp_f32 v219, v219
    v_exp_f32 v220, v220
    v_exp_f32 v221, v221
    v_exp_f32 v222, v222
    v_exp_f32 v223, v223
    v_smfmac_f32_32x32x32_bf16 v[146:161], v[104:107], v[210:217], v132
    s_mov_b64 exec, s[24:25]
    ds_read_b128 v[96:99], v137 offset:20480
    s_mov_b64 exec, -1
    v_exp_f32 v224, v224
    v_exp_f32 v225, v225
    v_exp_f32 v226, v226
    v_exp_f32 v227, v227
    v_smfmac_f32_32x32x32_bf16 v[146:161], v[108:111], v[218:225], v132
    s_mov_b64 exec, s[24:25]
    ds_read_b128 v[100:103], v137 offset:21120
    s_mov_b64 exec, -1
    v_exp_f32 v228, v228
    v_exp_f32 v229, v229
    v_exp_f32 v230, v230
    v_exp_f32 v231, v231
    v_mfma_f32_32x32x16_bf16 v[178:193], v[16:19], v[242:245], v[178:193]
    v_mov_b32 v11, 133104
    ds_write_b32 v11, v131
    v_exp_f32 v232, v232
    v_exp_f32 v233, v233
    v_exp_f32 v234, v234
    v_exp_f32 v235, v235
    v_smfmac_f32_32x32x32_bf16 v[162:177], v[104:107], v[226:233], v132
    v_exp_f32 v236, v236
    v_exp_f32 v237, v237
    v_exp_f32 v238, v238
    v_exp_f32 v239, v239
    v_mfma_f32_32x32x16_bf16 v[194:209], v[16:19], v[246:249], v[194:209]
    v_exp_f32 v240, v240
    v_exp_f32 v241, v241
    v_exp_f32 v178, v178
    v_exp_f32 v179, v179
    v_smfmac_f32_32x32x32_bf16 v[162:177], v[108:111], v[234:241], v132
    s_waitcnt lgkmcnt(0)
    s_nop 0
    ds_read2st64_b64 v[16:19], v133 offset0:140 offset1:142
    v_exp_f32 v180, v180
    v_exp_f32 v181, v181
    v_exp_f32 v182, v182
    v_exp_f32 v183, v183
    v_mfma_f32_32x32x4_2b_bf16 v[210:241], v[28:29], v[250:251], 0 cbsz:1 abid:1
    v_exp_f32 v184, v184
    v_exp_f32 v185, v185
    v_exp_f32 v186, v186
    v_exp_f32 v187, v187
    v_exp_f32 v188, v188
    v_exp_f32 v189, v189
    v_exp_f32 v190, v190
    v_exp_f32 v191, v191
    v_smfmac_f32_32x32x32_bf16 v[146:161], v[96:99], v[178:185], v132
    s_mov_b64 exec, s[24:25]
    ds_read_b128 v[104:107], v137 offset:21760
    s_mov_b64 exec, -1
    v_exp_f32 v192, v192
    v_exp_f32 v193, v193
    v_exp_f32 v194, v194
    v_exp_f32 v195, v195
    v_smfmac_f32_32x32x32_bf16 v[146:161], v[100:103], v[186:193], v132
    s_mov_b64 exec, s[24:25]
    ds_read_b128 v[108:111], v137 offset:22400
    s_mov_b64 exec, -1
    v_exp_f32 v196, v196
    v_exp_f32 v197, v197
    v_exp_f32 v198, v198
    v_exp_f32 v199, v199
    v_mfma_f32_32x32x16_bf16 v[210:225], v[20:23], v[242:245], v[210:225]
    s_cmp_eq_u32 s16, 4
    s_cbranch_scc0 L_r_get
    buffer_load_dword v5, v145, s[44:47], s40 offen sc1
L_r_get:
    v_exp_f32 v200, v200
    v_exp_f32 v201, v201
    v_exp_f32 v202, v202
    v_exp_f32 v203, v203
    v_smfmac_f32_32x32x32_bf16 v[162:177], v[96:99], v[194:201], v132
    v_exp_f32 v204, v204
    v_exp_f32 v205, v205
    v_exp_f32 v206, v206
    v_exp_f32 v207, v207
    v_mfma_f32_32x32x16_bf16 v[226:241], v[20:23], v[246:249], v[226:241]
    v_exp_f32 v208, v208
    v_exp_f32 v209, v209
    v_exp_f32 v210, v210
    v_exp_f32 v211, v211
    v_smfmac_f32_32x32x32_bf16 v[162:177], v[100:103], v[202:209], v132
    s_waitcnt lgkmcnt(0)
    s_setprio 2
    ds_read2st64_b64 v[20:23], v134 offset0:140 offset1:142
    v_exp_f32 v212, v212
    v_exp_f32 v213, v213
    v_exp_f32 v214, v214
    v_exp_f32 v215, v215
    v_mfma_f32_32x32x4_2b_bf16 v[178:209], v[30:31], v[250:251], 0 cbsz:1 abid:0
    v_exp_f32 v216, v216
    v_exp_f32 v217, v217
    v_exp_f32 v218, v218
    v_exp_f32 v219, v219
    v_exp_f32 v220, v220
    v_exp_f32 v221, v221
    v_exp_f32 v222, v222
    v_exp_f32 v223, v223
    v_smfmac_f32_32x32x32_bf16 v[146:161], v[104:107], v[210:217], v132
    s_mov_b64 exec, s[24:25]
    ds_read_b128 v[96:99], v137 offset:30720
    s_mov_b64 exec, -1
    v_exp_f32 v224, v224
    v_exp_f32 v225, v225
    v_exp_f32 v226, v226
    v_exp_f32 v227, v227
    v_smfmac_f32_32x32x32_bf16 v[146:161], v[108:111], v[218:225], v132
    s_mov_b64 exec, s[24:25]
    ds_read_b128 v[100:103], v137 offset:31360
    s_mov_b64 exec, -1
    v_exp_f32 v228, v228
    v_exp_f32 v229, v229
    v_exp_f32 v230, v230
    v_exp_f32 v231, v231
    v_mfma_f32_32x32x16_bf16 v[178:193], v[16:19], v[242:245], v[178:193]
    v_exp_f32 v232, v232
    v_exp_f32 v233, v233
    v_exp_f32 v234, v234
    v_exp_f32 v235, v235
    v_smfmac_f32_32x32x32_bf16 v[162:177], v[104:107], v[226:233], v132
    v_exp_f32 v236, v236
    v_exp_f32 v237, v237
    v_exp_f32 v238, v238
    v_exp_f32 v239, v239
    v_mfma_f32_32x32x16_bf16 v[194:209], v[16:19], v[246:249], v[194:209]
    v_exp_f32 v240, v240
    v_exp_f32 v241, v241
    v_exp_f32 v178, v178
    v_exp_f32 v179, v179
    v_smfmac_f32_32x32x32_bf16 v[162:177], v[108:111], v[234:241], v132
    s_waitcnt lgkmcnt(0)
    s_nop 0
    v_exp_f32 v180, v180
    v_exp_f32 v181, v181
    v_exp_f32 v182, v182
    v_exp_f32 v183, v183
    v_mfma_f32_32x32x4_2b_bf16 v[210:241], v[30:31], v[250:251], 0 cbsz:1 abid:1
    v_exp_f32 v184, v184
    v_exp_f32 v185, v185
    v_exp_f32 v186, v186
    v_exp_f32 v187, v187
    v_exp_f32 v188, v188
    v_exp_f32 v189, v189
    v_exp_f32 v190, v190
    v_exp_f32 v191, v191
    v_smfmac_f32_32x32x32_bf16 v[146:161], v[96:99], v[178:185], v132
    s_mov_b64 exec, s[24:25]
    ds_read_b128 v[104:107], v137 offset:32000
    s_mov_b64 exec, -1
    v_exp_f32 v192, v192
    v_exp_f32 v193, v193
    v_exp_f32 v194, v194
    v_exp_f32 v195, v195
    v_smfmac_f32_32x32x32_bf16 v[146:161], v[100:103], v[186:193], v132
    s_mov_b64 exec, s[24:25]
    ds_read_b128 v[108:111], v137 offset:32640
    s_mov_b64 exec, -1
    v_exp_f32 v196, v196
    v_exp_f32 v197, v197
    v_exp_f32 v198, v198
    v_exp_f32 v199, v199
    v_mfma_f32_32x32x16_bf16 v[210:225], v[20:23], v[242:245], v[210:225]
    v_exp_f32 v200, v200
    v_exp_f32 v201, v201
    v_exp_f32 v202, v202
    v_exp_f32 v203, v203
    v_smfmac_f32_32x32x32_bf16 v[162:177], v[96:99], v[194:201], v132
    v_exp_f32 v204, v204
    v_exp_f32 v205, v205
    v_exp_f32 v206, v206
    v_exp_f32 v207, v207
    v_mfma_f32_32x32x16_bf16 v[226:241], v[20:23], v[246:249], v[226:241]
    v_exp_f32 v208, v208
    v_exp_f32 v209, v209
    v_exp_f32 v210, v210
    v_exp_f32 v211, v211
    v_smfmac_f32_32x32x32_bf16 v[162:177], v[100:103], v[202:209], v132
    s_waitcnt lgkmcnt(0)
    s_setprio 1
    v_exp_f32 v212, v212
    v_exp_f32 v213, v213
    v_exp_f32 v214, v214
    v_exp_f32 v215, v215
    v_exp_f32 v216, v216
    v_exp_f32 v217, v217
    v_exp_f32 v218, v218
    v_exp_f32 v219, v219
    v_exp_f32 v220, v220
    v_exp_f32 v221, v221
    v_exp_f32 v222, v222
    v_exp_f32 v223, v223
    v_smfmac_f32_32x32x32_bf16 v[146:161], v[104:107], v[210:217], v132
    v_exp_f32 v224, v224
    v_exp_f32 v225, v225
    v_exp_f32 v226, v226
    v_exp_f32 v227, v227
    v_smfmac_f32_32x32x32_bf16 v[146:161], v[108:111], v[218:225], v132
    v_exp_f32 v228, v228
    v_exp_f32 v229, v229
    v_exp_f32 v230, v230
    v_exp_f32 v231, v231
    v_exp_f32 v232, v232
    v_exp_f32 v233, v233
    v_exp_f32 v234, v234
    v_exp_f32 v235, v235
    v_smfmac_f32_32x32x32_bf16 v[162:177], v[104:107], v[226:233], v132
    v_exp_f32 v236, v236
    v_exp_f32 v237, v237
    v_exp_f32 v238, v238
    v_exp_f32 v239, v239
    ds_write_b128 v128, v[154:157] offset:2048
    ds_write_b128 v128, v[146:149] offset:0
    ds_write_b128 v128, v[150:153] offset:1024
    v_exp_f32 v240, v240
    v_exp_f32 v241, v241
    s_cmp_eq_u32 s16, 4
    s_cbranch_scc0 L_epi
    s_waitcnt vmcnt(0)
    v_cmp_ne_u32 vcc, 0, v5
    s_nop 0
    s_cmp_eq_u64 vcc, -1
    s_cbranch_scc0 L_r_wait
L_epi:
    s_setprio 0
    s_nop 0
    v_smfmac_f32_32x32x32_bf16 v[162:177], v[108:111], v[234:241], v132
    s_waitcnt vmcnt(0) lgkmcnt(0)
    s_barrier
    ds_read_b128 v[154:157], v129 offset:2048
    ds_read_b128 v[146:149], v129
    ds_read_b128 v[150:153], v129 offset:1024
    s_nop 6
    s_waitcnt lgkmcnt(2)
    v_pk_add_f32 v[170:171], v[170:171], v[154:155]
    v_pk_add_f32 v[172:173], v[172:173], v[156:157]
    v_mov_b32 v7, v170
    v_mov_b32 v9, v170
    s_mov_b32 s30, 0x21800000
    s_waitcnt lgkmcnt(1)
    v_permlane32_swap_b32 v7, v9
    v_pk_add_f32 v[162:163], v[162:163], v[146:147]
    v_pk_add_f32 v[164:165], v[164:165], v[148:149]
    s_mov_b32 s31, 0x5d800000
    s_waitcnt lgkmcnt(0)
    v_pk_add_f32 v[166:167], v[166:167], v[150:151]
    v_pk_add_f32 v[168:169], v[168:169], v[152:153]
    v_cmp_le_f32 s[32:33], s30, v9
    v_cmp_ge_f32 s[34:35], s31, v9
    v_pk_mul_f32 v[10:11], v[170:171], 0
    v_pk_fma_f32 v[10:11], v[172:173], 0, v[10:11]
    v_pk_fma_f32 v[10:11], v[162:163], 0, v[10:11]
    v_pk_fma_f32 v[10:11], v[164:165], 0, v[10:11]
    v_pk_fma_f32 v[10:11], v[166:167], 0, v[10:11]
    v_pk_fma_f32 v[10:11], v[168:169], 0, v[10:11]
    s_and_b64 s[32:33], s[32:33], s[34:35]
    v_cmp_o_f32 vcc, v10, v11
    v_rcp_f32 v8, v9
    s_and_b64 s[32:33], s[32:33], vcc
    s_cmp_eq_u64 s[32:33], -1
    s_cbranch_scc0 L_attn_slow
L_attn_fin:
    v_pk_mul_f32 v[162:163], v[162:163], v[8:9] op_sel_hi:[1,0]
    v_pk_mul_f32 v[164:165], v[164:165], v[8:9] op_sel_hi:[1,0]
    v_pk_mul_f32 v[166:167], v[166:167], v[8:9] op_sel_hi:[1,0]
    v_pk_mul_f32 v[168:169], v[168:169], v[8:9] op_sel_hi:[1,0]
    v_cvt_pk_bf16_f32 v70, v162, v163
    v_cvt_pk_bf16_f32 v71, v164, v165
    v_cvt_pk_bf16_f32 v72, v166, v167
    v_cvt_pk_bf16_f32 v73, v168, v169
    buffer_store_dwordx4 v[70:73], v126, s[44:47], s36 offen sc1
    v_pk_mul_f32 v[170:171], v[170:171], v[8:9] op_sel_hi:[1,0]
    v_pk_mul_f32 v[172:173], v[172:173], v[8:9] op_sel_hi:[1,0]
    v_cvt_pk_bf16_f32 v74, v170, v171
    v_cvt_pk_bf16_f32 v75, v172, v173
    s_mov_b32 exec_hi, 0
    buffer_store_dwordx2 v[74:75], v127, s[44:47], s37 offen sc1
    s_mov_b32 exec_hi, -1
    v_mov_b32 v2, v145
    s_getreg_b32 s30, hwreg(HW_REG_XCC_ID, 0, 1)
    s_xor_b32 s30, s30, s2
    s_and_b32 s30, s30, 1
    s_mul_i32 s31, s30, 25600
    s_sub_u32 s32, 25600, s31
    v_add_u32 v6, s31, v138
    v_add_u32 v7, s31, v139
    v_add_u32 v3, s32, v138
    v_add_u32 v5, s32, v139
    v_mov_b32 v8, v140
    v_mov_b32 v9, v141
    v_mov_b32 v10, v142
    v_mov_b32 v11, v143
    v_mov_b32 v12, v144
    v_mov_b32 v13, v116
    v_mov_b32 v14, v117
    v_mov_b32 v15, v118
    v_mov_b32 v0, v121
    v_lshlrev_b32 v4, 3, v1
    s_lshr_b32 s26, s16, 2
    s_lshr_b32 s27, s2, 5
    s_mul_i32 s27, s27, 160
    s_add_u32 s27, s27, s41
    s_add_u32 s28, s41, 7864320
    s_lshl_b32 s3, s26, 1
    s_add_u32 s3, s3, s30
    s_xor_b32 s29, s3, 1
    s_lshl_b32 s22, s3, 12
    s_add_u32 s22, s22, s28
    s_lshl_b32 s24, s29, 12
    s_add_u32 s24, s24, s28
    s_add_u32 s28, s28, 16384
    s_lshl_b32 s23, s3, 10
    s_add_u32 s23, s23, s28
    s_lshl_b32 s25, s29, 10
    s_add_u32 s25, s25, s28
    s_xor_b32 s3, s30, s2
    s_mov_b32 s28, 0
    s_bitcmp0_b32 s3, 0
    s_barrier
    s_cbranch_scc1 L_p3_two
    ds_read_b64_tr_b16 v[76:77], v6 offset:0
    ds_read_b64_tr_b16 v[78:79], v6 offset:1280
    ds_read_b64_tr_b16 v[80:81], v6 offset:32
    ds_read_b64_tr_b16 v[82:83], v6 offset:1312
    ds_read_b64_tr_b16 v[84:85], v6 offset:64
    ds_read_b64_tr_b16 v[86:87], v6 offset:1344
    ds_read_b64_tr_b16 v[88:89], v6 offset:96
    ds_read_b64_tr_b16 v[90:91], v6 offset:1376
    ds_read_b64_tr_b16 v[92:93], v6 offset:128
    ds_read_b64_tr_b16 v[94:95], v6 offset:1408
    buffer_load_dwordx4 v[16:19], v0, s[44:47], s22 offen offset:0 sc1
    ds_read_b64_tr_b16 v[96:97], v6 offset:6400
    ds_read_b64_tr_b16 v[98:99], v6 offset:7680
    ds_read_b64_tr_b16 v[100:101], v6 offset:6432
    ds_read_b64_tr_b16 v[102:103], v6 offset:7712
    ds_read_b64_tr_b16 v[104:105], v6 offset:6464
    ds_read_b64_tr_b16 v[106:107], v6 offset:7744
    ds_read_b64_tr_b16 v[108:109], v6 offset:6496
    ds_read_b64_tr_b16 v[110:111], v6 offset:7776
    ds_read_b64_tr_b16 v[112:113], v6 offset:6528
    ds_read_b64_tr_b16 v[114:115], v6 offset:7808
    buffer_load_dwordx4 v[20:23], v0, s[44:47], s22 offen offset:1024 sc1
    ds_read_b64_tr_b16 v[116:117], v6 offset:12800
    ds_read_b64_tr_b16 v[118:119], v6 offset:14080
    ds_read_b64_tr_b16 v[120:121], v6 offset:12832
    ds_read_b64_tr_b16 v[122:123], v6 offset:14112
    ds_read_b64_tr_b16 v[124:125], v6 offset:12864
    ds_read_b64_tr_b16 v[126:127], v6 offset:14144
    ds_read_b64_tr_b16 v[128:129], v6 offset:12896
    ds_read_b64_tr_b16 v[130:131], v6 offset:14176
    ds_read_b64_tr_b16 v[132:133], v6 offset:12928
    ds_read_b64_tr_b16 v[134:135], v6 offset:14208
    buffer_load_dwordx4 v[24:27], v0, s[44:47], s22 offen offset:2048 sc1
    ds_read_b64_tr_b16 v[136:137], v6 offset:19200
    ds_read_b64_tr_b16 v[138:139], v6 offset:20480
    ds_read_b64_tr_b16 v[140:141], v6 offset:19232
    ds_read_b64_tr_b16 v[142:143], v6 offset:20512
    ds_read_b64_tr_b16 v[144:145], v6 offset:19264
    ds_read_b64_tr_b16 v[146:147], v6 offset:20544
    ds_read_b64_tr_b16 v[148:149], v6 offset:19296
    ds_read_b64_tr_b16 v[150:151], v6 offset:20576
    ds_read_b64_tr_b16 v[152:153], v6 offset:19328
    ds_read_b64_tr_b16 v[154:155], v6 offset:20608
    buffer_load_dwordx4 v[28:31], v0, s[44:47], s22 offen offset:3072 sc1
    ds_read_b64_tr_b16 v[156:157], v7 offset:0
    ds_read_b64_tr_b16 v[158:159], v7 offset:12800
    ds_read_b64_tr_b16 v[160:161], v7 offset:32
    ds_read_b64_tr_b16 v[162:163], v7 offset:12832
    ds_read_b64_tr_b16 v[164:165], v7 offset:64
    ds_read_b64_tr_b16 v[166:167], v7 offset:12864
    ds_read_b64_tr_b16 v[168:169], v7 offset:96
    ds_read_b64_tr_b16 v[170:171], v7 offset:12896
    ds_read_b64_tr_b16 v[172:173], v7 offset:128
    ds_read_b64_tr_b16 v[174:175], v7 offset:12928
    buffer_load_dwordx2 v[32:33], v4, s[44:47], s23 offen offset:0 sc1
    buffer_load_dwordx2 v[34:35], v4, s[44:47], s23 offen offset:512 sc1
    ds_read_b64_tr_b16 v[176:177], v3 offset:0
    ds_read_b64_tr_b16 v[178:179], v3 offset:1280
    ds_read_b64_tr_b16 v[180:181], v3 offset:32
    ds_read_b64_tr_b16 v[182:183], v3 offset:1312
    ds_read_b64_tr_b16 v[184:185], v3 offset:64
    ds_read_b64_tr_b16 v[186:187], v3 offset:1344
    ds_read_b64_tr_b16 v[188:189], v3 offset:96
    ds_read_b64_tr_b16 v[190:191], v3 offset:1376
    ds_read_b64_tr_b16 v[192:193], v3 offset:128
    ds_read_b64_tr_b16 v[194:195], v3 offset:1408
    v_mov_b32 v1, 1
    v_mov_b32 v56, 133104
    s_waitcnt vmcnt(6)
    s_mov_b64 exec, 1
    ds_add_u32 v56, v1
    s_mov_b64 exec, -1
    s_waitcnt lgkmcnt(0)
L_p3_one:
    s_waitcnt vmcnt(5)
    buffer_load_dwordx4 v[36:39], v0, s[44:47], s24 offen offset:0 sc1
    v_max3_u32 v1, v16, v17, v18
    v_max_u32 v1, v1, v19
    v_cmp_eq_u32 vcc, -1, v1
    s_cbranch_vccnz L_ck0_again
L_ck0_ok:
    v_mfma_f32_16x16x32_bf16 v[56:59], v[76:79], v[16:19], 0
    ds_read_b64_tr_b16 v[196:197], v3 offset:6400
    ds_read_b64_tr_b16 v[198:199], v3 offset:7680
    v_mfma_f32_16x16x32_bf16 v[60:63], v[80:83], v[16:19], 0
    ds_read_b64_tr_b16 v[200:201], v3 offset:6432
    ds_read_b64_tr_b16 v[202:203], v3 offset:7712
    v_mfma_f32_16x16x32_bf16 v[64:67], v[84:87], v[16:19], 0
    ds_read_b64_tr_b16 v[204:205], v3 offset:6464
    s_waitcnt vmcnt(5)
    buffer_load_dwordx4 v[40:43], v0, s[44:47], s24 offen offset:1024 sc1
    v_max3_u32 v1, v20, v21, v22
    v_mfma_f32_16x16x32_bf16 v[68:71], v[88:91], v[16:19], 0
    v_max_u32 v1, v1, v23
    v_cmp_eq_u32 vcc, -1, v1
    v_mfma_f32_16x16x32_bf16 v[72:75], v[92:95], v[16:19], 0
    ds_read_b64_tr_b16 v[206:207], v3 offset:7744
    ds_read_b64_tr_b16 v[208:209], v3 offset:6496
    s_cbranch_vccnz L_ck1_again
L_ck1_ok:
    v_mfma_f32_16x16x32_bf16 v[56:59], v[96:99], v[20:23], v[56:59]
    ds_read_b64_tr_b16 v[210:211], v3 offset:7776
    ds_read_b64_tr_b16 v[212:213], v3 offset:6528
    v_mfma_f32_16x16x32_bf16 v[60:63], v[100:103], v[20:23], v[60:63]
    ds_read_b64_tr_b16 v[214:215], v3 offset:7808
    ds_read_b64_tr_b16 v[216:217], v3 offset:12800
    v_mfma_f32_16x16x32_bf16 v[64:67], v[104:107], v[20:23], v[64:67]
    ds_read_b64_tr_b16 v[218:219], v3 offset:14080
    s_waitcnt vmcnt(5)
    buffer_load_dwordx4 v[44:47], v0, s[44:47], s24 offen offset:2048 sc1
    v_max3_u32 v1, v24, v25, v26
    v_mfma_f32_16x16x32_bf16 v[68:71], v[108:111], v[20:23], v[68:71]
    v_max_u32 v1, v1, v27
    v_cmp_eq_u32 vcc, -1, v1
    v_mfma_f32_16x16x32_bf16 v[72:75], v[112:115], v[20:23], v[72:75]
    ds_read_b64_tr_b16 v[220:221], v3 offset:12832
    ds_read_b64_tr_b16 v[222:223], v3 offset:14112
    s_cbranch_vccnz L_ck2_again
L_ck2_ok:
    v_mfma_f32_16x16x32_bf16 v[56:59], v[116:119], v[24:27], v[56:59]
    ds_read_b64_tr_b16 v[224:225], v3 offset:12864
    ds_read_b64_tr_b16 v[226:227], v3 offset:14144
    v_mfma_f32_16x16x32_bf16 v[60:63], v[120:123], v[24:27], v[60:63]
    ds_read_b64_tr_b16 v[228:229], v3 offset:12896
    ds_read_b64_tr_b16 v[230:231], v3 offset:14176
    v_mfma_f32_16x16x32_bf16 v[64:67], v[124:127], v[24:27], v[64:67]
    ds_read_b64_tr_b16 v[232:233], v3 offset:12928
    s_waitcnt vmcnt(5)
    buffer_load_dwordx4 v[48:51], v0, s[44:47], s24 offen offset:3072 sc1
    v_max3_u32 v1, v28, v29, v30
    v_mfma_f32_16x16x32_bf16 v[68:71], v[128:131], v[24:27], v[68:71]
    v_max_u32 v1, v1, v31
    v_cmp_eq_u32 vcc, -1, v1
    v_mfma_f32_16x16x32_bf16 v[72:75], v[132:135], v[24:27], v[72:75]
    ds_read_b64_tr_b16 v[234:235], v3 offset:14208
    ds_read_b64_tr_b16 v[236:237], v3 offset:19200
    s_cbranch_vccnz L_ck3_again
L_ck3_ok:
    v_mfma_f32_16x16x32_bf16 v[56:59], v[136:139], v[28:31], v[56:59]
    ds_read_b64_tr_b16 v[238:239], v3 offset:20480
    ds_read_b64_tr_b16 v[240:241], v3 offset:19232
    v_mfma_f32_16x16x32_bf16 v[60:63], v[140:143], v[28:31], v[60:63]
    ds_read_b64_tr_b16 v[242:243], v3 offset:20512
    ds_read_b64_tr_b16 v[244:245], v3 offset:19264
    v_mfma_f32_16x16x32_bf16 v[64:67], v[144:147], v[28:31], v[64:67]
    ds_read_b64_tr_b16 v[246:247], v3 offset:20544
    s_waitcnt vmcnt(4)
    buffer_load_dwordx2 v[52:53], v4, s[44:47], s25 offen offset:0 sc1
    buffer_load_dwordx2 v[54:55], v4, s[44:47], s25 offen offset:512 sc1
    v_max3_u32 v1, v32, v33, v34
    v_mfma_f32_16x16x32_bf16 v[68:71], v[148:151], v[28:31], v[68:71]
    v_max_u32 v1, v1, v35
    v_cmp_eq_u32 vcc, -1, v1
    v_mfma_f32_16x16x32_bf16 v[72:75], v[152:155], v[28:31], v[72:75]
    ds_read_b64_tr_b16 v[248:249], v3 offset:19296
    ds_read_b64_tr_b16 v[250:251], v3 offset:20576
    s_cbranch_vccnz L_ck4_again
L_ck4_ok:
    v_mfma_f32_16x16x32_bf16 v[56:59], v[156:159], v[32:35], v[56:59]
    ds_read_b64_tr_b16 v[252:253], v3 offset:19328
    ds_read_b64_tr_b16 v[254:255], v3 offset:20608
    v_mfma_f32_16x16x32_bf16 v[60:63], v[160:163], v[32:35], v[60:63]
    ds_read_b64_tr_b16 v[76:77], v5 offset:0
    ds_read_b64_tr_b16 v[78:79], v5 offset:12800
    v_mfma_f32_16x16x32_bf16 v[64:67], v[164:167], v[32:35], v[64:67]
    ds_read_b64_tr_b16 v[80:81], v5 offset:32
    s_waitcnt vmcnt(5)
    v_max3_u32 v1, v36, v37, v38
    v_mfma_f32_16x16x32_bf16 v[68:71], v[168:171], v[32:35], v[68:71]
    v_max_u32 v1, v1, v39
    v_cmp_eq_u32 vcc, -1, v1
    v_mfma_f32_16x16x32_bf16 v[72:75], v[172:175], v[32:35], v[72:75]
    ds_read_b64_tr_b16 v[82:83], v5 offset:12832
    ds_read_b64_tr_b16 v[84:85], v5 offset:64
L_p3_join:
    s_cbranch_vccnz L_ck5_again
L_ck5_ok:
    v_mfma_f32_16x16x32_bf16 v[16:19], v[176:179], v[36:39], 0
    ds_read_b64_tr_b16 v[86:87], v5 offset:12864
    ds_read_b64_tr_b16 v[88:89], v5 offset:96
    v_mfma_f32_16x16x32_bf16 v[20:23], v[180:183], v[36:39], 0
    ds_read_b64_tr_b16 v[90:91], v5 offset:12896
    ds_read_b64_tr_b16 v[92:93], v5 offset:128
    v_mfma_f32_16x16x32_bf16 v[24:27], v[184:187], v[36:39], 0
    ds_read_b64_tr_b16 v[94:95], v5 offset:12928
    s_waitcnt vmcnt(4) lgkmcnt(15)
    v_max3_u32 v1, v40, v41, v42
    v_mfma_f32_16x16x32_bf16 v[28:31], v[188:191], v[36:39], 0
    v_max_u32 v1, v1, v43
    v_cmp_eq_u32 vcc, -1, v1
    v_mfma_f32_16x16x32_bf16 v[32:35], v[192:195], v[36:39], 0
    s_cbranch_vccnz L_ck6_again
L_ck6_ok:
    v_mfma_f32_16x16x32_bf16 v[16:19], v[196:199], v[40:43], v[16:19]
    v_mfma_f32_16x16x32_bf16 v[20:23], v[200:203], v[40:43], v[20:23]
    v_mfma_f32_16x16x32_bf16 v[24:27], v[204:207], v[40:43], v[24:27]
    s_waitcnt vmcnt(3) lgkmcnt(15)
    v_max3_u32 v1, v44, v45, v46
    v_mfma_f32_16x16x32_bf16 v[28:31], v[208:211], v[40:43], v[28:31]
    v_max_u32 v1, v1, v47
    v_cmp_eq_u32 vcc, -1, v1
    v_mfma_f32_16x16x32_bf16 v[32:35], v[212:215], v[40:43], v[32:35]
    s_cbranch_vccnz L_ck7_again
L_ck7_ok:
    v_mfma_f32_16x16x32_bf16 v[16:19], v[216:219], v[44:47], v[16:19]
    v_mfma_f32_16x16x32_bf16 v[20:23], v[220:223], v[44:47], v[20:23]
    v_mfma_f32_16x16x32_bf16 v[24:27], v[224:227], v[44:47], v[24:27]
    s_waitcnt vmcnt(2) lgkmcnt(10)
    v_max3_u32 v1, v48, v49, v50
    v_mfma_f32_16x16x32_bf16 v[28:31], v[228:231], v[44:47], v[28:31]
    v_max_u32 v1, v1, v51
    v_cmp_eq_u32 vcc, -1, v1
    v_mfma_f32_16x16x32_bf16 v[32:35], v[232:235], v[44:47], v[32:35]
    s_cbranch_vccnz L_ck8_again
L_ck8_ok:
    v_mfma_f32_16x16x32_bf16 v[16:19], v[236:239], v[48:51], v[16:19]
    v_mfma_f32_16x16x32_bf16 v[20:23], v[240:243], v[48:51], v[20:23]
    v_mfma_f32_16x16x32_bf16 v[24:27], v[244:247], v[48:51], v[24:27]
    s_waitcnt vmcnt(0) lgkmcnt(0)
    v_max3_u32 v1, v52, v53, v54
    v_mfma_f32_16x16x32_bf16 v[28:31], v[248:251], v[48:51], v[28:31]
    v_max_u32 v1, v1, v55
    v_cmp_eq_u32 vcc, -1, v1
    v_mfma_f32_16x16x32_bf16 v[32:35], v[252:255], v[48:51], v[32:35]
    s_waitcnt lgkmcnt(0)
    s_cmp_lt_u32 s16, 4
    s_cbranch_scc0 L_out_fin
    s_cbranch_vccnz L_ck9w_again
L_ck9w_ok:
    v_mfma_f32_16x16x32_bf16 v[16:19], v[76:79], v[52:55], v[16:19]
    v_mfma_f32_16x16x32_bf16 v[20:23], v[80:83], v[52:55], v[20:23]
    v_mfma_f32_16x16x32_bf16 v[24:27], v[84:87], v[52:55], v[24:27]
    v_mfma_f32_16x16x32_bf16 v[28:31], v[88:91], v[52:55], v[28:31]
    v_mfma_f32_16x16x32_bf16 v[32:35], v[92:95], v[52:55], v[32:35]
    s_nop 3
    v_pk_add_f32 v[56:57], v[56:57], v[16:17]
    v_pk_add_f32 v[58:59], v[58:59], v[18:19]
    ds_write_b128 v8, v[56:59] offset:0
    v_pk_add_f32 v[60:61], v[60:61], v[20:21]
    v_pk_add_f32 v[62:63], v[62:63], v[22:23]
    ds_write_b128 v8, v[60:63] offset:1024
    v_pk_add_f32 v[64:65], v[64:65], v[24:25]
    v_pk_add_f32 v[66:67], v[66:67], v[26:27]
    ds_write_b128 v8, v[64:67] offset:2048
    v_pk_add_f32 v[68:69], v[68:69], v[28:29]
    v_pk_add_f32 v[70:71], v[70:71], v[30:31]
    ds_write_b128 v8, v[68:71] offset:3072
    v_pk_add_f32 v[72:73], v[72:73], v[32:33]
    v_pk_add_f32 v[74:75], v[74:75], v[34:35]
    ds_write_b128 v8, v[72:75] offset:4096
    v_mov_b32 v1, 1
    s_waitcnt lgkmcnt(0)
    s_barrier
    s_cmp_eq_u32 s16, 0
    s_cbranch_scc0 L_fin
    s_mov_b64 exec, 1
    buffer_store_dword v1, v0, s[44:47], s39 offen sc1
    s_branch L_fin
L_out_fin:
    s_barrier
    ds_read_b128 v[96:99], v8 offset:0
    ds_read_b128 v[100:103], v8 offset:1024
    ds_read_b128 v[104:107], v8 offset:2048
    ds_read_b128 v[108:111], v8 offset:3072
    ds_read_b128 v[112:115], v8 offset:4096
    s_cbranch_vccnz L_ck9f_again
L_ck9f_ok:
    v_mfma_f32_16x16x32_bf16 v[16:19], v[76:79], v[52:55], v[16:19]
    v_mfma_f32_16x16x32_bf16 v[20:23], v[80:83], v[52:55], v[20:23]
    v_mfma_f32_16x16x32_bf16 v[24:27], v[84:87], v[52:55], v[24:27]
    v_mfma_f32_16x16x32_bf16 v[28:31], v[88:91], v[52:55], v[28:31]
    v_mfma_f32_16x16x32_bf16 v[32:35], v[92:95], v[52:55], v[32:35]
    s_waitcnt lgkmcnt(0)
    s_nop 2
    v_pk_add_f32 v[56:57], v[56:57], v[16:17]
    v_pk_add_f32 v[58:59], v[58:59], v[18:19]
    v_pk_add_f32 v[56:57], v[56:57], v[96:97]
    v_pk_add_f32 v[58:59], v[58:59], v[98:99]
    v_cvt_pk_bf16_f32 v36, v56, v57
    v_cvt_pk_bf16_f32 v37, v58, v59
    ds_write_b64 v9, v[36:37] offset:0
    v_pk_add_f32 v[60:61], v[60:61], v[20:21]
    v_pk_add_f32 v[62:63], v[62:63], v[22:23]
    v_pk_add_f32 v[60:61], v[60:61], v[100:101]
    v_pk_add_f32 v[62:63], v[62:63], v[102:103]
    v_cvt_pk_bf16_f32 v38, v60, v61
    v_cvt_pk_bf16_f32 v39, v62, v63
    ds_write_b64 v9, v[38:39] offset:32
    v_pk_add_f32 v[64:65], v[64:65], v[24:25]
    v_pk_add_f32 v[66:67], v[66:67], v[26:27]
    v_pk_add_f32 v[64:65], v[64:65], v[104:105]
    v_pk_add_f32 v[66:67], v[66:67], v[106:107]
    v_cvt_pk_bf16_f32 v40, v64, v65
    v_cvt_pk_bf16_f32 v41, v66, v67
    ds_write_b64 v9, v[40:41] offset:64
    v_pk_add_f32 v[68:69], v[68:69], v[28:29]
    v_pk_add_f32 v[70:71], v[70:71], v[30:31]
    v_pk_add_f32 v[68:69], v[68:69], v[108:109]
    v_pk_add_f32 v[70:71], v[70:71], v[110:111]
    v_cvt_pk_bf16_f32 v42, v68, v69
    v_cvt_pk_bf16_f32 v43, v70, v71
    ds_write_b64 v9, v[42:43] offset:96
    v_pk_add_f32 v[72:73], v[72:73], v[32:33]
    v_pk_add_f32 v[74:75], v[74:75], v[34:35]
    v_pk_add_f32 v[72:73], v[72:73], v[112:113]
    v_pk_add_f32 v[74:75], v[74:75], v[114:115]
    v_cvt_pk_bf16_f32 v44, v72, v73
    v_cvt_pk_bf16_f32 v45, v74, v75
    ds_write_b64 v9, v[44:45] offset:128
    ds_read_b128 v[96:99], v10
    ds_read_b128 v[100:103], v11
    ds_read_b128 v[104:107], v12
    s_waitcnt lgkmcnt(2)
    buffer_store_dwordx4 v[96:99], v13, s[52:55], s27 offen
    s_waitcnt lgkmcnt(1)
    buffer_store_dwordx4 v[100:103], v14, s[52:55], s27 offen
    s_waitcnt lgkmcnt(0)
    s_mov_b32 exec_hi, 0
    buffer_store_dwordx4 v[104:107], v15, s[52:55], s27 offen
L_fin:
L_end:
    s_endpgm
L_ck9f_again:
    s_add_u32 s28, s28, 1
    s_cmp_eq_u32 s28, 32
    s_cbranch_scc0 L_ck9f_ld
    s_call_b64 s[30:31], L_confirmed
L_ck9f_ld:
    buffer_load_dwordx2 v[52:53], v4, s[44:47], s25 offen offset:0 sc1
    buffer_load_dwordx2 v[54:55], v4, s[44:47], s25 offen offset:512 sc1
    s_waitcnt vmcnt(0)
    s_cmp_ge_u32 s28, 32
    s_cbranch_scc1 L_ck9f_ok
    v_max3_u32 v1, v52, v53, v54
    v_max_u32 v1, v1, v55
    v_cmp_eq_u32 vcc, -1, v1
    s_cbranch_vccnz L_ck9f_again
    s_branch L_ck9f_ok
L_ck9w_again:
    s_add_u32 s28, s28, 1
    s_cmp_eq_u32 s28, 32
    s_cbranch_scc0 L_ck9w_ld
    s_call_b64 s[30:31], L_confirmed
L_ck9w_ld:
    buffer_load_dwordx2 v[52:53], v4, s[44:47], s25 offen offset:0 sc1
    buffer_load_dwordx2 v[54:55], v4, s[44:47], s25 offen offset:512 sc1
    s_waitcnt vmcnt(0)
    s_cmp_ge_u32 s28, 32
    s_cbranch_scc1 L_ck9w_ok
    v_max3_u32 v1, v52, v53, v54
    v_max_u32 v1, v1, v55
    v_cmp_eq_u32 vcc, -1, v1
    s_cbranch_vccnz L_ck9w_again
    s_branch L_ck9w_ok
L_ck8_again:
    s_add_u32 s28, s28, 1
    s_cmp_eq_u32 s28, 32
    s_cbranch_scc0 L_ck8_ld
    s_call_b64 s[30:31], L_confirmed
L_ck8_ld:
    buffer_load_dwordx4 v[48:51], v0, s[44:47], s24 offen offset:3072 sc1
    buffer_load_dwordx2 v[52:53], v4, s[44:47], s25 offen offset:0 sc1
    buffer_load_dwordx2 v[54:55], v4, s[44:47], s25 offen offset:512 sc1
    s_waitcnt vmcnt(2)
    s_cmp_ge_u32 s28, 32
    s_cbranch_scc1 L_ck8_ok
    v_max3_u32 v1, v48, v49, v50
    v_max_u32 v1, v1, v51
    v_cmp_eq_u32 vcc, -1, v1
    s_cbranch_vccnz L_ck8_again
    s_branch L_ck8_ok
L_ck7_again:
    s_add_u32 s28, s28, 1
    s_cmp_eq_u32 s28, 32
    s_cbranch_scc0 L_ck7_ld
    s_call_b64 s[30:31], L_confirmed
L_ck7_ld:
    buffer_load_dwordx4 v[44:47], v0, s[44:47], s24 offen offset:2048 sc1
    buffer_load_dwordx4 v[48:51], v0, s[44:47], s24 offen offset:3072 sc1
    buffer_load_dwordx2 v[52:53], v4, s[44:47], s25 offen offset:0 sc1
    buffer_load_dwordx2 v[54:55], v4, s[44:47], s25 offen offset:512 sc1
    s_waitcnt vmcnt(3)
    s_cmp_ge_u32 s28, 32
    s_cbranch_scc1 L_ck7_ok
    v_max3_u32 v1, v44, v45, v46
    v_max_u32 v1, v1, v47
    v_cmp_eq_u32 vcc, -1, v1
    s_cbranch_vccnz L_ck7_again
    s_branch L_ck7_ok
L_ck6_again:
    s_add_u32 s28, s28, 1
    s_cmp_eq_u32 s28, 32
    s_cbranch_scc0 L_ck6_ld
    s_call_b64 s[30:31], L_confirmed
L_ck6_ld:
    buffer_load_dwordx4 v[40:43], v0, s[44:47], s24 offen offset:1024 sc1
    buffer_load_dwordx4 v[44:47], v0, s[44:47], s24 offen offset:2048 sc1
    buffer_load_dwordx4 v[48:51], v0, s[44:47], s24 offen offset:3072 sc1
    buffer_load_dwordx2 v[52:53], v4, s[44:47], s25 offen offset:0 sc1
    buffer_load_dwordx2 v[54:55], v4, s[44:47], s25 offen offset:512 sc1
    s_waitcnt vmcnt(4)
    s_cmp_ge_u32 s28, 32
    s_cbranch_scc1 L_ck6_ok
    v_max3_u32 v1, v40, v41, v42
    v_max_u32 v1, v1, v43
    v_cmp_eq_u32 vcc, -1, v1
    s_cbranch_vccnz L_ck6_again
    s_branch L_ck6_ok
L_ck5_again:
    s_add_u32 s28, s28, 1
    s_cmp_eq_u32 s28, 32
    s_cbranch_scc0 L_ck5_ld
    s_call_b64 s[30:31], L_confirmed
L_ck5_ld:
    buffer_load_dwordx4 v[36:39], v0, s[44:47], s24 offen offset:0 sc1
    buffer_load_dwordx4 v[40:43], v0, s[44:47], s24 offen offset:1024 sc1
    buffer_load_dwordx4 v[44:47], v0, s[44:47], s24 offen offset:2048 sc1
    buffer_load_dwordx4 v[48:51], v0, s[44:47], s24 offen offset:3072 sc1
    buffer_load_dwordx2 v[52:53], v4, s[44:47], s25 offen offset:0 sc1
    buffer_load_dwordx2 v[54:55], v4, s[44:47], s25 offen offset:512 sc1
    s_waitcnt vmcnt(5)
    s_cmp_ge_u32 s28, 32
    s_cbranch_scc1 L_ck5_ok
    v_max3_u32 v1, v36, v37, v38
    v_max_u32 v1, v1, v39
    v_cmp_eq_u32 vcc, -1, v1
    s_cbranch_vccnz L_ck5_again
    s_branch L_ck5_ok
L_ck4_again:
    s_add_u32 s28, s28, 1
    s_cmp_eq_u32 s28, 32
    s_cbranch_scc0 L_ck4_ld
    s_call_b64 s[30:31], L_confirmed
L_ck4_ld:
    buffer_load_dwordx2 v[32:33], v4, s[44:47], s23 offen offset:0 sc1
    buffer_load_dwordx2 v[34:35], v4, s[44:47], s23 offen offset:512 sc1
    buffer_load_dwordx4 v[36:39], v0, s[44:47], s24 offen offset:0 sc1
    buffer_load_dwordx4 v[40:43], v0, s[44:47], s24 offen offset:1024 sc1
    buffer_load_dwordx4 v[44:47], v0, s[44:47], s24 offen offset:2048 sc1
    buffer_load_dwordx4 v[48:51], v0, s[44:47], s24 offen offset:3072 sc1
    buffer_load_dwordx2 v[52:53], v4, s[44:47], s25 offen offset:0 sc1
    buffer_load_dwordx2 v[54:55], v4, s[44:47], s25 offen offset:512 sc1
    s_waitcnt vmcnt(6)
    s_cmp_ge_u32 s28, 32
    s_cbranch_scc1 L_ck4_ok
    v_max3_u32 v1, v32, v33, v34
    v_max_u32 v1, v1, v35
    v_cmp_eq_u32 vcc, -1, v1
    s_cbranch_vccnz L_ck4_again
    s_branch L_ck4_ok
L_ck3_again:
    s_add_u32 s28, s28, 1
    s_cmp_eq_u32 s28, 32
    s_cbranch_scc0 L_ck3_ld
    s_call_b64 s[30:31], L_confirmed
L_ck3_ld:
    buffer_load_dwordx4 v[28:31], v0, s[44:47], s22 offen offset:3072 sc1
    buffer_load_dwordx2 v[32:33], v4, s[44:47], s23 offen offset:0 sc1
    buffer_load_dwordx2 v[34:35], v4, s[44:47], s23 offen offset:512 sc1
    buffer_load_dwordx4 v[36:39], v0, s[44:47], s24 offen offset:0 sc1
    buffer_load_dwordx4 v[40:43], v0, s[44:47], s24 offen offset:1024 sc1
    buffer_load_dwordx4 v[44:47], v0, s[44:47], s24 offen offset:2048 sc1
    buffer_load_dwordx4 v[48:51], v0, s[44:47], s24 offen offset:3072 sc1
    s_waitcnt vmcnt(6)
    s_cmp_ge_u32 s28, 32
    s_cbranch_scc1 L_ck3_ok
    v_max3_u32 v1, v28, v29, v30
    v_max_u32 v1, v1, v31
    v_cmp_eq_u32 vcc, -1, v1
    s_cbranch_vccnz L_ck3_again
    s_branch L_ck3_ok
L_ck2_again:
    s_add_u32 s28, s28, 1
    s_cmp_eq_u32 s28, 32
    s_cbranch_scc0 L_ck2_ld
    s_call_b64 s[30:31], L_confirmed
L_ck2_ld:
    buffer_load_dwordx4 v[24:27], v0, s[44:47], s22 offen offset:2048 sc1
    buffer_load_dwordx4 v[28:31], v0, s[44:47], s22 offen offset:3072 sc1
    buffer_load_dwordx2 v[32:33], v4, s[44:47], s23 offen offset:0 sc1
    buffer_load_dwordx2 v[34:35], v4, s[44:47], s23 offen offset:512 sc1
    buffer_load_dwordx4 v[36:39], v0, s[44:47], s24 offen offset:0 sc1
    buffer_load_dwordx4 v[40:43], v0, s[44:47], s24 offen offset:1024 sc1
    buffer_load_dwordx4 v[44:47], v0, s[44:47], s24 offen offset:2048 sc1
    s_waitcnt vmcnt(6)
    s_cmp_ge_u32 s28, 32
    s_cbranch_scc1 L_ck2_ok
    v_max3_u32 v1, v24, v25, v26
    v_max_u32 v1, v1, v27
    v_cmp_eq_u32 vcc, -1, v1
    s_cbranch_vccnz L_ck2_again
    s_branch L_ck2_ok
L_ck1_again:
    s_add_u32 s28, s28, 1
    s_cmp_eq_u32 s28, 32
    s_cbranch_scc0 L_ck1_ld
    s_call_b64 s[30:31], L_confirmed
L_ck1_ld:
    buffer_load_dwordx4 v[20:23], v0, s[44:47], s22 offen offset:1024 sc1
    buffer_load_dwordx4 v[24:27], v0, s[44:47], s22 offen offset:2048 sc1
    buffer_load_dwordx4 v[28:31], v0, s[44:47], s22 offen offset:3072 sc1
    buffer_load_dwordx2 v[32:33], v4, s[44:47], s23 offen offset:0 sc1
    buffer_load_dwordx2 v[34:35], v4, s[44:47], s23 offen offset:512 sc1
    buffer_load_dwordx4 v[36:39], v0, s[44:47], s24 offen offset:0 sc1
    buffer_load_dwordx4 v[40:43], v0, s[44:47], s24 offen offset:1024 sc1
    s_waitcnt vmcnt(6)
    s_cmp_ge_u32 s28, 32
    s_cbranch_scc1 L_ck1_ok
    v_max3_u32 v1, v20, v21, v22
    v_max_u32 v1, v1, v23
    v_cmp_eq_u32 vcc, -1, v1
    s_cbranch_vccnz L_ck1_again
    s_branch L_ck1_ok
L_ck0_again:
    s_add_u32 s28, s28, 1
    s_cmp_eq_u32 s28, 32
    s_cbranch_scc0 L_ck0_ld
    s_call_b64 s[30:31], L_confirmed
L_ck0_ld:
    buffer_load_dwordx4 v[16:19], v0, s[44:47], s22 offen offset:0 sc1
    buffer_load_dwordx4 v[20:23], v0, s[44:47], s22 offen offset:1024 sc1
    buffer_load_dwordx4 v[24:27], v0, s[44:47], s22 offen offset:2048 sc1
    buffer_load_dwordx4 v[28:31], v0, s[44:47], s22 offen offset:3072 sc1
    buffer_load_dwordx2 v[32:33], v4, s[44:47], s23 offen offset:0 sc1
    buffer_load_dwordx2 v[34:35], v4, s[44:47], s23 offen offset:512 sc1
    buffer_load_dwordx4 v[36:39], v0, s[44:47], s24 offen offset:0 sc1
    s_waitcnt vmcnt(6)
    s_cmp_ge_u32 s28, 32
    s_cbranch_scc1 L_ck0_ok
    v_max3_u32 v1, v16, v17, v18
    v_max_u32 v1, v1, v19
    v_cmp_eq_u32 vcc, -1, v1
    s_cbranch_vccnz L_ck0_again
    s_branch L_ck0_ok
L_confirmed:
    s_mov_b32 s35, 0
L_cnt:
    v_mov_b32 v1, 133104
    ds_read_b32 v1, v1
    s_waitcnt lgkmcnt(0)
    v_readfirstlane_b32 s34, v1
    s_cmp_eq_u32 s34, 8
    s_cselect_b32 s35, 4194304, s35
    s_add_u32 s35, s35, 1
    s_cmp_lt_u32 s35, 4194304
    s_cbranch_scc1 L_cnt
L_cnt_ok:
    s_mov_b64 exec, 1
    buffer_store_dword v1, v0, s[44:47], s39 offen sc1
    s_mov_b64 exec, -1
    s_add_u32 s34, s40, 32768
    s_waitcnt vmcnt(0)
    s_mov_b32 s35, 0
L_poll3:
    buffer_load_dword v1, v2, s[44:47], s34 offen sc1
    s_waitcnt vmcnt(0)
    v_cmp_ne_u32 vcc, 0, v1
    s_nop 0
    s_cmp_eq_u64 vcc, -1
    s_cselect_b32 s35, 262144, s35
    s_add_u32 s35, s35, 1
    s_cmp_lt_u32 s35, 262144
    s_cbranch_scc1 L_poll3
L_poll3_ok:
    s_setpc_b64 s[30:31]
L_p3_two:
    ds_read_b64_tr_b16 v[76:77], v6 offset:0
    ds_read_b64_tr_b16 v[78:79], v6 offset:1280
    ds_read_b64_tr_b16 v[80:81], v6 offset:32
    ds_read_b64_tr_b16 v[82:83], v6 offset:1312
    ds_read_b64_tr_b16 v[84:85], v6 offset:64
    ds_read_b64_tr_b16 v[86:87], v6 offset:1344
    ds_read_b64_tr_b16 v[88:89], v6 offset:96
    ds_read_b64_tr_b16 v[90:91], v6 offset:1376
    ds_read_b64_tr_b16 v[92:93], v6 offset:128
    ds_read_b64_tr_b16 v[94:95], v6 offset:1408
    ds_read_b64_tr_b16 v[96:97], v6 offset:6400
    ds_read_b64_tr_b16 v[98:99], v6 offset:7680
    ds_read_b64_tr_b16 v[100:101], v6 offset:6432
    ds_read_b64_tr_b16 v[102:103], v6 offset:7712
    ds_read_b64_tr_b16 v[104:105], v6 offset:6464
    ds_read_b64_tr_b16 v[106:107], v6 offset:7744
    ds_read_b64_tr_b16 v[108:109], v6 offset:6496
    ds_read_b64_tr_b16 v[110:111], v6 offset:7776
    ds_read_b64_tr_b16 v[112:113], v6 offset:6528
    ds_read_b64_tr_b16 v[114:115], v6 offset:7808
    ds_read_b64_tr_b16 v[116:117], v6 offset:12800
    ds_read_b64_tr_b16 v[118:119], v6 offset:14080
    ds_read_b64_tr_b16 v[120:121], v6 offset:12832
    ds_read_b64_tr_b16 v[122:123], v6 offset:14112
    ds_read_b64_tr_b16 v[124:125], v6 offset:12864
    ds_read_b64_tr_b16 v[126:127], v6 offset:14144
    ds_read_b64_tr_b16 v[128:129], v6 offset:12896
    ds_read_b64_tr_b16 v[130:131], v6 offset:14176
    ds_read_b64_tr_b16 v[132:133], v6 offset:12928
    ds_read_b64_tr_b16 v[134:135], v6 offset:14208
    ds_read_b64_tr_b16 v[136:137], v6 offset:19200
    ds_read_b64_tr_b16 v[138:139], v6 offset:20480
    ds_read_b64_tr_b16 v[140:141], v6 offset:19232
    ds_read_b64_tr_b16 v[142:143], v6 offset:20512
    ds_read_b64_tr_b16 v[144:145], v6 offset:19264
    ds_read_b64_tr_b16 v[146:147], v6 offset:20544
    ds_read_b64_tr_b16 v[148:149], v6 offset:19296
    ds_read_b64_tr_b16 v[150:151], v6 offset:20576
    ds_read_b64_tr_b16 v[152:153], v6 offset:19328
    ds_read_b64_tr_b16 v[154:155], v6 offset:20608
    ds_read_b64_tr_b16 v[156:157], v7 offset:0
    ds_read_b64_tr_b16 v[158:159], v7 offset:12800
    ds_read_b64_tr_b16 v[160:161], v7 offset:32
    ds_read_b64_tr_b16 v[162:163], v7 offset:12832
    ds_read_b64_tr_b16 v[164:165], v7 offset:64
    buffer_load_dwordx4 v[16:19], v0, s[44:47], s22 offen offset:0 sc1
    ds_read_b64_tr_b16 v[166:167], v7 offset:12864
    ds_read_b64_tr_b16 v[168:169], v7 offset:96
    ds_read_b64_tr_b16 v[170:171], v7 offset:12896
    ds_read_b64_tr_b16 v[172:173], v7 offset:128
    ds_read_b64_tr_b16 v[174:175], v7 offset:12928
    buffer_load_dwordx4 v[20:23], v0, s[44:47], s22 offen offset:1024 sc1
    ds_read_b64_tr_b16 v[176:177], v3 offset:0
    ds_read_b64_tr_b16 v[178:179], v3 offset:1280
    ds_read_b64_tr_b16 v[180:181], v3 offset:32
    ds_read_b64_tr_b16 v[182:183], v3 offset:1312
    ds_read_b64_tr_b16 v[184:185], v3 offset:64
    buffer_load_dwordx4 v[24:27], v0, s[44:47], s22 offen offset:2048 sc1
    ds_read_b64_tr_b16 v[186:187], v3 offset:1344
    ds_read_b64_tr_b16 v[188:189], v3 offset:96
    ds_read_b64_tr_b16 v[190:191], v3 offset:1376
    ds_read_b64_tr_b16 v[192:193], v3 offset:128
    ds_read_b64_tr_b16 v[194:195], v3 offset:1408
    buffer_load_dwordx4 v[28:31], v0, s[44:47], s22 offen offset:3072 sc1
    buffer_load_dwordx2 v[32:33], v4, s[44:47], s23 offen offset:0 sc1
    buffer_load_dwordx2 v[34:35], v4, s[44:47], s23 offen offset:512 sc1
    v_mov_b32 v1, 1
    v_mov_b32 v56, 133104
    s_waitcnt vmcnt(6)
    s_mov_b64 exec, 1
    ds_add_u32 v56, v1
    s_mov_b64 exec, -1
    s_waitcnt lgkmcnt(0)
    s_branch L_p3_one
L_code_end:
L_r_wait:
    s_mov_b32 s35, 0
L_r_spin:
    buffer_load_dword v5, v145, s[44:47], s40 offen sc1
    s_waitcnt vmcnt(0)
    v_cmp_ne_u32 vcc, 0, v5
    s_nop 0
    s_cmp_eq_u64 vcc, -1
    s_cselect_b32 s35, 262144, s35
    s_add_u32 s35, s35, 1
    s_cmp_lt_u32 s35, 262144
    s_cbranch_scc1 L_r_spin
L_r_spin_ok:
    s_branch L_epi
L_attn_slow:
    v_and_b32 v2, 31, v1
    v_lshlrev_b32 v14, 3, v2
    v_lshrrev_b32 v3, 5, v1
    v_mul_u32_u24 v3, 320, v3
    v_lshl_add_u32 v15, v2, 4, v3
    v_mov_b32 v10, 0xff800000
    s_mov_b32 s34, 0
    v_mov_b32 v162, 0
    v_mov_b32 v163, 0
    v_mov_b32 v164, 0
    v_mov_b32 v165, 0
    v_mov_b32 v166, 0
    v_mov_b32 v167, 0
    v_mov_b32 v168, 0
    v_mov_b32 v169, 0
    v_mov_b32 v170, 0
    v_mov_b32 v171, 0
    v_mov_b32 v172, 0
    v_mov_b32 v173, 0
    v_mov_b32 v174, 0
    v_mov_b32 v175, 0
    v_mov_b32 v176, 0
    v_mov_b32 v177, 0
L_slow_pass:
    s_mov_b32 s35, 0
L_slow_tile:
    s_lshr_b32 s30, s35, 1
    s_mul_i32 s30, s30, 5120
    s_add_u32 s30, s30, s21
    s_and_b32 s3, s35, 1
    s_mul_i32 s31, s3, 1280
    s_add_u32 s31, s31, s30
    s_lshl_b32 s3, s3, 8
    s_add_u32 s30, s30, s3
    buffer_load_dwordx2 v[24:25], v14, s[44:47], s30 offen offset:2048 sc1
    buffer_load_dwordx2 v[16:17], v122, s[44:47], s30 offen sc1
    buffer_load_dwordx2 v[18:19], v122, s[44:47], s30 offen offset:1024 sc1
    s_mov_b64 exec, s[24:25]
    buffer_load_dwordx4 v[96:99], v15, s[44:47], s31 offen offset:2560 sc1
    buffer_load_dwordx4 v[100:103], v15, s[44:47], s31 offen offset:3200 sc1
    s_mov_b64 exec, -1
    s_waitcnt vmcnt(0)
    v_mfma_f32_32x32x4_2b_bf16 v[178:209], v[24:25], v[250:251], 0
    s_nop 15
    s_nop 3
    v_mfma_f32_32x32x16_bf16 v[194:209], v[16:19], v[246:249], v[194:209]
    s_nop 15
    s_cmp_eq_u32 s34, 0
    s_cbranch_scc0 L_slow_pv
    v_max3_f32 v10, v10, v194, v195
    v_max3_f32 v10, v10, v196, v197
    v_max3_f32 v10, v10, v198, v199
    v_max3_f32 v10, v10, v200, v201
    v_max3_f32 v10, v10, v202, v203
    v_max3_f32 v10, v10, v204, v205
    v_max3_f32 v10, v10, v206, v207
    v_max3_f32 v10, v10, v208, v209
    s_branch L_slow_next
L_slow_pv:
    v_sub_f32 v194, v194, v10
    v_sub_f32 v195, v195, v10
    v_sub_f32 v196, v196, v10
    v_sub_f32 v197, v197, v10
    v_sub_f32 v198, v198, v10
    v_sub_f32 v199, v199, v10
    v_sub_f32 v200, v200, v10
    v_sub_f32 v201, v201, v10
    v_sub_f32 v202, v202, v10
    v_sub_f32 v203, v203, v10
    v_sub_f32 v204, v204, v10
    v_sub_f32 v205, v205, v10
    v_sub_f32 v206, v206, v10
    v_sub_f32 v207, v207, v10
    v_sub_f32 v208, v208, v10
    v_sub_f32 v209, v209, v10
    v_exp_f32 v194, v194
    v_exp_f32 v195, v195
    v_exp_f32 v196, v196
    v_exp_f32 v197, v197
    v_exp_f32 v198, v198
    v_exp_f32 v199, v199
    v_exp_f32 v200, v200
    v_exp_f32 v201, v201
    v_exp_f32 v202, v202
    v_exp_f32 v203, v203
    v_exp_f32 v204, v204
    v_exp_f32 v205, v205
    v_exp_f32 v206, v206
    v_exp_f32 v207, v207
    v_exp_f32 v208, v208
    v_exp_f32 v209, v209
    s_nop 3
    v_smfmac_f32_32x32x32_bf16 v[162:177], v[96:99], v[194:201], v132
    v_smfmac_f32_32x32x32_bf16 v[162:177], v[100:103], v[202:209], v132
    s_nop 15
L_slow_next:
    s_add_u32 s35, s35, 1
    s_cmp_lt_u32 s35, 64
    s_cbranch_scc1 L_slow_tile
    s_cmp_eq_u32 s34, 0
    s_cbranch_scc0 L_slow_done
    v_mov_b32 v11, v10
    s_nop 1
    v_permlane32_swap_b32 v10, v11
    s_nop 1
    v_max_f32 v10, v10, v11
    s_mov_b32 s34, 1
    s_branch L_slow_pass
L_slow_done:
    v_mov_b32 v7, v170
    v_mov_b32 v9, v170
    s_nop 1
    v_permlane32_swap_b32 v7, v9
    s_nop 1
    v_rcp_f32 v8, v9
    s_branch L_attn_fin
.section .rodata,"a"
.p2align 6
.amdhsa_kernel standalone__softmax_full_mha__prompt_kernel
  .amdhsa_next_free_vgpr 256
  .amdhsa_next_free_sgpr 102
  .amdhsa_accum_offset 256
  .amdhsa_group_segment_fixed_size 0
  .amdhsa_kernarg_size 48
  .amdhsa_user_sgpr_count 2
  .amdhsa_user_sgpr_kernarg_segment_ptr 1
  .amdhsa_system_sgpr_workgroup_id_x 1
.end_amdhsa_kernel
```
